```python
import torch

def _softmax(x, axis=-1):
    return torch.softmax(x, dim=axis)

def _gelu(x):
    return torch.nn.functional.gelu(x, approximate='tanh')

def _silu(x):
    return torch.nn.functional.silu(x)

def _sigmoid(x):
    return torch.sigmoid(x)

def _layernorm(x, axis=-1, eps=1e-05):
    m = x.mean(dim=axis, keepdim=True)
    v = x.var(dim=axis, keepdim=True, unbiased=False)
    return (x - m) / torch.sqrt(v + eps)

def _scatter_add(tgt, idx, src, axis=0):
    return tgt.clone().index_add_(axis, idx, src)

def _segment_sum(src, seg, n):
    out = torch.zeros((n,) + src.shape[1:], dtype=src.dtype)
    return out.index_add_(0, seg, src)

def _pad(x, pw):
    flat = tuple((v for pair in reversed(pw) for v in pair))
    return torch.nn.functional.pad(x, flat)
kernel_name = 'adaLN_cond__sliding_local_dilated__mixer_channel_mlp__prompt'

def setup_inputs():

    _w = lambda a: (lambda t: t.to(torch.bfloat16) if t.is_floating_point() else t)(torch.as_tensor(a))

    def _A_setup():
        B, S, D = (1, 2048, 512)
        return {'x': _w((lambda *s: torch.randn(*s, dtype=torch.bfloat16) * 0.05)(B, S, D)), 'wqkv': _w((lambda *s: torch.randn(*s, dtype=torch.bfloat16) * 0.05)(D, 3 * D)), 'wo': _w((lambda *s: torch.randn(*s, dtype=torch.bfloat16) * 0.05)(D, D))}
    _A_in = _A_setup()

    def _B_setup():
        B, S, D, F = (1, 2048, 512, 1376)
        return {'x': _w((lambda *s: torch.randn(*s, dtype=torch.bfloat16) * 0.05)(B, S, D)), 'w1': _w((lambda *s: torch.randn(*s, dtype=torch.bfloat16) * 3.2)(D, F) * D ** (-0.5)), 'b1': _w((lambda *s: torch.randn(*s, dtype=torch.bfloat16) * 1.6)(F)), 'w2': _w((lambda *s: torch.randn(*s, dtype=torch.bfloat16) * 1.6)(F, D) * F ** (-0.5)), 'b2': _w((lambda *s: torch.randn(*s, dtype=torch.bfloat16) * 1.6)(D))}
    _B_in = _B_setup()
    return {'A_x': _A_in['x'], 'A_wqkv': _A_in['wqkv'], 'A_wo': _A_in['wo'], 'B_x': _B_in['x'], 'B_w1': _B_in['w1'], 'B_b1': _B_in['b1'], 'B_w2': _B_in['w2'], 'B_b2': _B_in['b2'], 'c': _w((lambda *s: torch.randn(*s, dtype=torch.bfloat16) * 0.2)(1, 512) * 8.0), 'w_mod': _w((lambda *s: torch.randn(*s, dtype=torch.bfloat16) * 0.2)(512, 6 * 512) * 512 ** (-0.5) * 8.0)}

def reference(A_x, A_wqkv, A_wo, B_x, B_w1, B_b1, B_w2, B_b2, c, w_mod):

    def _A_ref(x, wqkv, wo):
        B, S, D = x.shape
        H = 32
        Dh = D // H
        W, dil = (8, 2)
        qkv = (lambda x, *d: x.permute(*d))((x @ wqkv).reshape(B, S, 3, H, Dh), 2, 0, 3, 1, 4)
        q, k, v = (qkv[0], qkv[1], qkv[2])
        scale = Dh ** (-0.5)
        pos = torch.arange(S)
        off = torch.arange(W) * dil
        idx = pos[:, None] - off[None, :]
        mask = idx >= 0
        idx_c = torch.where(mask, idx, 0).reshape(-1)
        kg = k[:, :, idx_c, :].reshape(B, H, S, W, Dh)
        vg = v[:, :, idx_c, :].reshape(B, H, S, W, Dh)
        logits = torch.einsum('bhsd,bhswd->bhsw', q, kg) * scale
        logits = torch.where(mask[None, None, :, :], logits, -1000000000.0)
        attn = _softmax(logits, axis=-1)
        o = torch.einsum('bhsw,bhswd->bhsd', attn, vg)
        return (lambda x, *d: x.permute(*d))(o, 0, 2, 1, 3).reshape(B, S, D) @ wo

    def _B_ref(x, w1, b1, w2, b2):
        y = _layernorm(x, axis=-1)
        h = _gelu(torch.einsum('bsd,df->bsf', y, w1) + b1)
        return torch.einsum('bsf,fd->bsd', h, w2) + b2
    x = A_x
    mod = (_silu(c) @ w_mod).reshape(c.shape[0], 6, 1, -1)
    sa, ca, ga, sb, cb, gb = (mod[:, 0].clone(), mod[:, 1].clone(), mod[:, 2].clone(), mod[:, 3].clone(), mod[:, 4].clone(), mod[:, 5].clone())
    h = _layernorm(x, axis=-1) * (1 + ca) + sa
    x = x + ga * _A_ref(h, A_wqkv, A_wo)
    h = _layernorm(x, axis=-1) * (1 + cb) + sb
    x = x + gb * _B_ref(h, B_w1, B_b1, B_w2, B_b2)
    return x
```

```asm
; @launch grid=(256,1,1) block=(256,1,1) lds=163840
.amdgcn_target "amdgcn-amd-amdhsa--gfx950"
.text
.globl adaLN_cond__sliding_local_dilated__mixer_channel_mlp__prompt_kernel
.p2align 8
.type adaLN_cond__sliding_local_dilated__mixer_channel_mlp__prompt_kernel,@function
adaLN_cond__sliding_local_dilated__mixer_channel_mlp__prompt_kernel:
    s_cmp_ge_u32 s2, 256
    s_cbranch_scc1 L_end
    s_load_dwordx8 s[32:39], s[0:1], 64
    s_load_dwordx16 s[16:31], s[0:1], 0
    s_load_dwordx2 s[40:41], s[0:1], 96
    v_lshrrev_b32 v20, 6, v0
    v_and_b32 v1, 63, v0
    v_readfirstlane_b32 s3, v20
    v_lshlrev_b32 v15, 4, v1
    s_getpc_b64 s[64:65]
    s_lshr_b32 s66, s2, 3
    s_lshl_b32 s67, s66, 10
    v_lshl_add_u32 v0, v0, 2, s67
    v_min_u32 v21, CODE_LAST, v0
    global_load_dword v18, v21, s[64:65]
    s_and_b32 s4, s66, 7
    s_lshr_b32 s66, s66, 3
    s_and_b32 s5, s2, 7
    s_lshl2_add_u32 s5, s5, s66
    v_and_b32 v9, 7, v1
    v_lshrrev_b32 v10, 3, v1
    s_and_b32 s64, s2, 3
    s_lshl2_add_u32 s64, s64, s3
    s_lshl_b32 s65, s64, 6
    s_mul_i32 s64, s64, 196608
    s_lshr_b32 s68, s2, 2
    s_lshl_b32 s68, s68, 7
    s_add_u32 s64, s64, s68
    s_cmp_lt_u32 s2, 192
    s_cselect_b32 s64, s64, 0x40000000
    v_mul_u32_u24 v118, 24576, v10
    v_lshl_add_u32 v118, v9, 4, v118
    v_lshlrev_b32 v119, 3, v10
    v_lshrrev_b32 v12, 4, v1
    v_and_b32 v11, 15, v1
    s_lshl_b32 s11, s5, 16
    s_mul_i32 s69, s4, 10
    s_add_u32 s69, s69, s3
    s_lshl_b32 s70, s69, 10
    s_add_u32 s70, s70, s11
    v_and_b32 v20, 1, v12
    v_lshlrev_b32 v20, 5, v20
    v_lshlrev_b32 v32, 4, v9
    v_xor_b32 v32, v32, v20
    s_lshl_b32 s71, s3, 3
    v_add_u32 v20, s71, v10
    v_mul_u32_u24 v131, 3072, v20
    s_and_b32 s71, s3, 1
    s_lshl_b32 s71, s71, 6
    v_xor_b32 v20, s71, v32
    s_lshl_b32 s71, s4, 7
    v_add3_u32 v131, v131, v20, s71
    s_mul_i32 s42, s3, 3072
    s_add_u32 s42, s42, 81920
    s_mov_b32 s43, 0
    s_waitcnt lgkmcnt(0)
    s_mov_b64 s[60:61], s[32:33]
    s_mov_b32 s62, 0x400
    s_mov_b32 s63, 0x20000
    buffer_load_dwordx2 v[240:241], v119, s[60:63], s65 offen
    s_mov_b64 s[52:53], s[34:35]
    s_nop 0
    s_mov_b32 s54, 0x300000
    s_mov_b32 s55, 0x20000
    buffer_load_dwordx4 v[84:87], v118, s[52:55], s64 offen
    s_add_u32 s64, s64, 6144
    buffer_load_dwordx4 v[88:91], v118, s[52:55], s64 offen
    s_add_u32 s64, s64, 6144
    buffer_load_dwordx4 v[92:95], v118, s[52:55], s64 offen
    s_add_u32 s64, s64, 6144
    buffer_load_dwordx4 v[96:99], v118, s[52:55], s64 offen
    s_add_u32 s66, s40, 0x352000
    s_addc_u32 s67, s41, 0
    s_load_dword s6, s[66:67], 0
    s_mov_b64 s[44:45], s[16:17]
    s_mov_b32 s46, 0x200000
    s_mov_b32 s47, 0x20000
    s_sub_u32 s64, s70, 16384
    s_cselect_b32 s64, 0x40000000, s64
    buffer_load_dwordx4 v[228:231], v15, s[44:47], s64 offen
    s_sub_u32 s64, s70, 12288
    s_cselect_b32 s64, 0x40000000, s64
    buffer_load_dwordx4 v[232:235], v15, s[44:47], s64 offen
    s_sub_u32 s64, s70, 8192
    s_cselect_b32 s64, 0x40000000, s64
    buffer_load_dwordx4 v[236:239], v15, s[44:47], s64 offen
    s_mov_b64 s[48:49], s[18:19]
    s_mov_b32 s50, 0x180000
    s_mov_b32 s51, 0x20000
    s_lshl2_add_u32 s64, s2, s3
    s_mul_i32 s64, s64, 1536
    v_lshlrev_b32 v20, 7, v1
    s_mov_b64 exec, 0xfff
    buffer_load_dword v19, v20, s[48:51], s64 offen
    s_mov_b64 exec, -1
    v_lshlrev_b32 v254, 4, v11
    v_lshl_add_u32 v254, v12, 10, v254
    s_lshl_b32 s64, s3, 8
    s_add_u32 s11, s11, s64
    s_sub_u32 s35, s11, 16384
    s_cselect_b32 s35, 0x40000000, s35
    s_lshl2_add_u32 s64, s2, s3
    s_sub_u32 s64, 1023, s64
    s_mov_b32 s59, 0x20000
    s_mov_b32 s58, 1409024
    s_movk_i32 s79, 1024
    s_mov_b32 s78, 32768
    s_cmp_ge_u32 s64, 480
    s_cbranch_scc1 pw2_2
    s_cmp_ge_u32 s64, 128
    s_cbranch_scc1 pw1_1
    s_mov_b32 s56, s20
    s_mov_b32 s57, s21
    s_mov_b32 s58, 524288
    s_lshr_b32 s65, s64, 3
    s_and_b32 s66, s64, 7
    s_mov_b32 s77, 0
    s_branch pdn_3
pw1_1:
    s_mov_b32 s56, s24
    s_mov_b32 s57, s25
    s_sub_u32 s64, s64, 128
    s_and_b32 s65, s64, 15
    s_lshr_b32 s66, s64, 4
    s_movk_i32 s79, 2752
    s_mov_b32 s77, 524288
    s_mov_b32 s78, 90112
    s_branch pdn_3
pw2_2:
    s_mov_b32 s56, s28
    s_mov_b32 s57, s29
    s_sub_u32 s64, s64, 480
    s_lshr_b32 s65, s64, 3
    s_and_b32 s66, s64, 7
    s_cmp_lt_u32 s64, 344
    s_cselect_b32 s77, 1966080, 0x40000000
pdn_3:
    s_mul_i32 s76, s65, s79
    s_lshl_b32 s76, s76, 5
    s_lshl_b32 s67, s66, 7
    s_add_u32 s76, s76, s67
    s_lshl_b32 s67, s66, 12
    s_mul_i32 s65, s65, s78
    s_add_u32 s77, s77, s67
    s_add_u32 s77, s77, s65
    v_mul_lo_u32 v20, v10, s79
    v_add_u32 v126, v20, v32
    v_xor_b32 v21, 64, v32
    v_add_u32 v127, v20, v21
    s_lshl_b32 s79, s79, 3
    s_lshl_b32 s80, s3, 12
    s_add_u32 s80, s80, 65536
    s_add_u32 m0, s80, 0
    s_nop 0
    buffer_load_dwordx4 v126, s[56:59], s76 offen lds
    s_add_u32 s76, s76, s79
    s_add_u32 m0, s80, 1024
    s_nop 0
    buffer_load_dwordx4 v127, s[56:59], s76 offen lds
    s_add_u32 s76, s76, s79
    s_add_u32 m0, s80, 2048
    s_nop 0
    buffer_load_dwordx4 v126, s[56:59], s76 offen lds
    s_add_u32 s76, s76, s79
    s_add_u32 m0, s80, 3072
    s_nop 0
    buffer_load_dwordx4 v127, s[56:59], s76 offen lds
    s_mov_b64 s[12:13], s[40:41]
    s_mov_b32 s14, 0x1000000
    s_mov_b32 s15, 0x20000
    s_mov_b32 s16, 0xffff0000
    s_and_b32 s64, s2, 3
    s_mul_i32 s64, s64, 12288
    s_lshl1_add_u32 s64, s68, s64
    s_lshl_b32 s65, s3, 6
    s_lshl1_add_u32 s64, s65, s64
    s_add_u32 s64, s64, 0x340000
    s_cmp_lt_u32 s2, 192
    s_cselect_b32 s64, s64, 0x40000000
    s_cmp_lt_u32 s3, 2
    s_cselect_b32 s17, s64, 0x40000000
    v_lshlrev_b32 v118, 4, v10
    v_lshrrev_b32 v130, 5, v1
    v_lshl_add_u32 v20, v130, 3, v9
    v_lshlrev_b32 v20, 8, v20
    v_and_b32 v21, 3, v10
    v_lshl_add_u32 v20, v21, 4, v20
    v_add_u32 v242, s65, v20
    v_and_b32 v243, 0x3ff, v0
    v_lshlrev_b32 v243, 3, v243
    s_waitcnt vmcnt(12)
    v_lshlrev_b32 v20, 16, v240
    v_and_b32 v21, s16, v240
    v_lshlrev_b32 v22, 16, v241
    v_and_b32 v23, s16, v241
    v_mul_f32 v24, 0xbfb8aa3b, v20
    v_mul_f32 v25, 0xbfb8aa3b, v21
    v_mul_f32 v26, 0xbfb8aa3b, v22
    v_mul_f32 v27, 0xbfb8aa3b, v23
    v_exp_f32 v24, v24
    v_exp_f32 v25, v25
    v_exp_f32 v26, v26
    v_exp_f32 v27, v27
    v_add_f32 v24, 1.0, v24
    v_add_f32 v25, 1.0, v25
    v_add_f32 v26, 1.0, v26
    v_add_f32 v27, 1.0, v27
    v_rcp_f32 v24, v24
    v_rcp_f32 v25, v25
    v_rcp_f32 v26, v26
    v_rcp_f32 v27, v27
    v_mul_f32 v20, v20, v24
    v_mul_f32 v21, v21, v25
    v_mul_f32 v22, v22, v26
    v_mul_f32_e64 v23, v23, v27
    v_cvt_pk_bf16_f32 v212, v20, 0
    v_cvt_pk_bf16_f32 v213, 0, v20
    v_cvt_pk_bf16_f32 v214, v21, 0
    v_cvt_pk_bf16_f32 v215, 0, v21
    v_cvt_pk_bf16_f32 v216, v22, 0
    v_cvt_pk_bf16_f32 v217, 0, v22
    v_cvt_pk_bf16_f32 v218, v23, 0
    v_cvt_pk_bf16_f32 v219, 0, v23
    s_waitcnt vmcnt(11)
    s_nop 0
    v_dot2_f32_bf16 v220, v84, v212, 0
    v_dot2_f32_bf16 v221, v84, v213, 0
    v_dot2_f32_bf16 v222, v85, v212, 0
    v_dot2_f32_bf16 v223, v85, v213, 0
    v_dot2_f32_bf16 v224, v86, v212, 0
    v_dot2_f32_bf16 v225, v86, v213, 0
    v_dot2_f32_bf16 v226, v87, v212, 0
    v_dot2_f32_bf16 v227, v87, v213, 0
    s_waitcnt vmcnt(10)
    v_dot2c_f32_bf16 v220, v88, v214
    v_dot2c_f32_bf16 v221, v88, v215
    v_dot2c_f32_bf16 v222, v89, v214
    v_dot2c_f32_bf16 v223, v89, v215
    v_dot2c_f32_bf16 v224, v90, v214
    v_dot2c_f32_bf16 v225, v90, v215
    v_dot2c_f32_bf16 v226, v91, v214
    v_dot2c_f32_bf16 v227, v91, v215
    s_waitcnt vmcnt(9)
    v_dot2c_f32_bf16 v220, v92, v216
    v_dot2c_f32_bf16 v221, v92, v217
    v_dot2c_f32_bf16 v222, v93, v216
    v_dot2c_f32_bf16 v223, v93, v217
    v_dot2c_f32_bf16 v224, v94, v216
    v_dot2c_f32_bf16 v225, v94, v217
    v_dot2c_f32_bf16 v226, v95, v216
    v_dot2c_f32_bf16 v227, v95, v217
    s_waitcnt vmcnt(8)
    v_dot2c_f32_bf16 v220, v96, v218
    v_dot2c_f32_bf16 v221, v96, v219
    v_dot2c_f32_bf16 v222, v97, v218
    v_dot2c_f32_bf16 v223, v97, v219
    v_dot2c_f32_bf16 v224, v98, v218
    v_dot2c_f32_bf16 v225, v98, v219
    v_dot2c_f32_bf16 v226, v99, v218
    v_dot2c_f32_bf16 v227, v99, v219
    v_permlane32_swap_b32 v220, v224
    v_permlane32_swap_b32 v221, v225
    v_permlane32_swap_b32 v222, v226
    v_permlane32_swap_b32 v223, v227
    v_add_f32 v220, v220, v224
    v_add_f32 v221, v221, v225
    v_add_f32 v222, v222, v226
    v_add_f32 v223, v223, v227
    ds_write_b128 v242, v[220:223] offset:0
    s_waitcnt lgkmcnt(0)
    s_add_u32 s6, s6, 0x01010101
    v_mov_b32_e64 v2, s6
    s_bfe_u32 s72, s6, 0x80000
    s_bfe_u32 s73, s6, 0x80008
    s_bfe_u32 s74, s6, 0x80010
    s_bfe_u32 s75, s6, 0x80018
    v_mov_b32 v20, 0xffffff00
    s_barrier
    ds_read_b128 v[220:223], v243 offset:0
    ds_read_b128 v[224:227], v243 offset:16
    v_mov_b32 v4, 0
    s_getreg_b32 s64, hwreg(HW_REG_XCC_ID, 0, 4)
    s_xor_b32 s64, s64, s6
    v_mov_b32 v112, s64
    s_lshl_b32 s18, s2, 4
    s_add_u32 s18, s18, 0x350000
    s_cmp_eq_u32 s3, 3
    s_cselect_b32 s18, s18, 0x40000000
    s_waitcnt lgkmcnt(0)
    v_pk_add_f32 v[220:221], v[220:221], v[224:225]
    v_pk_add_f32 v[222:223], v[222:223], v[226:227]
    s_nop 0
    v_add_f32_dpp v220, v220, v220 quad_perm:[1,0,3,2] row_mask:0xf bank_mask:0xf
    v_add_f32_dpp v221, v221, v221 quad_perm:[1,0,3,2] row_mask:0xf bank_mask:0xf
    v_add_f32_dpp v222, v222, v222 quad_perm:[1,0,3,2] row_mask:0xf bank_mask:0xf
    v_add_f32_dpp v223, v223, v223 quad_perm:[1,0,3,2] row_mask:0xf bank_mask:0xf
    v_add_f32_dpp v220, v220, v220 quad_perm:[2,3,0,1] row_mask:0xf bank_mask:0xf
    v_add_f32_dpp v221, v221, v221 quad_perm:[2,3,0,1] row_mask:0xf bank_mask:0xf
    v_add_f32_dpp v222, v222, v222 quad_perm:[2,3,0,1] row_mask:0xf bank_mask:0xf
    v_add_f32_dpp v223, v223, v223 quad_perm:[2,3,0,1] row_mask:0xf bank_mask:0xf
    v_add_f32_dpp v220, v220, v220 row_half_mirror row_mask:0xf bank_mask:0xf
    v_add_f32_dpp v221, v221, v221 row_half_mirror row_mask:0xf bank_mask:0xf
    v_add_f32_dpp v222, v222, v222 row_half_mirror row_mask:0xf bank_mask:0xf
    v_add_f32_dpp v223, v223, v223 row_half_mirror row_mask:0xf bank_mask:0xf
    v_and_or_b32 v220, v220, v20, s72
    v_and_or_b32 v221, v221, v20, s73
    v_and_or_b32 v222, v222, v20, s74
    v_and_or_b32 v223, v223, v20, s75
    s_mov_b32 exec_lo, 0x1010101
    s_mov_b32 exec_hi, exec_lo
    buffer_store_dwordx4 v[220:223], v118, s[12:15], s17 offen sc1
    s_mov_b64 exec, -1
    s_mov_b32 s7, 400000
    s_lshl2_add_u32 s8, s4, s3
    s_mul_i32 s10, s5, 0x58000
    s_add_u32 s10, s10, 0x400000
    v_mov_b32 v7, 0x3f803f80
    v_lshlrev_b32 v114, 7, v9
    v_mov_b32 v215, 0
    v_mov_b32 v219, 0
    s_waitcnt vmcnt(8)
    v_dot2_f32_bf16 v212, v228, v7, 0
    v_dot2_f32_bf16 v216, v228, v228, 0
    s_waitcnt vmcnt(7)
    v_dot2_f32_bf16 v213, v232, v7, 0
    v_dot2_f32_bf16 v217, v232, v232, 0
    s_waitcnt vmcnt(6)
    v_dot2_f32_bf16 v214, v236, v7, 0
    v_dot2_f32_bf16 v218, v236, v236, 0
    v_dot2c_f32_bf16 v212, v229, v7
    v_dot2c_f32_bf16 v216, v229, v229
    v_dot2c_f32_bf16 v213, v233, v7
    v_dot2c_f32_bf16 v217, v233, v233
    buffer_load_dwordx4 v[40:43], v254, s[44:47], s35 offen
    s_add_u32 s35, s35, 4096
    v_dot2c_f32_bf16 v214, v237, v7
    v_dot2c_f32_bf16 v218, v237, v237
    v_dot2c_f32_bf16 v212, v230, v7
    v_dot2c_f32_bf16 v216, v230, v230
    v_dot2c_f32_bf16 v213, v234, v7
    v_dot2c_f32_bf16 v217, v234, v234
    v_dot2c_f32_bf16 v214, v238, v7
    v_dot2c_f32_bf16 v218, v238, v238
    v_dot2c_f32_bf16 v212, v231, v7
    v_dot2c_f32_bf16 v216, v231, v231
    v_dot2c_f32_bf16 v213, v235, v7
    v_dot2c_f32_bf16 v217, v235, v235
    v_dot2c_f32_bf16 v214, v239, v7
    v_dot2c_f32_bf16 v218, v239, v239
    s_and_b32 s34, s69, 3
    s_mul_i32 s34, s34, 20
    v_permlane32_swap_b32 v212, v214
    buffer_load_dwordx4 v[48:51], v254, s[44:47], s35 offen
    s_add_u32 s35, s35, 4096
    v_permlane32_swap_b32 v213, v215
    v_permlane32_swap_b32 v216, v218
    v_permlane32_swap_b32 v217, v219
    v_add_f32 v212, v212, v214
    v_add_f32 v213, v213, v215
    v_add_f32 v216, v216, v218
    v_add_f32 v217, v217, v219
    s_lshr_b32 s69, s69, 2
    s_add_u32 s34, s34, s69
    v_permlane16_swap_b32 v212, v213
    v_permlane16_swap_b32 v216, v217
    v_add_f32 v212, v212, v213
    v_add_f32 v216, v216, v217
    buffer_load_dwordx4 v[56:59], v254, s[44:47], s35 offen
    s_add_u32 s35, s35, 4096
    s_lshl_b32 s34, s34, 4
    s_add_u32 s34, s34, s10
    v_add_f32_dpp v212, v212, v212 row_ror:8 row_mask:0xf bank_mask:0xf
    v_add_f32_dpp v216, v216, v216 row_ror:8 row_mask:0xf bank_mask:0xf
    s_nop 0
    v_add_f32_dpp v212, v212, v212 row_ror:4 row_mask:0xf bank_mask:0xf
    v_add_f32_dpp v216, v216, v216 row_ror:4 row_mask:0xf bank_mask:0xf
    s_nop 0
    v_add_f32_dpp v212, v212, v212 row_ror:2 row_mask:0xf bank_mask:0xf
    v_add_f32_dpp v216, v216, v216 row_ror:2 row_mask:0xf bank_mask:0xf
    s_nop 0
    v_add_f32_dpp v212, v212, v212 row_ror:1 row_mask:0xf bank_mask:0xf
    v_add_f32_dpp v216, v216, v216 row_ror:1 row_mask:0xf bank_mask:0xf
    v_mul_f32 v212, 0xbb000000, v212
    v_mul_f32 v216, 0x3b000000, v216
    v_fma_f32 v216, -v212, v212, v216
    v_max_f32 v216, 0, v216
    v_add_f32 v216, 0x3727c5ac, v216
    v_rsq_f32 v216, v216
    v_mov_b32 v217, v112
    buffer_load_dwordx4 v[64:67], v254, s[44:47], s35 offen
    v_mov_b32 v219, v112
    s_mov_b32 s32, 0x00010001
    s_cmp_lt_u32 s3, 2
    s_cselect_b32 s33, 1, 0
    v_mul_f32 v218, v212, v216
    s_mov_b64 exec, s[32:33]
    buffer_store_dwordx4 v[216:219], v1, s[12:15], s34 offen sc1
    s_mov_b64 exec, -1
    v_xor_b32 v20, v11, v12
    v_lshlrev_b32 v20, 4, v20
    v_lshl_add_u32 v20, v12, 8, v20
    s_mul_i32 s65, s3, 12288
    v_add_u32 v20, s65, v20
    v_xor_b32 v108, 0, v20
    v_xor_b32 v109, 64, v20
    buffer_load_dwordx4 v[72:75], v254, s[44:47], s11 offen
    s_add_u32 s11, s11, 4096
    v_xor_b32 v110, 128, v20
    v_xor_b32 v111, 192, v20
    v_mul_u32_u24 v119, 320, v12
    v_lshl_add_u32 v119, v11, 4, v119
    v_and_b32 v3, 31, v1
    buffer_load_dwordx4 v[80:83], v254, s[44:47], s11 offen
    s_add_u32 s11, s11, 4096
    v_mul_u32_u24 v3, 4, v3
    s_add_u32 s22, s10, 0x5000
    s_mul_i32 s17, s8, 4
    s_add_u32 s17, s17, s22
    s_mul_i32 s84, s3, 512
    buffer_load_dwordx4 v[136:139], v254, s[44:47], s11 offen
    s_add_u32 s11, s11, 4096
    s_add_u32 s84, s84, 0x340000
    s_add_u32 s85, s84, 12288
    s_add_u32 s86, s84, 24576
    s_add_u32 s87, s84, 36864
    v_lshlrev_b32 v128, 11, v130
    buffer_load_dwordx4 v[144:147], v254, s[44:47], s11 offen
    s_add_u32 s11, s11, 4096
    v_lshl_add_u32 v128, v9, 4, v128
    v_and_b32 v20, 1, v10
    v_lshl_add_u32 v128, v20, 8, v128
    v_and_b32 v20, 1, v12
    buffer_load_dwordx4 v[152:155], v254, s[44:47], s11 offen
    s_add_u32 s11, s11, 4096
    v_lshl_add_u32 v128, v20, 7, v128
    v_cvt_f32_u32 v129, v130
    v_lshrrev_b32 v20, 2, v11
    v_lshlrev_b32 v13, 7, v20
    v_lshrrev_b32 v20, 3, v11
    buffer_load_dwordx4 v[160:163], v254, s[44:47], s11 offen
    s_add_u32 s11, s11, 4096
    v_and_b32 v21, 1, v12
    v_lshl_add_u32 v20, v21, 1, v20
    v_lshl_add_u32 v13, v20, 5, v13
    v_and_b32 v20, 3, v11
    v_lshl_add_u32 v13, v20, 3, v13
    buffer_load_dwordx4 v[168:171], v254, s[44:47], s11 offen
    s_add_u32 s11, s11, 4096
    s_lshl_b32 s64, s3, 5
    v_xor_b32 v116, s64, v13
    v_mul_u32_u24 v20, 3072, v12
    v_add_u32 v116, v116, v20
    v_add_u32 v116, 81920, v116
    buffer_load_dwordx4 v[176:179], v254, s[44:47], s11 offen
    s_add_u32 s11, s11, 4096
    v_add_u32 v117, 61440, v116
    v_add_u32 v16, 0x10000, v15
    v_add_u32 v17, 0x20000, v15
    v_lshlrev_b32 v8, 2, v1
    s_waitcnt vmcnt(12)
    v_lshlrev_b32 v36, 16, v40
    v_and_b32 v37, s16, v40
    v_lshlrev_b32 v38, 16, v41
    v_and_b32 v39, s16, v41
    v_lshlrev_b32 v40, 16, v42
    v_and_b32 v41, s16, v42
    v_lshlrev_b32 v42, 16, v43
    v_and_b32 v43, s16, v43
    s_waitcnt vmcnt(11)
    v_lshlrev_b32 v44, 16, v48
    buffer_load_dwordx4 v[184:187], v254, s[44:47], s11 offen
    s_add_u32 s11, s11, 4096
    v_and_b32 v45, s16, v48
    v_lshlrev_b32 v46, 16, v49
    v_and_b32 v47, s16, v49
    v_lshlrev_b32 v48, 16, v50
    v_and_b32 v49, s16, v50
    v_lshlrev_b32 v50, 16, v51
    v_and_b32 v51, s16, v51
    s_waitcnt vmcnt(11)
    v_lshlrev_b32 v52, 16, v56
    v_and_b32 v53, s16, v56
    v_lshlrev_b32 v54, 16, v57
    v_and_b32 v55, s16, v57
    buffer_load_dwordx4 v[192:195], v254, s[44:47], s11 offen
    s_add_u32 s11, s11, 4096
    v_lshlrev_b32 v56, 16, v58
    v_and_b32 v57, s16, v58
    v_lshlrev_b32 v58, 16, v59
    v_and_b32 v59, s16, v59
    s_waitcnt vmcnt(11)
    v_lshlrev_b32 v60, 16, v64
    v_and_b32 v61, s16, v64
    v_lshlrev_b32 v62, 16, v65
    v_and_b32 v63, s16, v65
    v_lshlrev_b32 v64, 16, v66
    v_and_b32 v65, s16, v66
    v_lshlrev_b32 v66, 16, v67
    buffer_load_dwordx4 v[200:203], v254, s[44:47], s11 offen
    s_add_u32 s11, s11, 4096
    v_and_b32 v67, s16, v67
    v_lshl_add_u32 v120, v12, 10, v13
    v_add_u32 v120, s80, v120
    v_xor_b32 v121, 32, v120
    v_xor_b32 v122, 64, v120
    v_xor_b32 v123, 96, v120
    ds_read_b64_tr_b16 a[240:241], v120 offset:0
    ds_read_b64_tr_b16 a[242:243], v120 offset:512
    ds_read_b64_tr_b16 a[244:245], v121 offset:0
    buffer_load_dwordx4 v[208:211], v254, s[44:47], s11 offen
    s_add_u32 s11, s11, 4096
    ds_read_b64_tr_b16 a[246:247], v121 offset:512
    ds_read_b64_tr_b16 a[248:249], v122 offset:0
    ds_read_b64_tr_b16 a[250:251], v122 offset:512
    ds_read_b64_tr_b16 a[252:253], v123 offset:0
    ds_read_b64_tr_b16 a[254:255], v123 offset:512
    s_waitcnt vmcnt(11)
    v_lshlrev_b32 v68, 16, v72
    v_and_b32 v69, s16, v72
    v_lshlrev_b32 v70, 16, v73
    v_and_b32 v71, s16, v73
    v_lshlrev_b32 v72, 16, v74
    v_and_b32 v73, s16, v74
    v_lshlrev_b32 v74, 16, v75
    v_and_b32 v75, s16, v75
    s_waitcnt vmcnt(10)
    v_lshlrev_b32 v76, 16, v80
    v_and_b32 v77, s16, v80
    buffer_load_dwordx4 v[216:219], v254, s[44:47], s11 offen
    s_add_u32 s11, s11, 4096
    v_lshlrev_b32 v78, 16, v81
    v_and_b32 v79, s16, v81
    v_lshlrev_b32 v80, 16, v82
    v_and_b32 v81, s16, v82
    v_lshlrev_b32 v82, 16, v83
    v_and_b32 v83, s16, v83
    s_waitcnt vmcnt(10)
    v_lshlrev_b32 v132, 16, v136
    v_and_b32 v133, s16, v136
    v_lshlrev_b32 v134, 16, v137
    v_and_b32 v135, s16, v137
    buffer_load_dwordx4 v[224:227], v254, s[44:47], s11 offen
    s_add_u32 s11, s11, 4096
    v_lshlrev_b32 v136, 16, v138
    v_and_b32 v137, s16, v138
    v_lshlrev_b32 v138, 16, v139
    v_and_b32 v139, s16, v139
    s_waitcnt vmcnt(10)
    v_lshlrev_b32 v140, 16, v144
    v_and_b32 v141, s16, v144
    v_lshlrev_b32 v142, 16, v145
    v_and_b32 v143, s16, v145
    v_lshlrev_b32 v144, 16, v146
    v_and_b32 v145, s16, v146
    buffer_load_dwordx4 v[232:235], v254, s[44:47], s11 offen
    s_add_u32 s11, s11, 4096
    v_lshlrev_b32 v146, 16, v147
    v_and_b32 v147, s16, v147
    s_waitcnt vmcnt(10)
    v_lshlrev_b32 v148, 16, v152
    v_and_b32 v149, s16, v152
    v_lshlrev_b32 v150, 16, v153
    v_and_b32 v151, s16, v153
    v_lshlrev_b32 v152, 16, v154
    v_and_b32 v153, s16, v154
    v_lshlrev_b32 v154, 16, v155
    v_and_b32 v155, s16, v155
    buffer_load_dwordx4 v[240:243], v254, s[44:47], s11 offen
    s_waitcnt vmcnt(10)
    v_lshlrev_b32 v156, 16, v160
    v_and_b32 v157, s16, v160
    v_lshlrev_b32 v158, 16, v161
    v_and_b32 v159, s16, v161
    v_lshlrev_b32 v160, 16, v162
    s_add_u32 m0, s42, 0
    s_nop 0
    buffer_load_dwordx4 v131, s[48:51], s43 offen offset:0 lds
    v_and_b32 v161, s16, v162
    v_lshlrev_b32 v162, 16, v163
    v_and_b32 v163, s16, v163
    s_waitcnt vmcnt(10)
    v_lshlrev_b32 v164, 16, v168
    v_and_b32 v165, s16, v168
    v_lshlrev_b32 v166, 16, v169
    v_and_b32 v167, s16, v169
    v_lshlrev_b32 v168, 16, v170
    v_and_b32 v169, s16, v170
    v_lshlrev_b32 v170, 16, v171
    buffer_load_dwordx4 v131, s[48:51], s43 offen offset:1024 lds
    v_and_b32 v171, s16, v171
    s_waitcnt vmcnt(10)
    v_lshlrev_b32 v172, 16, v176
    v_and_b32 v173, s16, v176
    v_lshlrev_b32 v174, 16, v177
    v_and_b32 v175, s16, v177
    buffer_load_dwordx4 v131, s[48:51], s43 offen offset:2048 lds
    v_lshlrev_b32 v176, 16, v178
    v_and_b32 v177, s16, v178
    v_lshlrev_b32 v178, 16, v179
    v_and_b32 v179, s16, v179
    buffer_load_dwordx4 v[100:103], v119, s[12:15], s10 offen sc1
    s_mov_b32 exec_lo, 0xf000f
    s_mov_b32 exec_hi, exec_lo
    buffer_load_dwordx4 v[104:107], v119, s[12:15], s10 offen offset:256 sc1
    s_mov_b64 exec, -1
    buffer_load_dwordx4 v[84:87], v128, s[12:15], s84 offen sc1
    buffer_load_dwordx4 v[88:91], v128, s[12:15], s85 offen sc1
    buffer_load_dwordx4 v[92:95], v128, s[12:15], s86 offen sc1
    buffer_load_dwordx4 v[96:99], v128, s[12:15], s87 offen sc1
    s_waitcnt vmcnt(16)
    v_lshlrev_b32 v180, 16, v184
    v_and_b32 v181, s16, v184
    v_lshlrev_b32 v182, 16, v185
    v_and_b32 v183, s16, v185
    v_lshlrev_b32 v184, 16, v186
    v_and_b32 v185, s16, v186
    v_lshlrev_b32 v186, 16, v187
    v_and_b32 v187, s16, v187
    s_waitcnt vmcnt(15)
    v_lshlrev_b32 v188, 16, v192
    v_and_b32 v189, s16, v192
    s_add_u32 m0, s42, 12288
    s_add_u32 s43, s43, 98304
    buffer_load_dwordx4 v131, s[48:51], s43 offen offset:0 lds
    v_lshlrev_b32 v190, 16, v193
    v_and_b32 v191, s16, v193
    v_lshlrev_b32 v192, 16, v194
    v_and_b32 v193, s16, v194
    v_lshlrev_b32 v194, 16, v195
    v_and_b32 v195, s16, v195
    s_waitcnt vmcnt(15)
    v_lshlrev_b32 v196, 16, v200
    v_and_b32 v197, s16, v200
    v_lshlrev_b32 v198, 16, v201
    v_and_b32 v199, s16, v201
    v_lshlrev_b32 v200, 16, v202
    v_and_b32 v201, s16, v202
    v_lshlrev_b32 v202, 16, v203
    v_and_b32 v203, s16, v203
    s_waitcnt vmcnt(14)
    v_lshlrev_b32 v204, 16, v208
    v_and_b32 v205, s16, v208
    buffer_load_dwordx4 v131, s[48:51], s43 offen offset:1024 lds
    v_lshlrev_b32 v206, 16, v209
    v_and_b32 v207, s16, v209
    v_lshlrev_b32 v208, 16, v210
    v_and_b32 v209, s16, v210
    v_lshlrev_b32 v210, 16, v211
    v_and_b32 v211, s16, v211
    buffer_load_dwordx4 v131, s[48:51], s43 offen offset:2048 lds
    s_waitcnt vmcnt(15)
    v_lshlrev_b32 v212, 16, v216
    v_and_b32 v213, s16, v216
    v_lshlrev_b32 v214, 16, v217
    v_and_b32 v215, s16, v217
    v_lshlrev_b32 v216, 16, v218
    s_add_u32 m0, s42, 24576
    s_add_u32 s43, s43, 98304
    buffer_load_dwordx4 v131, s[48:51], s43 offen offset:0 lds
    v_and_b32 v217, s16, v218
    v_lshlrev_b32 v218, 16, v219
    v_and_b32 v219, s16, v219
    s_waitcnt vmcnt(15)
    v_lshlrev_b32 v220, 16, v224
    v_and_b32 v221, s16, v224
    v_lshlrev_b32 v222, 16, v225
    v_and_b32 v223, s16, v225
    v_lshlrev_b32 v224, 16, v226
    v_and_b32 v225, s16, v226
    v_lshlrev_b32 v226, 16, v227
    v_and_b32 v227, s16, v227
    s_waitcnt vmcnt(14)
    v_lshlrev_b32 v228, 16, v232
    v_and_b32 v229, s16, v232
    v_lshlrev_b32 v230, 16, v233
    v_and_b32 v231, s16, v233
    v_lshlrev_b32 v232, 16, v234
    v_and_b32 v233, s16, v234
    buffer_load_dwordx4 v131, s[48:51], s43 offen offset:1024 lds
    v_lshlrev_b32 v234, 16, v235
    v_and_b32 v235, s16, v235
    s_waitcnt vmcnt(14)
    v_lshlrev_b32 v236, 16, v240
    v_and_b32 v237, s16, v240
    v_lshlrev_b32 v238, 16, v241
    buffer_load_dwordx4 v131, s[48:51], s43 offen offset:2048 lds
    v_and_b32 v239, s16, v241
    v_lshlrev_b32 v240, 16, v242
    v_and_b32 v241, s16, v242
    v_lshlrev_b32 v242, 16, v243
    v_and_b32 v243, s16, v243
    s_waitcnt vmcnt(11)
    v_xor_b32 v101, v101, v112
    v_xor_b32 v103, v103, v112
    s_waitcnt vmcnt(10)
    v_xor_b32 v105, v105, v112
    v_xor_b32 v107, v107, v112
    v_or_b32 v101, v101, v103
    s_mov_b32 exec_lo, 0xf000f
    s_mov_b32 exec_hi, exec_lo
    v_or3_b32 v101, v101, v105, v107
    s_mov_b64 exec, -1
    v_cmp_lt_u32 vcc, 15, v101
    s_nop 0
    s_cbranch_vccnz retry_4
ready_5:
    v_cmp_ne_u32 s[82:83], 0, v101
    v_mov_b32_dpp v20, v100 row_newbcast:0 row_mask:0xf bank_mask:0xf
    v_mov_b32_dpp v21, v102 row_newbcast:0 row_mask:0xf bank_mask:0xf
    v_mov_b32_dpp v22, v100 row_newbcast:1 row_mask:0xf bank_mask:0xf
    v_mov_b32_dpp v23, v102 row_newbcast:1 row_mask:0xf bank_mask:0xf
    v_mov_b32_dpp v24, v100 row_newbcast:2 row_mask:0xf bank_mask:0xf
    v_mov_b32_dpp v25, v102 row_newbcast:2 row_mask:0xf bank_mask:0xf
    v_mov_b32_dpp v26, v100 row_newbcast:3 row_mask:0xf bank_mask:0xf
    v_mov_b32_dpp v27, v102 row_newbcast:3 row_mask:0xf bank_mask:0xf
    v_pk_fma_f32 v[36:37], v[36:37], v[20:21], v[20:21] op_sel:[0,0,1] op_sel_hi:[1,0,1]
    v_pk_fma_f32 v[38:39], v[38:39], v[20:21], v[20:21] op_sel:[0,0,1] op_sel_hi:[1,0,1]
    v_pk_fma_f32 v[40:41], v[40:41], v[20:21], v[20:21] op_sel:[0,0,1] op_sel_hi:[1,0,1]
    s_add_u32 m0, s42, 36864
    s_add_u32 s43, s43, 98304
    buffer_load_dwordx4 v131, s[48:51], s43 offen offset:0 lds
    v_pk_fma_f32 v[42:43], v[42:43], v[20:21], v[20:21] op_sel:[0,0,1] op_sel_hi:[1,0,1]
    v_pk_fma_f32 v[44:45], v[44:45], v[22:23], v[22:23] op_sel:[0,0,1] op_sel_hi:[1,0,1]
    v_pk_fma_f32 v[46:47], v[46:47], v[22:23], v[22:23] op_sel:[0,0,1] op_sel_hi:[1,0,1]
    v_pk_fma_f32 v[48:49], v[48:49], v[22:23], v[22:23] op_sel:[0,0,1] op_sel_hi:[1,0,1]
    v_pk_fma_f32 v[50:51], v[50:51], v[22:23], v[22:23] op_sel:[0,0,1] op_sel_hi:[1,0,1]
    v_pk_fma_f32 v[52:53], v[52:53], v[24:25], v[24:25] op_sel:[0,0,1] op_sel_hi:[1,0,1]
    v_pk_fma_f32 v[54:55], v[54:55], v[24:25], v[24:25] op_sel:[0,0,1] op_sel_hi:[1,0,1]
    v_pk_fma_f32 v[56:57], v[56:57], v[24:25], v[24:25] op_sel:[0,0,1] op_sel_hi:[1,0,1]
    v_pk_fma_f32 v[58:59], v[58:59], v[24:25], v[24:25] op_sel:[0,0,1] op_sel_hi:[1,0,1]
    v_pk_fma_f32 v[60:61], v[60:61], v[26:27], v[26:27] op_sel:[0,0,1] op_sel_hi:[1,0,1]
    v_pk_fma_f32 v[62:63], v[62:63], v[26:27], v[26:27] op_sel:[0,0,1] op_sel_hi:[1,0,1]
    v_pk_fma_f32 v[64:65], v[64:65], v[26:27], v[26:27] op_sel:[0,0,1] op_sel_hi:[1,0,1]
    v_pk_fma_f32 v[66:67], v[66:67], v[26:27], v[26:27] op_sel:[0,0,1] op_sel_hi:[1,0,1]
    v_mov_b32_dpp v20, v100 row_newbcast:4 row_mask:0xf bank_mask:0xf
    v_mov_b32_dpp v21, v102 row_newbcast:4 row_mask:0xf bank_mask:0xf
    v_mov_b32_dpp v22, v100 row_newbcast:5 row_mask:0xf bank_mask:0xf
    v_mov_b32_dpp v23, v102 row_newbcast:5 row_mask:0xf bank_mask:0xf
    v_mov_b32_dpp v24, v100 row_newbcast:6 row_mask:0xf bank_mask:0xf
    v_mov_b32_dpp v25, v102 row_newbcast:6 row_mask:0xf bank_mask:0xf
    v_mov_b32_dpp v26, v100 row_newbcast:7 row_mask:0xf bank_mask:0xf
    v_mov_b32_dpp v27, v102 row_newbcast:7 row_mask:0xf bank_mask:0xf
    v_pk_fma_f32 v[68:69], v[68:69], v[20:21], v[20:21] op_sel:[0,0,1] op_sel_hi:[1,0,1]
    v_pk_fma_f32 v[70:71], v[70:71], v[20:21], v[20:21] op_sel:[0,0,1] op_sel_hi:[1,0,1]
    v_pk_fma_f32 v[72:73], v[72:73], v[20:21], v[20:21] op_sel:[0,0,1] op_sel_hi:[1,0,1]
    v_pk_fma_f32 v[74:75], v[74:75], v[20:21], v[20:21] op_sel:[0,0,1] op_sel_hi:[1,0,1]
    v_pk_fma_f32 v[76:77], v[76:77], v[22:23], v[22:23] op_sel:[0,0,1] op_sel_hi:[1,0,1]
    v_pk_fma_f32 v[78:79], v[78:79], v[22:23], v[22:23] op_sel:[0,0,1] op_sel_hi:[1,0,1]
    v_pk_fma_f32 v[80:81], v[80:81], v[22:23], v[22:23] op_sel:[0,0,1] op_sel_hi:[1,0,1]
    v_pk_fma_f32 v[82:83], v[82:83], v[22:23], v[22:23] op_sel:[0,0,1] op_sel_hi:[1,0,1]
    v_pk_fma_f32 v[132:133], v[132:133], v[24:25], v[24:25] op_sel:[0,0,1] op_sel_hi:[1,0,1]
    v_pk_fma_f32 v[134:135], v[134:135], v[24:25], v[24:25] op_sel:[0,0,1] op_sel_hi:[1,0,1]
    v_pk_fma_f32 v[136:137], v[136:137], v[24:25], v[24:25] op_sel:[0,0,1] op_sel_hi:[1,0,1]
    v_pk_fma_f32 v[138:139], v[138:139], v[24:25], v[24:25] op_sel:[0,0,1] op_sel_hi:[1,0,1]
    v_pk_fma_f32 v[140:141], v[140:141], v[26:27], v[26:27] op_sel:[0,0,1] op_sel_hi:[1,0,1]
    v_pk_fma_f32 v[142:143], v[142:143], v[26:27], v[26:27] op_sel:[0,0,1] op_sel_hi:[1,0,1]
    v_pk_fma_f32 v[144:145], v[144:145], v[26:27], v[26:27] op_sel:[0,0,1] op_sel_hi:[1,0,1]
    v_pk_fma_f32 v[146:147], v[146:147], v[26:27], v[26:27] op_sel:[0,0,1] op_sel_hi:[1,0,1]
    buffer_load_dwordx4 v131, s[48:51], s43 offen offset:1024 lds
    v_mov_b32_dpp v20, v100 row_newbcast:8 row_mask:0xf bank_mask:0xf
    v_mov_b32_dpp v21, v102 row_newbcast:8 row_mask:0xf bank_mask:0xf
    v_mov_b32_dpp v22, v100 row_newbcast:9 row_mask:0xf bank_mask:0xf
    v_mov_b32_dpp v23, v102 row_newbcast:9 row_mask:0xf bank_mask:0xf
    v_mov_b32_dpp v24, v100 row_newbcast:10 row_mask:0xf bank_mask:0xf
    v_mov_b32_dpp v25, v102 row_newbcast:10 row_mask:0xf bank_mask:0xf
    v_mov_b32_dpp v26, v100 row_newbcast:11 row_mask:0xf bank_mask:0xf
    v_mov_b32_dpp v27, v102 row_newbcast:11 row_mask:0xf bank_mask:0xf
    v_pk_fma_f32 v[148:149], v[148:149], v[20:21], v[20:21] op_sel:[0,0,1] op_sel_hi:[1,0,1]
    v_pk_fma_f32 v[150:151], v[150:151], v[20:21], v[20:21] op_sel:[0,0,1] op_sel_hi:[1,0,1]
    v_pk_fma_f32 v[152:153], v[152:153], v[20:21], v[20:21] op_sel:[0,0,1] op_sel_hi:[1,0,1]
    v_pk_fma_f32 v[154:155], v[154:155], v[20:21], v[20:21] op_sel:[0,0,1] op_sel_hi:[1,0,1]
    buffer_load_dwordx4 v131, s[48:51], s43 offen offset:2048 lds
    v_pk_fma_f32 v[156:157], v[156:157], v[22:23], v[22:23] op_sel:[0,0,1] op_sel_hi:[1,0,1]
    v_pk_fma_f32 v[158:159], v[158:159], v[22:23], v[22:23] op_sel:[0,0,1] op_sel_hi:[1,0,1]
    v_pk_fma_f32 v[160:161], v[160:161], v[22:23], v[22:23] op_sel:[0,0,1] op_sel_hi:[1,0,1]
    v_pk_fma_f32 v[162:163], v[162:163], v[22:23], v[22:23] op_sel:[0,0,1] op_sel_hi:[1,0,1]
    v_pk_fma_f32 v[164:165], v[164:165], v[24:25], v[24:25] op_sel:[0,0,1] op_sel_hi:[1,0,1]
    v_pk_fma_f32 v[166:167], v[166:167], v[24:25], v[24:25] op_sel:[0,0,1] op_sel_hi:[1,0,1]
    v_pk_fma_f32 v[168:169], v[168:169], v[24:25], v[24:25] op_sel:[0,0,1] op_sel_hi:[1,0,1]
    v_pk_fma_f32 v[170:171], v[170:171], v[24:25], v[24:25] op_sel:[0,0,1] op_sel_hi:[1,0,1]
    v_pk_fma_f32 v[172:173], v[172:173], v[26:27], v[26:27] op_sel:[0,0,1] op_sel_hi:[1,0,1]
    v_pk_fma_f32 v[174:175], v[174:175], v[26:27], v[26:27] op_sel:[0,0,1] op_sel_hi:[1,0,1]
    v_pk_fma_f32 v[176:177], v[176:177], v[26:27], v[26:27] op_sel:[0,0,1] op_sel_hi:[1,0,1]
    v_pk_fma_f32 v[178:179], v[178:179], v[26:27], v[26:27] op_sel:[0,0,1] op_sel_hi:[1,0,1]
    s_waitcnt vmcnt(12)
    v_xor_b32 v84, s72, v84
    v_xor_b32 v85, s73, v85
    v_xor_b32 v86, s74, v86
    v_xor_b32 v87, s75, v87
    s_waitcnt vmcnt(11)
    v_xor_b32 v88, s72, v88
    v_xor_b32 v89, s73, v89
    v_xor_b32 v90, s74, v90
    v_xor_b32 v91, s75, v91
    s_waitcnt vmcnt(10)
    v_xor_b32 v92, s72, v92
    v_xor_b32 v93, s73, v93
    v_xor_b32 v94, s74, v94
    v_xor_b32 v95, s75, v95
    s_waitcnt vmcnt(9)
    v_xor_b32 v96, s72, v96
    v_xor_b32 v97, s73, v97
    v_xor_b32 v98, s74, v98
    v_xor_b32 v99, s75, v99
    v_or3_b32 v28, v84, v85, v86
    v_or3_b32 v29, v87, v88, v89
    v_or3_b32 v30, v90, v91, v92
    v_or3_b32 v31, v93, v94, v95
    v_or3_b32 v32, v96, v97, v98
    v_or3_b32 v28, v28, v29, v30
    v_or3_b32 v31, v31, v32, v99
    v_or_b32 v28, v28, v31
    v_and_b32 v28, 0xff, v28
    v_cmp_ne_u32 vcc, 0, v28
    s_nop 0
    s_cbranch_vccnz retry_6
ready_7:
    v_pk_add_f32 v[84:85], v[84:85], v[88:89]
    v_pk_add_f32 v[86:87], v[86:87], v[90:91]
    v_pk_add_f32 v[92:93], v[92:93], v[96:97]
    v_pk_add_f32 v[94:95], v[94:95], v[98:99]
    v_pk_add_f32 v[84:85], v[84:85], v[92:93]
    v_pk_add_f32 v[86:87], v[86:87], v[94:95]
    v_cvt_pk_bf16_f32 v88, v84, v85
    v_cvt_pk_bf16_f32 v89, v86, v87
    v_lshlrev_b32 v84, 16, v88
    v_and_b32 v85, s16, v88
    v_lshlrev_b32 v86, 16, v89
    v_and_b32 v87, s16, v89
    v_add_f32 v84, v129, v84
    v_add_f32 v85, v129, v85
    v_add_f32 v86, v129, v86
    v_add_f32 v87, v129, v87
    v_cvt_pk_bf16_f32 v88, v84, v85
    v_cvt_pk_bf16_f32 v89, v86, v87
    v_lshlrev_b32 v84, 16, v88
    v_and_b32 v85, s16, v88
    v_lshlrev_b32 v86, 16, v89
    v_and_b32 v87, s16, v89
    v_mov_b32 v92, v84
    v_mov_b32 v93, v85
    v_mov_b32 v94, v86
    v_mov_b32 v95, v87
    v_permlane32_swap_b32 v84, v92
    v_permlane32_swap_b32 v85, v93
    v_permlane32_swap_b32 v86, v94
    v_permlane32_swap_b32 v87, v95
    v_mov_b32 v88, v84
    v_mov_b32 v96, v92
    v_mov_b32 v89, v85
    v_mov_b32 v97, v93
    v_mov_b32 v90, v86
    v_mov_b32 v98, v94
    v_mov_b32 v91, v87
    v_mov_b32 v99, v95
    v_permlane16_swap_b32 v84, v88
    v_permlane16_swap_b32 v92, v96
    v_permlane16_swap_b32 v85, v89
    v_permlane16_swap_b32 v93, v97
    v_permlane16_swap_b32 v86, v90
    v_permlane16_swap_b32 v94, v98
    v_permlane16_swap_b32 v87, v91
    v_permlane16_swap_b32 v95, v99
    v_pk_fma_f32 v[36:37], v[36:37], v[92:93], v[84:85]
    v_pk_fma_f32 v[38:39], v[38:39], v[94:95], v[86:87]
    v_pk_fma_f32 v[40:41], v[40:41], v[96:97], v[88:89]
    v_pk_fma_f32 v[42:43], v[42:43], v[98:99], v[90:91]
    v_cvt_pk_bf16_f32 v36, v36, v37
    v_cvt_pk_bf16_f32 v37, v38, v39
    v_cvt_pk_bf16_f32 v38, v40, v41
    v_cvt_pk_bf16_f32 v39, v42, v43
    ds_write_b128 v108, v[36:39] offset:0
    s_add_u32 m0, s42, 49152
    s_add_u32 s43, s43, 98304
    buffer_load_dwordx4 v131, s[48:51], s43 offen offset:0 lds
    v_pk_fma_f32 v[44:45], v[44:45], v[92:93], v[84:85]
    v_pk_fma_f32 v[46:47], v[46:47], v[94:95], v[86:87]
    v_pk_fma_f32 v[48:49], v[48:49], v[96:97], v[88:89]
    v_pk_fma_f32 v[50:51], v[50:51], v[98:99], v[90:91]
    v_cvt_pk_bf16_f32 v44, v44, v45
    v_cvt_pk_bf16_f32 v45, v46, v47
    v_cvt_pk_bf16_f32 v46, v48, v49
    v_cvt_pk_bf16_f32 v47, v50, v51
    ds_write_b128 v109, v[44:47] offset:1024
    v_pk_fma_f32 v[52:53], v[52:53], v[92:93], v[84:85]
    v_pk_fma_f32 v[54:55], v[54:55], v[94:95], v[86:87]
    v_pk_fma_f32 v[56:57], v[56:57], v[96:97], v[88:89]
    v_pk_fma_f32 v[58:59], v[58:59], v[98:99], v[90:91]
    v_cvt_pk_bf16_f32 v52, v52, v53
    buffer_load_dwordx4 v131, s[48:51], s43 offen offset:1024 lds
    v_cvt_pk_bf16_f32 v53, v54, v55
    v_cvt_pk_bf16_f32 v54, v56, v57
    v_cvt_pk_bf16_f32 v55, v58, v59
    ds_write_b128 v110, v[52:55] offset:2048
    buffer_load_dwordx4 v131, s[48:51], s43 offen offset:2048 lds
    v_pk_fma_f32 v[60:61], v[60:61], v[92:93], v[84:85]
    v_pk_fma_f32 v[62:63], v[62:63], v[94:95], v[86:87]
    v_pk_fma_f32 v[64:65], v[64:65], v[96:97], v[88:89]
    v_pk_fma_f32 v[66:67], v[66:67], v[98:99], v[90:91]
    s_add_u32 m0, s42, 61440
    s_add_u32 s43, s43, 98304
    buffer_load_dwordx4 v131, s[48:51], s43 offen offset:0 lds
    v_cvt_pk_bf16_f32 v60, v60, v61
    v_cvt_pk_bf16_f32 v61, v62, v63
    v_cvt_pk_bf16_f32 v62, v64, v65
    v_cvt_pk_bf16_f32 v63, v66, v67
    ds_write_b128 v111, v[60:63] offset:3072
    v_mov_b32_dpp v20, v100 row_newbcast:12 row_mask:0xf bank_mask:0xf
    v_mov_b32_dpp v21, v102 row_newbcast:12 row_mask:0xf bank_mask:0xf
    v_mov_b32_dpp v22, v100 row_newbcast:13 row_mask:0xf bank_mask:0xf
    v_mov_b32_dpp v23, v102 row_newbcast:13 row_mask:0xf bank_mask:0xf
    v_mov_b32_dpp v24, v100 row_newbcast:14 row_mask:0xf bank_mask:0xf
    v_mov_b32_dpp v25, v102 row_newbcast:14 row_mask:0xf bank_mask:0xf
    v_mov_b32_dpp v26, v100 row_newbcast:15 row_mask:0xf bank_mask:0xf
    v_mov_b32_dpp v27, v102 row_newbcast:15 row_mask:0xf bank_mask:0xf
    v_pk_fma_f32 v[180:181], v[180:181], v[20:21], v[20:21] op_sel:[0,0,1] op_sel_hi:[1,0,1]
    v_pk_fma_f32 v[182:183], v[182:183], v[20:21], v[20:21] op_sel:[0,0,1] op_sel_hi:[1,0,1]
    v_pk_fma_f32 v[184:185], v[184:185], v[20:21], v[20:21] op_sel:[0,0,1] op_sel_hi:[1,0,1]
    buffer_load_dwordx4 v131, s[48:51], s43 offen offset:1024 lds
    v_pk_fma_f32 v[186:187], v[186:187], v[20:21], v[20:21] op_sel:[0,0,1] op_sel_hi:[1,0,1]
    v_pk_fma_f32 v[188:189], v[188:189], v[22:23], v[22:23] op_sel:[0,0,1] op_sel_hi:[1,0,1]
    v_pk_fma_f32 v[190:191], v[190:191], v[22:23], v[22:23] op_sel:[0,0,1] op_sel_hi:[1,0,1]
    v_pk_fma_f32 v[192:193], v[192:193], v[22:23], v[22:23] op_sel:[0,0,1] op_sel_hi:[1,0,1]
    v_pk_fma_f32 v[194:195], v[194:195], v[22:23], v[22:23] op_sel:[0,0,1] op_sel_hi:[1,0,1]
    v_pk_fma_f32 v[196:197], v[196:197], v[24:25], v[24:25] op_sel:[0,0,1] op_sel_hi:[1,0,1]
    v_pk_fma_f32 v[198:199], v[198:199], v[24:25], v[24:25] op_sel:[0,0,1] op_sel_hi:[1,0,1]
    buffer_load_dwordx4 v131, s[48:51], s43 offen offset:2048 lds
    v_pk_fma_f32 v[200:201], v[200:201], v[24:25], v[24:25] op_sel:[0,0,1] op_sel_hi:[1,0,1]
    v_pk_fma_f32 v[202:203], v[202:203], v[24:25], v[24:25] op_sel:[0,0,1] op_sel_hi:[1,0,1]
    v_pk_fma_f32 v[204:205], v[204:205], v[26:27], v[26:27] op_sel:[0,0,1] op_sel_hi:[1,0,1]
    v_pk_fma_f32 v[206:207], v[206:207], v[26:27], v[26:27] op_sel:[0,0,1] op_sel_hi:[1,0,1]
    v_pk_fma_f32 v[208:209], v[208:209], v[26:27], v[26:27] op_sel:[0,0,1] op_sel_hi:[1,0,1]
    v_pk_fma_f32 v[210:211], v[210:211], v[26:27], v[26:27] op_sel:[0,0,1] op_sel_hi:[1,0,1]
    s_waitcnt lgkmcnt(4)
    s_barrier
    ds_read_b64_tr_b16 a[0:1], v116 offset:0
    ds_read_b64_tr_b16 a[2:3], v116 offset:512
    ds_read_b64_tr_b16 a[4:5], v116 offset:1024
    ds_read_b64_tr_b16 a[6:7], v116 offset:1536
    ds_read_b64_tr_b16 a[8:9], v116 offset:2048
    ds_read_b64_tr_b16 a[10:11], v116 offset:2560
    buffer_store_dwordx4 a[240:243], v15, s[12:15], s77 offen offset:0 sc1
    v_pk_fma_f32 v[68:69], v[68:69], v[92:93], v[84:85]
    v_pk_fma_f32 v[70:71], v[70:71], v[94:95], v[86:87]
    v_pk_fma_f32 v[72:73], v[72:73], v[96:97], v[88:89]
    v_pk_fma_f32 v[74:75], v[74:75], v[98:99], v[90:91]
    v_cvt_pk_bf16_f32 v68, v68, v69
    v_cvt_pk_bf16_f32 v69, v70, v71
    v_cvt_pk_bf16_f32 v70, v72, v73
    v_cvt_pk_bf16_f32 v71, v74, v75
    ds_write_b128 v108, v[68:71] offset:4096
    v_pk_fma_f32 v[76:77], v[76:77], v[92:93], v[84:85]
    v_pk_fma_f32 v[78:79], v[78:79], v[94:95], v[86:87]
    v_pk_fma_f32 v[80:81], v[80:81], v[96:97], v[88:89]
    v_pk_fma_f32 v[82:83], v[82:83], v[98:99], v[90:91]
    v_cvt_pk_bf16_f32 v76, v76, v77
    v_cvt_pk_bf16_f32 v77, v78, v79
    v_cvt_pk_bf16_f32 v78, v80, v81
    v_cvt_pk_bf16_f32 v79, v82, v83
    ds_write_b128 v109, v[76:79] offset:5120
    v_pk_fma_f32 v[132:133], v[132:133], v[92:93], v[84:85]
    v_pk_fma_f32 v[134:135], v[134:135], v[94:95], v[86:87]
    v_pk_fma_f32 v[136:137], v[136:137], v[96:97], v[88:89]
    v_pk_fma_f32 v[138:139], v[138:139], v[98:99], v[90:91]
    v_cvt_pk_bf16_f32 v132, v132, v133
    v_cvt_pk_bf16_f32 v133, v134, v135
    v_cvt_pk_bf16_f32 v134, v136, v137
    v_cvt_pk_bf16_f32 v135, v138, v139
    ds_write_b128 v110, v[132:135] offset:6144
    buffer_store_dwordx4 a[244:247], v15, s[12:15], s77 offen offset:1024 sc1
    v_pk_fma_f32 v[140:141], v[140:141], v[92:93], v[84:85]
    v_pk_fma_f32 v[142:143], v[142:143], v[94:95], v[86:87]
    v_pk_fma_f32 v[144:145], v[144:145], v[96:97], v[88:89]
    v_pk_fma_f32 v[146:147], v[146:147], v[98:99], v[90:91]
    v_cvt_pk_bf16_f32 v140, v140, v141
    v_cvt_pk_bf16_f32 v141, v142, v143
    v_cvt_pk_bf16_f32 v142, v144, v145
    v_cvt_pk_bf16_f32 v143, v146, v147
    ds_write_b128 v111, v[140:143] offset:7168
    v_mov_b32_dpp v20, v104 row_newbcast:0 row_mask:0xf bank_mask:0xf
    v_mov_b32_dpp v21, v106 row_newbcast:0 row_mask:0xf bank_mask:0xf
    v_mov_b32_dpp v22, v104 row_newbcast:1 row_mask:0xf bank_mask:0xf
    v_mov_b32_dpp v23, v106 row_newbcast:1 row_mask:0xf bank_mask:0xf
    v_mov_b32_dpp v24, v104 row_newbcast:2 row_mask:0xf bank_mask:0xf
    v_mov_b32_dpp v25, v106 row_newbcast:2 row_mask:0xf bank_mask:0xf
    v_mov_b32_dpp v26, v104 row_newbcast:3 row_mask:0xf bank_mask:0xf
    v_mov_b32_dpp v27, v106 row_newbcast:3 row_mask:0xf bank_mask:0xf
    v_pk_fma_f32 v[212:213], v[212:213], v[20:21], v[20:21] op_sel:[0,0,1] op_sel_hi:[1,0,1]
    v_pk_fma_f32 v[214:215], v[214:215], v[20:21], v[20:21] op_sel:[0,0,1] op_sel_hi:[1,0,1]
    v_pk_fma_f32 v[216:217], v[216:217], v[20:21], v[20:21] op_sel:[0,0,1] op_sel_hi:[1,0,1]
    v_pk_fma_f32 v[218:219], v[218:219], v[20:21], v[20:21] op_sel:[0,0,1] op_sel_hi:[1,0,1]
    v_pk_fma_f32 v[220:221], v[220:221], v[22:23], v[22:23] op_sel:[0,0,1] op_sel_hi:[1,0,1]
    v_pk_fma_f32 v[222:223], v[222:223], v[22:23], v[22:23] op_sel:[0,0,1] op_sel_hi:[1,0,1]
    v_pk_fma_f32 v[224:225], v[224:225], v[22:23], v[22:23] op_sel:[0,0,1] op_sel_hi:[1,0,1]
    v_pk_fma_f32 v[226:227], v[226:227], v[22:23], v[22:23] op_sel:[0,0,1] op_sel_hi:[1,0,1]
    v_pk_fma_f32 v[228:229], v[228:229], v[24:25], v[24:25] op_sel:[0,0,1] op_sel_hi:[1,0,1]
    v_pk_fma_f32 v[230:231], v[230:231], v[24:25], v[24:25] op_sel:[0,0,1] op_sel_hi:[1,0,1]
    v_pk_fma_f32 v[232:233], v[232:233], v[24:25], v[24:25] op_sel:[0,0,1] op_sel_hi:[1,0,1]
    v_pk_fma_f32 v[234:235], v[234:235], v[24:25], v[24:25] op_sel:[0,0,1] op_sel_hi:[1,0,1]
    v_pk_fma_f32 v[236:237], v[236:237], v[26:27], v[26:27] op_sel:[0,0,1] op_sel_hi:[1,0,1]
    v_pk_fma_f32 v[238:239], v[238:239], v[26:27], v[26:27] op_sel:[0,0,1] op_sel_hi:[1,0,1]
    v_pk_fma_f32 v[240:241], v[240:241], v[26:27], v[26:27] op_sel:[0,0,1] op_sel_hi:[1,0,1]
    v_pk_fma_f32 v[242:243], v[242:243], v[26:27], v[26:27] op_sel:[0,0,1] op_sel_hi:[1,0,1]
    s_waitcnt vmcnt(14)
    s_waitcnt lgkmcnt(4)
    s_barrier
    ds_read_b64_tr_b16 a[12:13], v116 offset:12288
    ds_read_b64_tr_b16 a[14:15], v116 offset:12800
    ds_read_b64_tr_b16 a[16:17], v116 offset:13312
    ds_read_b64_tr_b16 a[18:19], v116 offset:13824
    s_add_u32 m0, s42, 0
    s_add_u32 s43, s43, 98304
    buffer_load_dwordx4 v131, s[48:51], s43 offen offset:0 lds
    ds_read_b64_tr_b16 a[20:21], v116 offset:14336
    ds_read_b64_tr_b16 a[22:23], v116 offset:14848
    v_pk_fma_f32 v[148:149], v[148:149], v[92:93], v[84:85]
    v_pk_fma_f32 v[150:151], v[150:151], v[94:95], v[86:87]
    v_pk_fma_f32 v[152:153], v[152:153], v[96:97], v[88:89]
    v_pk_fma_f32 v[154:155], v[154:155], v[98:99], v[90:91]
    v_cvt_pk_bf16_f32 v148, v148, v149
    v_cvt_pk_bf16_f32 v149, v150, v151
    v_cvt_pk_bf16_f32 v150, v152, v153
    v_cvt_pk_bf16_f32 v151, v154, v155
    ds_write_b128 v108, v[148:151] offset:8192
    v_pk_fma_f32 v[156:157], v[156:157], v[92:93], v[84:85]
    v_pk_fma_f32 v[158:159], v[158:159], v[94:95], v[86:87]
    v_pk_fma_f32 v[160:161], v[160:161], v[96:97], v[88:89]
    v_pk_fma_f32 v[162:163], v[162:163], v[98:99], v[90:91]
    v_cvt_pk_bf16_f32 v156, v156, v157
    v_cvt_pk_bf16_f32 v157, v158, v159
    v_cvt_pk_bf16_f32 v158, v160, v161
    v_cvt_pk_bf16_f32 v159, v162, v163
    ds_write_b128 v109, v[156:159] offset:9216
    buffer_load_dwordx4 v131, s[48:51], s43 offen offset:1024 lds
    v_pk_fma_f32 v[164:165], v[164:165], v[92:93], v[84:85]
    v_pk_fma_f32 v[166:167], v[166:167], v[94:95], v[86:87]
    v_pk_fma_f32 v[168:169], v[168:169], v[96:97], v[88:89]
    v_pk_fma_f32 v[170:171], v[170:171], v[98:99], v[90:91]
    v_cvt_pk_bf16_f32 v164, v164, v165
    v_cvt_pk_bf16_f32 v165, v166, v167
    v_cvt_pk_bf16_f32 v166, v168, v169
    v_cvt_pk_bf16_f32 v167, v170, v171
    ds_write_b128 v110, v[164:167] offset:10240
    buffer_load_dwordx4 v131, s[48:51], s43 offen offset:2048 lds
    v_pk_fma_f32 v[172:173], v[172:173], v[92:93], v[84:85]
    v_pk_fma_f32 v[174:175], v[174:175], v[94:95], v[86:87]
    v_pk_fma_f32 v[176:177], v[176:177], v[96:97], v[88:89]
    v_pk_fma_f32 v[178:179], v[178:179], v[98:99], v[90:91]
    v_cvt_pk_bf16_f32 v172, v172, v173
    buffer_store_dwordx4 a[248:251], v15, s[12:15], s77 offen offset:2048 sc1
    v_cvt_pk_bf16_f32 v173, v174, v175
    v_cvt_pk_bf16_f32 v174, v176, v177
    v_cvt_pk_bf16_f32 v175, v178, v179
    ds_write_b128 v111, v[172:175] offset:11264
    s_waitcnt vmcnt(15)
    s_waitcnt lgkmcnt(4)
    s_barrier
    ds_read_b64_tr_b16 a[24:25], v116 offset:24576
    ds_read_b64_tr_b16 a[26:27], v116 offset:25088
    ds_read_b64_tr_b16 a[28:29], v116 offset:25600
    ds_read_b64_tr_b16 a[30:31], v116 offset:26112
    s_add_u32 m0, s42, 12288
    s_add_u32 s43, s43, 98304
    buffer_load_dwordx4 v131, s[48:51], s43 offen offset:0 lds
    ds_read_b64_tr_b16 a[32:33], v116 offset:26624
    ds_read_b64_tr_b16 a[34:35], v116 offset:27136
    s_lshl_b32 s64, s3, 12
    s_sub_u32 s64, 36864, s64
    v_add_u32 v108, s64, v108
    v_add_u32 v109, s64, v109
    v_add_u32 v110, s64, v110
    v_add_u32 v111, s64, v111
    v_pk_fma_f32 v[180:181], v[180:181], v[92:93], v[84:85]
    v_pk_fma_f32 v[182:183], v[182:183], v[94:95], v[86:87]
    v_pk_fma_f32 v[184:185], v[184:185], v[96:97], v[88:89]
    v_pk_fma_f32 v[186:187], v[186:187], v[98:99], v[90:91]
    v_cvt_pk_bf16_f32 v180, v180, v181
    v_cvt_pk_bf16_f32 v181, v182, v183
    v_cvt_pk_bf16_f32 v182, v184, v185
    v_cvt_pk_bf16_f32 v183, v186, v187
    ds_write_b128 v108, v[180:183] offset:12288
    v_pk_fma_f32 v[188:189], v[188:189], v[92:93], v[84:85]
    v_pk_fma_f32 v[190:191], v[190:191], v[94:95], v[86:87]
    v_pk_fma_f32 v[192:193], v[192:193], v[96:97], v[88:89]
    v_pk_fma_f32 v[194:195], v[194:195], v[98:99], v[90:91]
    v_cvt_pk_bf16_f32 v188, v188, v189
    v_cvt_pk_bf16_f32 v189, v190, v191
    v_cvt_pk_bf16_f32 v190, v192, v193
    v_cvt_pk_bf16_f32 v191, v194, v195
    ds_write_b128 v109, v[188:191] offset:13312
    buffer_load_dwordx4 v131, s[48:51], s43 offen offset:1024 lds
    v_pk_fma_f32 v[196:197], v[196:197], v[92:93], v[84:85]
    v_pk_fma_f32 v[198:199], v[198:199], v[94:95], v[86:87]
    v_pk_fma_f32 v[200:201], v[200:201], v[96:97], v[88:89]
    v_pk_fma_f32 v[202:203], v[202:203], v[98:99], v[90:91]
    v_cvt_pk_bf16_f32 v196, v196, v197
    v_cvt_pk_bf16_f32 v197, v198, v199
    v_cvt_pk_bf16_f32 v198, v200, v201
    buffer_load_dwordx4 v131, s[48:51], s43 offen offset:2048 lds
    v_cvt_pk_bf16_f32 v199, v202, v203
    ds_write_b128 v110, v[196:199] offset:14336
    v_pk_fma_f32 v[204:205], v[204:205], v[92:93], v[84:85]
    v_pk_fma_f32 v[206:207], v[206:207], v[94:95], v[86:87]
    v_pk_fma_f32 v[208:209], v[208:209], v[96:97], v[88:89]
    v_pk_fma_f32 v[210:211], v[210:211], v[98:99], v[90:91]
    buffer_store_dwordx4 a[252:255], v15, s[12:15], s77 offen offset:3072 sc1
    v_cvt_pk_bf16_f32 v204, v204, v205
    v_cvt_pk_bf16_f32 v205, v206, v207
    v_cvt_pk_bf16_f32 v206, v208, v209
    v_cvt_pk_bf16_f32 v207, v210, v211
    ds_write_b128 v111, v[204:207] offset:15360
    s_waitcnt vmcnt(16)
    s_waitcnt lgkmcnt(4)
    s_barrier
    ds_read_b64_tr_b16 a[36:37], v116 offset:36864
    ds_read_b64_tr_b16 a[38:39], v116 offset:37376
    ds_read_b64_tr_b16 a[40:41], v116 offset:37888
    ds_read_b64_tr_b16 a[42:43], v116 offset:38400
    ds_read_b64_tr_b16 a[44:45], v116 offset:38912
    s_add_u32 m0, s42, 24576
    s_add_u32 s43, s43, 98304
    buffer_load_dwordx4 v131, s[48:51], s43 offen offset:0 lds
    ds_read_b64_tr_b16 a[46:47], v116 offset:39424
    v_pk_fma_f32 v[212:213], v[212:213], v[92:93], v[84:85]
    v_pk_fma_f32 v[214:215], v[214:215], v[94:95], v[86:87]
    v_pk_fma_f32 v[216:217], v[216:217], v[96:97], v[88:89]
    v_pk_fma_f32 v[218:219], v[218:219], v[98:99], v[90:91]
    v_cvt_pk_bf16_f32 v212, v212, v213
    v_cvt_pk_bf16_f32 v213, v214, v215
    v_cvt_pk_bf16_f32 v214, v216, v217
    v_cvt_pk_bf16_f32 v215, v218, v219
    ds_write_b128 v108, v[212:215] offset:16384
    v_pk_fma_f32 v[220:221], v[220:221], v[92:93], v[84:85]
    v_pk_fma_f32 v[222:223], v[222:223], v[94:95], v[86:87]
    v_pk_fma_f32 v[224:225], v[224:225], v[96:97], v[88:89]
    v_pk_fma_f32 v[226:227], v[226:227], v[98:99], v[90:91]
    v_cvt_pk_bf16_f32 v220, v220, v221
    v_cvt_pk_bf16_f32 v221, v222, v223
    v_cvt_pk_bf16_f32 v222, v224, v225
    v_cvt_pk_bf16_f32 v223, v226, v227
    ds_write_b128 v109, v[220:223] offset:17408
    v_pk_fma_f32 v[228:229], v[228:229], v[92:93], v[84:85]
    v_pk_fma_f32 v[230:231], v[230:231], v[94:95], v[86:87]
    v_pk_fma_f32 v[232:233], v[232:233], v[96:97], v[88:89]
    v_pk_fma_f32 v[234:235], v[234:235], v[98:99], v[90:91]
    v_cvt_pk_bf16_f32 v228, v228, v229
    v_cvt_pk_bf16_f32 v229, v230, v231
    v_cvt_pk_bf16_f32 v230, v232, v233
    v_cvt_pk_bf16_f32 v231, v234, v235
    ds_write_b128 v110, v[228:231] offset:18432
    buffer_load_dwordx4 v131, s[48:51], s43 offen offset:1024 lds
    v_pk_fma_f32 v[236:237], v[236:237], v[92:93], v[84:85]
    v_pk_fma_f32 v[238:239], v[238:239], v[94:95], v[86:87]
    v_pk_fma_f32 v[240:241], v[240:241], v[96:97], v[88:89]
    v_pk_fma_f32 v[242:243], v[242:243], v[98:99], v[90:91]
    v_cvt_pk_bf16_f32 v236, v236, v237
    v_cvt_pk_bf16_f32 v237, v238, v239
    v_cvt_pk_bf16_f32 v238, v240, v241
    v_cvt_pk_bf16_f32 v239, v242, v243
    buffer_load_dwordx4 v131, s[48:51], s43 offen offset:2048 lds
    ds_write_b128 v111, v[236:239] offset:19456
    v_xor_b32 v24, v11, v12
    v_lshlrev_b32 v24, 4, v24
    v_lshl_add_u32 v24, v11, 8, v24
    v_xor_b32 v244, 0, v24
    v_xor_b32 v245, 64, v24
    v_xor_b32 v246, 128, v24
    v_xor_b32 v247, 192, v24
    s_getpc_b64 s[40:41]
L_pf1:
    v_min_u32 v19, pf_last1, v0
    global_load_dword v18, v19, s[40:41]
    s_waitcnt lgkmcnt(0)
    s_barrier
    ds_read_b128 v[136:139], v244 offset:0
    ds_read_b128 v[140:143], v244 offset:4096
    ds_read_b128 v[144:147], v244 offset:8192
    ds_read_b128 v[148:151], v244 offset:49152
    ds_read_b128 v[152:155], v244 offset:53248
    s_waitcnt lgkmcnt(4)
    v_mfma_f32_16x16x32_bf16 v[196:199], a[4:7], v[136:139], 0
    ds_read_b128 v[156:159], v245 offset:0
    ds_read_b128 v[160:163], v245 offset:4096
    v_mfma_f32_16x16x32_bf16 v[176:179], v[136:139], a[8:11], 0
    ds_read_b128 v[164:167], v245 offset:8192
    s_lshl_b32 s81, s8, 10
    s_waitcnt vmcnt(17)
    s_barrier
    s_waitcnt lgkmcnt(6)
    v_mfma_f32_16x16x32_bf16 v[200:203], a[4:7], v[140:143], 0
    v_mfma_f32_16x16x32_bf16 v[180:183], v[140:143], a[8:11], 0
    ds_read_b128 v[168:171], v245 offset:49152
    ds_read_b128 v[172:175], v245 offset:53248
    v_mfma_f32_16x16x32_bf16 v[216:219], a[0:3], v[140:143], 0
    s_add_u32 s92, s81, 0x80000
    v_add_u32 v252, 0x8000, v15
    s_waitcnt lgkmcnt(7)
    v_mfma_f32_16x16x32_bf16 v[204:207], a[4:7], v[144:147], 0
    ds_read_b64_tr_b16 a[48:49], v116 offset:49152
    s_and_b32 s95, s3, 1
    v_mfma_f32_16x16x32_bf16 v[184:187], v[144:147], a[8:11], 0
    ds_read_b64_tr_b16 a[50:51], v116 offset:49664
    v_mfma_f32_16x16x32_bf16 v[220:223], a[0:3], v[144:147], 0
    s_lshl_b32 s95, s95, 9
    s_add_u32 m0, s42, 36864
    s_add_u32 s43, s43, 98304
    buffer_load_dwordx4 v131, s[48:51], s43 offen offset:0 lds
    s_waitcnt lgkmcnt(8)
    v_mfma_f32_16x16x32_bf16 v[208:211], a[4:7], v[148:151], 0
    s_sub_u32 s81, s81, s95
    v_mfma_f32_16x16x32_bf16 v[188:191], v[148:151], a[8:11], 0
    s_add_u32 s95, s81, 0x1e0000
    ds_read_b64_tr_b16 a[52:53], v116 offset:50176
    v_mfma_f32_16x16x32_bf16 v[224:227], a[0:3], v[148:151], 0
    s_lshl_b32 s9, s3, 3
    s_add_u32 s9, s9, s4
    s_waitcnt lgkmcnt(8)
    v_mfma_f32_16x16x32_bf16 v[212:215], a[4:7], v[152:155], 0
    ds_read_b64_tr_b16 a[54:55], v116 offset:50688
    s_add_u32 s9, s9, 64
    v_mfma_f32_16x16x32_bf16 v[192:195], v[152:155], a[8:11], 0
    buffer_load_dwordx4 v131, s[48:51], s43 offen offset:1024 lds
    ds_read_b64_tr_b16 a[56:57], v116 offset:51200
    v_mfma_f32_16x16x32_bf16 v[228:231], a[0:3], v[152:155], 0
    s_sub_u32 s94, s9, s8
    s_waitcnt lgkmcnt(9)
    v_mfma_f32_16x16x32_bf16 v[196:199], a[16:19], v[156:159], v[196:199]
    s_lshl_b32 s94, s94, 10
    buffer_load_dwordx4 v131, s[48:51], s43 offen offset:2048 lds
    ds_read_b128 v[136:139], v246 offset:0
    v_mfma_f32_16x16x32_bf16 v[176:179], v[156:159], a[20:23], v[176:179]
    ds_read_b64_tr_b16 a[58:59], v116 offset:51712
    s_cmp_lt_u32 s9, 86
    s_cselect_b32 s94, s94, 0x40000000
    s_cselect_b64 s[98:99], -1, 1
    s_waitcnt lgkmcnt(10)
    v_mfma_f32_16x16x32_bf16 v[200:203], a[16:19], v[160:163], v[200:203]
    ds_read_b128 v[140:143], v246 offset:4096
    v_mfma_f32_16x16x32_bf16 v[180:183], v[160:163], a[20:23], v[180:183]
    ds_read_b128 v[144:147], v246 offset:8192
    s_waitcnt vmcnt(17)
    s_waitcnt vmcnt(7)
    s_waitcnt lgkmcnt(2)
    s_barrier
    v_mfma_f32_16x16x32_bf16 v[216:219], a[12:15], v[160:163], v[216:219]
    ds_read_b128 v[148:151], v246 offset:49152
    v_mfma_f32_16x16x32_bf16 v[204:207], a[16:19], v[164:167], v[204:207]
    ds_read_b128 v[152:155], v246 offset:53248
    v_add_u32 v253, s94, v15
    ds_read_b64_tr_b16 a[60:61], v117 offset:0
    v_mfma_f32_16x16x32_bf16 v[184:187], v[164:167], a[20:23], v[184:187]
    s_lshr_b32 s90, s8, 1
    s_lshl_b32 s90, s90, 11
    v_mfma_f32_16x16x32_bf16 v[220:223], a[12:15], v[164:167], v[220:223]
    s_mov_b64 exec, 1
    buffer_store_dword v2, v4, s[12:15], s18 offen sc1
    s_mov_b64 exec, -1
    v_mfma_f32_16x16x32_bf16 v[208:211], a[16:19], v[168:171], v[208:211]
    s_add_u32 s89, s10, s90
    ds_read_b64_tr_b16 a[62:63], v117 offset:512
    v_mfma_f32_16x16x32_bf16 v[188:191], v[168:171], a[20:23], v[188:191]
    s_and_b32 s90, s8, 1
    s_lshl_b32 s90, s90, 9
    s_lshl_b32 s18, s3, 10
    v_mfma_f32_16x16x32_bf16 v[224:227], a[12:15], v[168:171], v[224:227]
    ds_read_b64_tr_b16 a[64:65], v117 offset:1024
    s_add_u32 s89, s89, s90
    v_mfma_f32_16x16x32_bf16 v[212:215], a[16:19], v[172:175], v[212:215]
    s_add_u32 s89, s89, 0x3a800
    s_add_u32 s18, s18, 0x350000
    ds_read_b64_tr_b16 a[66:67], v117 offset:1536
    v_mfma_f32_16x16x32_bf16 v[192:195], v[172:175], a[20:23], v[192:195]
    v_lshrrev_b32 v24, 1, v12
    s_add_u32 m0, s42, 49152
    s_add_u32 s43, s43, 98304
    buffer_load_dwordx4 v131, s[48:51], s43 offen offset:0 lds
    v_mfma_f32_16x16x32_bf16 v[228:231], a[12:15], v[172:175], v[228:231]
    v_lshlrev_b32 v24, 8, v24
    v_mfma_f32_16x16x32_bf16 v[196:199], a[28:31], v[136:139], v[196:199]
    v_lshl_add_u32 v24, v11, 4, v24
    ds_read_b64_tr_b16 a[68:69], v117 offset:2048
    v_mfma_f32_16x16x32_bf16 v[176:179], v[136:139], a[32:35], v[176:179]
    ds_read_b128 v[156:159], v247 offset:0
    v_and_b32 v25, 1, v12
    v_lshl_add_u32 v5, v25, 10, v24
    s_waitcnt lgkmcnt(9)
    v_mfma_f32_16x16x32_bf16 v[200:203], a[28:31], v[140:143], v[200:203]
    ds_read_b128 v[160:163], v247 offset:4096
    buffer_load_dwordx4 v131, s[48:51], s43 offen offset:1024 lds
    ds_read_b64_tr_b16 a[70:71], v117 offset:2560
    v_mfma_f32_16x16x32_bf16 v[180:183], v[140:143], a[32:35], v[180:183]
    ds_read_b128 v[164:167], v247 offset:8192
    s_and_b32 s90, s3, 1
    v_mfma_f32_16x16x32_bf16 v[216:219], a[24:27], v[140:143], v[216:219]
    ds_read_b128 v[168:171], v247 offset:49152
    buffer_load_dwordx4 v131, s[48:51], s43 offen offset:2048 lds
    s_lshl_b32 s90, s90, 10
    s_waitcnt lgkmcnt(12)
    v_mfma_f32_16x16x32_bf16 v[204:207], a[28:31], v[144:147], v[204:207]
    ds_read_b128 v[172:175], v247 offset:53248
    s_waitcnt lgkmcnt(3)
    s_barrier
    v_mfma_f32_16x16x32_bf16 v[184:187], v[144:147], a[32:35], v[184:187]
    v_xor_b32 v115, s90, v5
    v_mfma_f32_16x16x32_bf16 v[220:223], a[24:27], v[144:147], v[220:223]
    buffer_load_dword v18, v5, s[12:15], s89 offen sc1
    s_add_u32 s23, s89, 32768
    buffer_load_dword v18, v5, s[12:15], s23 offen sc1
    s_add_u32 s23, s89, 4294879232
    buffer_load_dword v18, v5, s[12:15], s23 offen sc1
    s_lshl_b32 s90, s8, 9
    s_add_u32 s90, s90, s10
    s_add_u32 s23, s90, 4096
    s_mov_b64 exec, 15
    buffer_load_dword v18, v114, s[12:15], s23 offen sc1
    s_mov_b64 exec, -1
    s_mov_b64 exec, 0xff
    buffer_load_dword v18, v114, s[12:15], s22 offen sc1
    s_mov_b64 exec, -1
    v_mfma_f32_16x16x32_bf16 v[208:211], a[28:31], v[148:151], v[208:211]
    v_mfma_f32_16x16x32_bf16 v[188:191], v[148:151], a[32:35], v[188:191]
    v_mfma_f32_16x16x32_bf16 v[224:227], a[24:27], v[148:151], v[224:227]
    v_mfma_f32_16x16x32_bf16 v[212:215], a[28:31], v[152:155], v[212:215]
    ds_read_b64_tr_b16 a[72:73], v116 offset:0
    v_mfma_f32_16x16x32_bf16 v[192:195], v[152:155], a[32:35], v[192:195]
    ds_read_b64_tr_b16 a[74:75], v116 offset:512
    s_add_u32 m0, s42, 61440
    s_add_u32 s43, s43, 98304
    buffer_load_dwordx4 v131, s[48:51], s43 offen offset:0 lds
    v_mfma_f32_16x16x32_bf16 v[228:231], a[24:27], v[152:155], v[228:231]
    ds_read_b64_tr_b16 a[76:77], v116 offset:1024
    v_mfma_f32_16x16x32_bf16 v[196:199], a[40:43], v[156:159], v[196:199]
    ds_read_b64_tr_b16 a[78:79], v116 offset:1536
    ds_read_b128 v[136:139], v244 offset:12288
    v_mfma_f32_16x16x32_bf16 v[176:179], v[156:159], a[44:47], v[176:179]
    buffer_load_dwordx4 v131, s[48:51], s43 offen offset:1024 lds
    ds_read_b64_tr_b16 a[80:81], v116 offset:2048
    v_mfma_f32_16x16x32_bf16 v[200:203], a[40:43], v[160:163], v[200:203]
    ds_read_b128 v[140:143], v244 offset:16384
    buffer_load_dwordx4 v131, s[48:51], s43 offen offset:2048 lds
    ds_read_b128 v[144:147], v244 offset:20480
    v_mfma_f32_16x16x32_bf16 v[180:183], v[160:163], a[44:47], v[180:183]
    ds_read_b64_tr_b16 a[82:83], v116 offset:2560
    ds_read_b128 v[148:151], v244 offset:57344
    v_mfma_f32_16x16x32_bf16 v[216:219], a[36:39], v[160:163], v[216:219]
    s_waitcnt lgkmcnt(1)
    s_barrier
    v_mfma_f32_16x16x32_bf16 v[204:207], a[40:43], v[164:167], v[204:207]
    ds_read_b128 v[152:155], v244 offset:61440
    v_and_b32 v120, 31, v1
    v_mfma_f32_16x16x32_bf16 v[184:187], v[164:167], a[44:47], v[184:187]
    ds_read_b64_tr_b16 a[84:85], v116 offset:12288
    v_lshlrev_b32 v6, 10, v120
    v_mfma_f32_16x16x32_bf16 v[220:223], a[36:39], v[164:167], v[220:223]
    ds_read_b64_tr_b16 a[86:87], v116 offset:12800
    v_lshrrev_b32 v120, 5, v1
    v_mfma_f32_16x16x32_bf16 v[208:211], a[40:43], v[168:171], v[208:211]
    s_add_u32 m0, s42, 0
    s_add_u32 s43, s43, 98304
    buffer_load_dwordx4 v131, s[48:51], s43 offen offset:0 lds
    v_mfma_f32_16x16x32_bf16 v[188:191], v[168:171], a[44:47], v[188:191]
    v_lshl_add_u32 v6, v120, 4, v6
    s_lshl_b32 s96, s5, 16
    ds_read_b64_tr_b16 a[88:89], v116 offset:13312
    v_mfma_f32_16x16x32_bf16 v[224:227], a[36:39], v[168:171], v[224:227]
    s_lshl_b32 s69, s3, 14
    ds_read_b64_tr_b16 a[90:91], v116 offset:13824
    v_mfma_f32_16x16x32_bf16 v[212:215], a[40:43], v[172:175], v[212:215]
    s_add_u32 s69, s69, s96
    buffer_load_dwordx4 v131, s[48:51], s43 offen offset:1024 lds
    v_mfma_f32_16x16x32_bf16 v[192:195], v[172:175], a[44:47], v[192:195]
    s_lshl_b32 s68, s4, 7
    ds_read_b64_tr_b16 a[92:93], v116 offset:14336
    v_mfma_f32_16x16x32_bf16 v[228:231], a[36:39], v[172:175], v[228:231]
    s_add_u32 s69, s69, s68
    buffer_load_dwordx4 v131, s[48:51], s43 offen offset:2048 lds
    v_mfma_f32_16x16x32_bf16 v[196:199], a[52:55], v[136:139], v[196:199]
    s_lshl_b32 s68, s8, 5
    ds_read_b64_tr_b16 a[94:95], v116 offset:14848
    v_mfma_f32_16x16x32_bf16 v[176:179], v[136:139], a[56:59], v[176:179]
    ds_read_b128 v[156:159], v245 offset:12288
    s_add_u32 s96, s96, s68
    s_waitcnt vmcnt(19)
    s_waitcnt lgkmcnt(1)
    s_barrier
    v_mfma_f32_16x16x32_bf16 v[200:203], a[52:55], v[140:143], v[200:203]
    v_mfma_f32_16x16x32_bf16 v[180:183], v[140:143], a[56:59], v[180:183]
    ds_read_b128 v[160:163], v245 offset:16384
    ds_read_b128 v[164:167], v245 offset:20480
    v_lshlrev_b32 v124, 10, v10
    v_mfma_f32_16x16x32_bf16 v[216:219], a[48:51], v[140:143], v[216:219]
    ds_read_b128 v[168:171], v245 offset:57344
    v_xor_b32 v123, v9, v10
    v_lshl_add_u32 v124, v123, 4, v124
    v_mfma_f32_16x16x32_bf16 v[204:207], a[52:55], v[144:147], v[204:207]
    ds_read_b128 v[172:175], v245 offset:61440
    ds_read_b64_tr_b16 a[96:97], v116 offset:24576
    v_mfma_f32_16x16x32_bf16 v[184:187], v[144:147], a[56:59], v[184:187]
    s_lshl_b32 s71, s3, 11
    ds_read_b64_tr_b16 a[98:99], v116 offset:25088
    v_mfma_f32_16x16x32_bf16 v[220:223], a[48:51], v[144:147], v[220:223]
    v_lshlrev_b32 v125, 3, v12
    s_add_u32 m0, s42, 12288
    s_add_u32 s43, s43, 98304
    buffer_load_dwordx4 v131, s[48:51], s43 offen offset:0 lds
    v_mfma_f32_16x16x32_bf16 v[208:211], a[52:55], v[148:151], v[208:211]
    s_lshl_b32 s70, s9, 5
    s_sub_u32 s70, s70, s68
    v_mfma_f32_16x16x32_bf16 v[188:191], v[148:151], a[56:59], v[188:191]
    ds_read_b64_tr_b16 a[100:101], v116 offset:25600
    v_lshlrev_b32 v126, 10, v11
    v_mfma_f32_16x16x32_bf16 v[224:227], a[48:51], v[148:151], v[224:227]
    ds_read_b64_tr_b16 a[102:103], v116 offset:26112
    v_mov_b32 v127, s70
    v_mfma_f32_16x16x32_bf16 v[212:215], a[52:55], v[152:155], v[212:215]
    v_cmp_eq_u32 vcc, 2, v11
    s_nop 1
    v_cndmask_b32 v126, v126, v127, vcc
    buffer_load_dwordx4 v131, s[48:51], s43 offen offset:1024 lds
    v_mfma_f32_16x16x32_bf16 v[192:195], v[152:155], a[56:59], v[192:195]
    ds_read_b64_tr_b16 a[104:105], v116 offset:26624
    buffer_load_dwordx4 v131, s[48:51], s43 offen offset:2048 lds
    v_mfma_f32_16x16x32_bf16 v[228:231], a[48:51], v[152:155], v[228:231]
    v_add_u32 v126, v126, v125
    ds_read_b64_tr_b16 a[106:107], v116 offset:27136
    s_waitcnt lgkmcnt(10)
    v_mfma_f32_16x16x32_bf16 v[196:199], a[64:67], v[156:159], v[196:199]
    s_mov_b64 s[60:61], s[26:27]
    s_waitcnt vmcnt(18)
    s_waitcnt lgkmcnt(0)
    s_barrier
    v_mfma_f32_16x16x32_bf16 v[176:179], v[156:159], a[68:71], v[176:179]
    ds_read_b128 v[136:139], v246 offset:12288
    v_mfma_f32_16x16x32_bf16 v[200:203], a[64:67], v[160:163], v[200:203]
    ds_read_b128 v[140:143], v246 offset:16384
    s_mov_b32 s62, 0xac0
    s_mov_b32 s63, 0x20000
    v_mfma_f32_16x16x32_bf16 v[180:183], v[160:163], a[68:71], v[180:183]
    ds_read_b128 v[144:147], v246 offset:20480
    s_mov_b64 s[56:57], s[30:31]
    ds_read_b64_tr_b16 a[108:109], v116 offset:36864
    v_mfma_f32_16x16x32_bf16 v[216:219], a[60:63], v[160:163], v[216:219]
    ds_read_b128 v[148:151], v246 offset:57344
    s_mov_b32 s58, 0x400
    v_mfma_f32_16x16x32_bf16 v[204:207], a[64:67], v[164:167], v[204:207]
    ds_read_b128 v[152:155], v246 offset:61440
    ds_read_b64_tr_b16 a[110:111], v116 offset:37376
    v_mfma_f32_16x16x32_bf16 v[184:187], v[164:167], a[68:71], v[184:187]
    s_mov_b32 s59, 0x20000
    s_add_u32 m0, s42, 24576
    s_add_u32 s43, s43, 98304
    buffer_load_dwordx4 v131, s[48:51], s43 offen offset:0 lds
    v_mfma_f32_16x16x32_bf16 v[220:223], a[60:63], v[164:167], v[220:223]
    s_mov_b64 s[52:53], s[36:37]
    s_mov_b32 s54, 0x200000
    v_mfma_f32_16x16x32_bf16 v[208:211], a[64:67], v[168:171], v[208:211]
    ds_read_b64_tr_b16 a[112:113], v116 offset:37888
    s_mov_b32 s55, 0x20000
    v_mfma_f32_16x16x32_bf16 v[188:191], v[168:171], a[68:71], v[188:191]
    ds_read_b64_tr_b16 a[114:115], v116 offset:38400
    v_and_b32 v120, 3, v11
    v_mfma_f32_16x16x32_bf16 v[224:227], a[60:63], v[168:171], v[224:227]
    v_mul_u32_u24 v120, 12288, v120
    buffer_load_dwordx4 v131, s[48:51], s43 offen offset:1024 lds
    ds_read_b64_tr_b16 a[116:117], v116 offset:38912
    v_mfma_f32_16x16x32_bf16 v[212:215], a[64:67], v[172:175], v[212:215]
    v_lshrrev_b32 v121, 2, v11
    buffer_load_dwordx4 v131, s[48:51], s43 offen offset:2048 lds
    v_mfma_f32_16x16x32_bf16 v[192:195], v[172:175], a[68:71], v[192:195]
    v_lshl_add_u32 v120, v121, 11, v120
    ds_read_b64_tr_b16 a[118:119], v116 offset:39424
    v_mfma_f32_16x16x32_bf16 v[228:231], a[60:63], v[172:175], v[228:231]
    v_and_b32 v127, 1, v12
    s_waitcnt vmcnt(17)
    s_waitcnt lgkmcnt(0)
    s_barrier
    v_mfma_f32_16x16x32_bf16 v[196:199], a[76:79], v[136:139], v[196:199]
    v_lshl_add_u32 v120, v127, 4, v120
    ds_read_b128 v[156:159], v247 offset:12288
    v_mfma_f32_16x16x32_bf16 v[176:179], v[136:139], a[80:83], v[176:179]
    v_lshlrev_b32 v125, 4, v127
    v_lshrrev_b32 v127, 1, v12
    ds_read_b128 v[160:163], v247 offset:16384
    v_mfma_f32_16x16x32_bf16 v[200:203], a[76:79], v[140:143], v[200:203]
    ds_read_b64_tr_b16 a[120:121], v116 offset:49152
    ds_read_b128 v[164:167], v247 offset:20480
    v_mfma_f32_16x16x32_bf16 v[180:183], v[140:143], a[80:83], v[180:183]
    v_lshl_add_u32 v120, v127, 7, v120
    ds_read_b64_tr_b16 a[122:123], v116 offset:49664
    v_mfma_f32_16x16x32_bf16 v[216:219], a[72:75], v[140:143], v[216:219]
    ds_read_b128 v[168:171], v247 offset:57344
    v_lshl_add_u32 v125, v127, 3, v125
    ds_read_b128 v[172:175], v247 offset:61440
    v_mfma_f32_16x16x32_bf16 v[204:207], a[76:79], v[144:147], v[204:207]
    s_add_u32 m0, s42, 36864
    s_add_u32 s43, s43, 98304
    buffer_load_dwordx4 v131, s[48:51], s43 offen offset:0 lds
    v_mfma_f32_16x16x32_bf16 v[184:187], v[144:147], a[80:83], v[184:187]
    s_lshl_b32 s97, s4, 8
    s_lshl_b32 s70, s3, 5
    ds_read_b64_tr_b16 a[124:125], v116 offset:50176
    v_mfma_f32_16x16x32_bf16 v[220:223], a[72:75], v[144:147], v[220:223]
    s_add_u32 s97, s97, s70
    ds_read_b64_tr_b16 a[126:127], v116 offset:50688
    v_mfma_f32_16x16x32_bf16 v[208:211], a[76:79], v[148:151], v[208:211]
    s_add_u32 s97, s97, 0x341000
    v_mfma_f32_16x16x32_bf16 v[188:191], v[148:151], a[80:83], v[188:191]
    v_mul_u32_u24 v121, 1088, v121
    buffer_load_dwordx4 v131, s[48:51], s43 offen offset:1024 lds
    ds_read_b64_tr_b16 a[128:129], v116 offset:51200
    v_mfma_f32_16x16x32_bf16 v[224:227], a[72:75], v[148:151], v[224:227]
    v_add_u32 v121, v121, v125
    s_add_u32 s67, s68, 154560
    v_mfma_f32_16x16x32_bf16 v[212:215], a[76:79], v[152:155], v[212:215]
    buffer_load_dwordx4 v131, s[48:51], s43 offen offset:2048 lds
    ds_read_b64_tr_b16 a[130:131], v116 offset:51712
    v_mfma_f32_16x16x32_bf16 v[192:195], v[152:155], a[80:83], v[192:195]
    v_add_u32 v121, s67, v121
    s_waitcnt vmcnt(12)
    s_waitcnt lgkmcnt(0)
    s_barrier
    v_mfma_f32_16x16x32_bf16 v[228:231], a[72:75], v[152:155], v[228:231]
    v_lshlrev_b32 v127, 3, v127
    v_mfma_f32_16x16x32_bf16 v[196:199], a[88:91], v[156:159], v[196:199]
    v_and_b32 v123, 31, v1
    v_lshl_add_u32 v127, v123, 7, v127
    ds_read_b64_tr_b16 a[132:133], v117 offset:0
    v_mfma_f32_16x16x32_bf16 v[176:179], v[156:159], a[92:95], v[176:179]
    ds_read_b128 v[136:139], v244 offset:24576
    v_lshlrev_b32 v123, 4, v9
    v_mfma_f32_16x16x32_bf16 v[200:203], a[88:91], v[160:163], v[200:203]
    ds_read_b128 v[140:143], v244 offset:28672
    ds_read_b64_tr_b16 a[134:135], v117 offset:512
    v_mfma_f32_16x16x32_bf16 v[180:183], v[160:163], a[92:95], v[180:183]
    ds_read_b128 v[144:147], v244 offset:32768
    v_xor_b32 v123, s70, v123
    ds_read_b64_tr_b16 a[136:137], v117 offset:1024
    v_mfma_f32_16x16x32_bf16 v[216:219], a[84:87], v[160:163], v[216:219]
    v_add_u32 v127, v127, v123
    v_add_u32 v127, 147456, v127
    v_mfma_f32_16x16x32_bf16 v[204:207], a[88:91], v[164:167], v[204:207]
    buffer_load_dword v113, v15, s[12:15], s18 offen sc1
    ds_read_b64_tr_b16 a[138:139], v117 offset:1536
    v_mfma_f32_16x16x32_bf16 v[184:187], v[164:167], a[92:95], v[184:187]
    s_mov_b32 exec_lo, 0x70007
    s_mov_b32 exec_hi, exec_lo
    buffer_load_dwordx2 v[110:111], v126, s[60:63], s68 offen
    s_mov_b64 exec, -1
    s_mov_b32 exec_lo, 0x80008
    s_mov_b32 exec_hi, exec_lo
    buffer_load_dwordx2 v[110:111], v125, s[56:59], s68 offen
    s_mov_b64 exec, -1
    s_mov_b32 exec_lo, 0xf00ff00f
    s_mov_b32 exec_hi, exec_lo
    buffer_load_dwordx4 v[100:103], v120, s[12:15], s97 offen sc1
    s_mov_b64 exec, -1
    v_mfma_f32_16x16x32_bf16 v[220:223], a[84:87], v[164:167], v[220:223]
    v_mfma_f32_16x16x32_bf16 v[208:211], a[88:91], v[168:171], v[208:211]
    v_mfma_f32_16x16x32_bf16 v[188:191], v[168:171], a[92:95], v[188:191]
    ds_read_b64_tr_b16 a[140:141], v117 offset:2048
    v_mfma_f32_16x16x32_bf16 v[224:227], a[84:87], v[168:171], v[224:227]
    ds_read_b64_tr_b16 a[142:143], v117 offset:2560
    v_mfma_f32_16x16x32_bf16 v[212:215], a[88:91], v[172:175], v[212:215]
    s_waitcnt vmcnt(13)
    s_waitcnt lgkmcnt(0)
    s_barrier
    v_mfma_f32_16x16x32_bf16 v[192:195], v[172:175], a[92:95], v[192:195]
    ds_read_b64_tr_b16 a[144:145], v116 offset:0
    v_mfma_f32_16x16x32_bf16 v[228:231], a[84:87], v[172:175], v[228:231]
    ds_read_b64_tr_b16 a[146:147], v116 offset:512
    ds_read_b64_tr_b16 a[148:149], v116 offset:1024
    v_mfma_f32_16x16x32_bf16 v[196:199], a[100:103], v[136:139], v[196:199]
    ds_read_b64_tr_b16 a[150:151], v116 offset:1536
    ds_read_b128 v[156:159], v245 offset:24576
    v_mfma_f32_16x16x32_bf16 v[176:179], v[136:139], a[104:107], v[176:179]
    ds_read_b64_tr_b16 a[152:153], v116 offset:2048
    ds_read_b128 v[160:163], v245 offset:28672
    v_mfma_f32_16x16x32_bf16 v[200:203], a[100:103], v[140:143], v[200:203]
    v_mov_b32 v27, 0xf149f2ca
    ds_read_b128 v[164:167], v245 offset:32768
    ds_read_b64_tr_b16 a[154:155], v116 offset:2560
    v_mfma_f32_16x16x32_bf16 v[180:183], v[140:143], a[104:107], v[180:183]
    v_and_b32 v24, 1, v11
    s_waitcnt vmcnt(10)
    s_waitcnt lgkmcnt(0)
    s_barrier
    v_mfma_f32_16x16x32_bf16 v[216:219], a[96:99], v[140:143], v[216:219]
    v_mfma_f32_16x16x32_bf16 v[204:207], a[100:103], v[144:147], v[204:207]
    v_lshlrev_b32 v25, 4, v24
    v_mov_b32 v26, 0xffff
    ds_read_b64_tr_b16 a[156:157], v116 offset:12288
    v_mfma_f32_16x16x32_bf16 v[184:187], v[144:147], a[104:107], v[184:187]
    v_lshlrev_b32 v25, v25, v26
    v_lshl_add_u32 v26, v12, 2, v24
    v_mfma_f32_16x16x32_bf16 v[220:223], a[96:99], v[144:147], v[220:223]
    ds_read_b64_tr_b16 a[158:159], v116 offset:12800
    v_mfma_f32_16x16x32_bf16 v[196:199], a[112:115], v[156:159], v[196:199]
    v_cmp_le_u32 vcc, v26, v11
    s_nop 1
    v_cndmask_b32 v234, 0, v25, vcc
    ds_read_b128 v[136:139], v246 offset:24576
    v_mfma_f32_16x16x32_bf16 v[176:179], v[156:159], a[116:119], v[176:179]
    ds_read_b64_tr_b16 a[160:161], v116 offset:13312
    ds_read_b128 v[140:143], v246 offset:28672
    v_mfma_f32_16x16x32_bf16 v[200:203], a[112:115], v[160:163], v[200:203]
    ds_read_b64_tr_b16 a[162:163], v116 offset:13824
    ds_read_b128 v[144:147], v246 offset:32768
    v_mfma_f32_16x16x32_bf16 v[180:183], v[160:163], a[116:119], v[180:183]
    v_xor_b32 v232, v234, v25
    ds_read_b64_tr_b16 a[164:165], v116 offset:14336
    v_mfma_f32_16x16x32_bf16 v[216:219], a[108:111], v[160:163], v[216:219]
    v_add_u32 v26, 2, v26
    v_cmp_le_u32 vcc, v26, v11
    s_nop 1
    v_cndmask_b32 v235, 0, v25, vcc
    v_mfma_f32_16x16x32_bf16 v[204:207], a[112:115], v[164:167], v[204:207]
    ds_read_b64_tr_b16 a[166:167], v116 offset:14848
    s_waitcnt vmcnt(3)
    v_cmp_ne_u32 vcc, s6, v113
    s_nop 0
    s_cbranch_vccnz retry_12
ready_13:
    v_mfma_f32_16x16x32_bf16 v[184:187], v[164:167], a[116:119], v[184:187]
    v_xor_b32 v233, v235, v25
    s_waitcnt lgkmcnt(0)
    s_barrier
    v_mfma_f32_16x16x32_bf16 v[220:223], a[108:111], v[164:167], v[220:223]
    v_mfma_f32_16x16x32_bf16 v[196:199], a[124:127], v[136:139], v[196:199]
    v_bfe_i32 v236, v232, 0, 1
    v_bfi_b32 v236, v236, 0, v27
    ds_read_b128 v[156:159], v247 offset:24576
    v_mfma_f32_16x16x32_bf16 v[176:179], v[136:139], a[128:131], v[176:179]
    v_bfe_i32 v240, v234, 0, 1
    ds_read_b64_tr_b16 a[168:169], v116 offset:24576
    v_mfma_f32_16x16x32_bf16 v[200:203], a[124:127], v[140:143], v[200:203]
    ds_read_b128 v[160:163], v247 offset:28672
    v_bfi_b32 v240, v240, 0, v27
    ds_read_b128 v[164:167], v247 offset:32768
    v_mfma_f32_16x16x32_bf16 v[180:183], v[140:143], a[128:131], v[180:183]
    ds_read_b64_tr_b16 a[170:171], v116 offset:25088
    v_bfe_i32 v237, v232, 16, 1
    v_mfma_f32_16x16x32_bf16 v[216:219], a[120:123], v[140:143], v[216:219]
    ds_read_b64_tr_b16 a[172:173], v116 offset:25600
    v_bfi_b32 v237, v237, 0, v27
    v_mfma_f32_16x16x32_bf16 v[204:207], a[124:127], v[144:147], v[204:207]
    s_or_b32 s19, s2, s3
    s_cselect_b32 s19, 0x40000000, 0x352000
    s_mov_b64 exec, 1
    buffer_store_dword v2, v4, s[12:15], s19 offen sc1
    s_mov_b64 exec, -1
    v_mfma_f32_16x16x32_bf16 v[184:187], v[144:147], a[128:131], v[184:187]
    v_bfe_i32 v241, v234, 16, 1
    v_mfma_f32_16x16x32_bf16 v[220:223], a[120:123], v[144:147], v[220:223]
    v_bfi_b32 v241, v241, 0, v27
    v_bfe_i32 v238, v233, 0, 1
    s_waitcnt lgkmcnt(5)
    v_mfma_f32_16x16x32_bf16 v[196:199], a[136:139], v[156:159], v[196:199]
    ds_read_b64_tr_b16 a[174:175], v116 offset:26112
    v_bfi_b32 v238, v238, 0, v27
    v_mfma_f32_16x16x32_bf16 v[176:179], v[156:159], a[140:143], v[176:179]
    ds_read_b128 v[136:139], v244 offset:36864
    v_bfe_i32 v242, v235, 0, 1
    ds_read_b64_tr_b16 a[176:177], v116 offset:26624
    s_waitcnt lgkmcnt(6)
    v_mfma_f32_16x16x32_bf16 v[200:203], a[136:139], v[160:163], v[200:203]
    ds_read_b128 v[140:143], v244 offset:40960
    v_bfi_b32 v242, v242, 0, v27
    ds_read_b128 v[144:147], v244 offset:45056
    v_mfma_f32_16x16x32_bf16 v[180:183], v[160:163], a[140:143], v[180:183]
    ds_read_b64_tr_b16 a[178:179], v116 offset:27136
    v_bfe_i32 v239, v233, 16, 1
    buffer_load_dwordx4 a[192:195], v115, s[12:15], s81 offen sc1
    s_add_u32 s81, s81, 32768
    v_mfma_f32_16x16x32_bf16 v[216:219], a[132:135], v[160:163], v[216:219]
    v_bfi_b32 v239, v239, 0, v27
    s_waitcnt lgkmcnt(0)
    s_barrier
    v_mfma_f32_16x16x32_bf16 v[204:207], a[136:139], v[164:167], v[204:207]
    v_bfe_i32 v243, v235, 16, 1
    v_mfma_f32_16x16x32_bf16 v[184:187], v[164:167], a[140:143], v[184:187]
    v_bfi_b32 v243, v243, 0, v27
    ds_read_b64_tr_b16 a[180:181], v116 offset:36864
    buffer_load_dwordx4 a[196:199], v115, s[12:15], s81 offen sc1
    s_add_u32 s81, s81, 32768
    v_mfma_f32_16x16x32_bf16 v[220:223], a[132:135], v[164:167], v[220:223]
    s_cmp_eq_u32 s5, 0
    s_cselect_b32 s91, 0xf149f2ca, 0
    v_mfma_f32_16x16x32_bf16 v[196:199], a[148:151], v[136:139], v[196:199]
    ds_read_b64_tr_b16 a[182:183], v116 offset:37376
    ds_read_b64_tr_b16 a[184:185], v116 offset:37888
    v_mfma_f32_16x16x32_bf16 v[176:179], v[136:139], a[152:155], v[176:179]
    ds_read_b128 v[156:159], v245 offset:36864
    v_mov_b32 v248, v7
    buffer_load_dwordx4 a[200:203], v115, s[12:15], s81 offen sc1
    s_add_u32 s81, s81, 32768
    v_mfma_f32_16x16x32_bf16 v[200:203], a[148:151], v[140:143], v[200:203]
    ds_read_b128 v[160:163], v245 offset:40960
    v_mov_b32 v249, v7
    v_mfma_f32_16x16x32_bf16 v[180:183], v[140:143], a[152:155], v[180:183]
    ds_read_b64_tr_b16 a[186:187], v116 offset:38400
    ds_read_b128 v[164:167], v245 offset:45056
    v_mov_b32 v250, v7
    v_mfma_f32_16x16x32_bf16 v[216:219], a[144:147], v[140:143], v[216:219]
    ds_read_b64_tr_b16 a[188:189], v116 offset:38912
    buffer_load_dwordx4 a[204:207], v115, s[12:15], s81 offen sc1
    s_add_u32 s81, s81, 32768
    v_mfma_f32_16x16x32_bf16 v[204:207], a[148:151], v[144:147], v[204:207]
    v_mov_b32 v251, v7
    ds_read_b64_tr_b16 a[190:191], v116 offset:39424
    v_mfma_f32_16x16x32_bf16 v[184:187], v[144:147], a[152:155], v[184:187]
    s_mov_b32 s88, 0x3eb8aa3b
    s_add_u32 m0, s71, 147456
    s_nop 0
    buffer_load_dwordx4 v124, s[44:47], s69 offen lds
    s_add_u32 s69, s69, 8192
    v_mfma_f32_16x16x32_bf16 v[220:223], a[144:147], v[144:147], v[220:223]
    s_mul_i32 s84, s3, 512
    s_add_u32 s84, s84, 0x341800
    s_add_u32 s85, s84, 12288
    s_waitcnt lgkmcnt(5)
    v_mfma_f32_16x16x32_bf16 v[196:199], a[160:163], v[156:159], v[196:199]
    s_add_u32 s86, s84, 24576
    ds_read_b128 v[136:139], v246 offset:36864
    v_mfma_f32_16x16x32_bf16 v[176:179], v[156:159], a[164:167], v[176:179]
    s_add_u32 s87, s84, 36864
    ds_read_b128 v[140:143], v246 offset:40960
    s_waitcnt lgkmcnt(6)
    v_mfma_f32_16x16x32_bf16 v[200:203], a[160:163], v[160:163], v[200:203]
    buffer_load_dwordx4 v[84:87], v128, s[12:15], s84 offen sc1
    s_add_u32 m0, s71, 148480
    s_nop 0
    buffer_load_dwordx4 v124, s[44:47], s69 offen lds
    v_mfma_f32_16x16x32_bf16 v[180:183], v[160:163], a[164:167], v[180:183]
    ds_read_b128 v[144:147], v246 offset:45056
    v_mfma_f32_16x16x32_bf16 v[216:219], a[156:159], v[160:163], v[216:219]
    buffer_load_dwordx4 v[88:91], v128, s[12:15], s85 offen sc1
    buffer_load_dwordx4 v[92:95], v128, s[12:15], s86 offen sc1
    s_waitcnt lgkmcnt(5)
    v_mfma_f32_16x16x32_bf16 v[204:207], a[160:163], v[164:167], v[204:207]
    buffer_load_dwordx4 v[96:99], v128, s[12:15], s87 offen sc1
    v_mfma_f32_16x16x32_bf16 v[184:187], v[164:167], a[164:167], v[184:187]
    v_mfma_f32_16x16x32_bf16 v[220:223], a[156:159], v[164:167], v[220:223]
    s_waitcnt lgkmcnt(2)
    v_mfma_f32_16x16x32_bf16 v[196:199], a[172:175], v[136:139], v[196:199]
    ds_read_b128 v[156:159], v247 offset:36864
    ds_read_b128 v[160:163], v247 offset:40960
    v_mfma_f32_16x16x32_bf16 v[176:179], v[136:139], a[176:179], v[176:179]
    ds_read_b128 v[164:167], v247 offset:45056
    buffer_load_dwordx4 a[208:211], v115, s[12:15], s81 offen sc1
    s_add_u32 s81, s81, 32768
    s_waitcnt lgkmcnt(4)
    v_mfma_f32_16x16x32_bf16 v[200:203], a[172:175], v[140:143], v[200:203]
    v_mfma_f32_16x16x32_bf16 v[180:183], v[140:143], a[176:179], v[180:183]
    v_mfma_f32_16x16x32_bf16 v[216:219], a[168:171], v[140:143], v[216:219]
    s_waitcnt lgkmcnt(3)
    v_mfma_f32_16x16x32_bf16 v[204:207], a[172:175], v[144:147], v[204:207]
    v_mfma_f32_16x16x32_bf16 v[184:187], v[144:147], a[176:179], v[184:187]
    v_mfma_f32_16x16x32_bf16 v[220:223], a[168:171], v[144:147], v[220:223]
    s_cmp_lg_u64 s[82:83], 0
    s_cbranch_scc1 L_slow
    s_waitcnt lgkmcnt(2)
    v_mfma_f32_16x16x32_bf16 v[196:199], a[184:187], v[156:159], v[196:199]
    v_add_u32 v244, 49152, v244
    v_add_u32 v245, 49152, v245
    v_mfma_f32_16x16x32_bf16 v[176:179], v[156:159], a[188:191], v[176:179]
    buffer_load_dwordx4 a[212:215], v115, s[12:15], s81 offen sc1
    s_add_u32 s81, s81, 32768
    s_waitcnt lgkmcnt(1)
    v_mfma_f32_16x16x32_bf16 v[200:203], a[184:187], v[160:163], v[200:203]
    v_add_u32 v246, 49152, v246
    v_add_u32 v247, 49152, v247
    v_mfma_f32_16x16x32_bf16 v[180:183], v[160:163], a[188:191], v[180:183]
    ds_read_b128 v[148:151], v244 offset:16384
    ds_read_b128 v[152:155], v244 offset:20480
    v_mfma_f32_16x16x32_bf16 v[216:219], a[180:183], v[160:163], v[216:219]
    s_getpc_b64 s[40:41]
L_pf2:
    v_min_u32 v19, pf_last2, v0
    global_load_dword v18, v19, s[40:41]
    s_waitcnt lgkmcnt(2)
    v_mfma_f32_16x16x32_bf16 v[204:207], a[184:187], v[164:167], v[204:207]
    v_cvt_pk_bf16_f32 v136, v196, v197
    v_mfma_f32_16x16x32_bf16 v[184:187], v[164:167], a[188:191], v[184:187]
    v_mfma_f32_16x16x32_bf16 v[220:223], a[180:183], v[164:167], v[220:223]
    s_waitcnt lgkmcnt(1)
    v_mfma_f32_16x16x32_bf16 v[208:211], a[100:103], v[148:151], v[208:211]
    v_cvt_pk_bf16_f32 v137, v198, v199
    v_cvt_pk_bf16_f32 v138, v200, v201
    v_mfma_f32_16x16x32_bf16 v[188:191], v[148:151], a[104:107], v[188:191]
    ds_read_b128 v[168:171], v245 offset:16384
    v_cvt_pk_bf16_f32 v139, v202, v203
    v_mfma_f32_16x16x32_bf16 v[224:227], a[96:99], v[148:151], v[224:227]
    v_cvt_pk_bf16_f32 v140, v204, v205
    ds_read_b128 v[172:175], v245 offset:20480
    s_waitcnt lgkmcnt(2)
    v_mfma_f32_16x16x32_bf16 v[212:215], a[100:103], v[152:155], v[212:215]
    v_cvt_pk_bf16_f32 v141, v206, v207
    v_cvt_pk_bf16_f32 v20, v216, v217
    v_mfma_f32_16x16x32_bf16 v[192:195], v[152:155], a[104:107], v[192:195]
    buffer_load_dwordx4 a[216:219], v115, s[12:15], s81 offen sc1
    s_add_u32 s81, s81, 32768
    v_cvt_pk_bf16_f32 v21, v218, v219
    s_nop 1
    v_mfma_f32_16x16x16_bf16 v[196:199], v[136:137], v[20:21], v[236:239]
    v_cvt_pk_bf16_f32 v22, v220, v221
    v_mfma_f32_16x16x32_bf16 v[228:231], a[96:99], v[152:155], v[228:231]
    v_cvt_pk_bf16_f32 v23, v222, v223
    buffer_load_dwordx4 a[220:223], v115, s[12:15], s81 offen sc1
    s_add_u32 s81, s81, 32768
    v_mfma_f32_16x16x16_bf16 v[200:203], v[138:139], v[20:21], v[240:243]
    s_waitcnt lgkmcnt(1)
    v_mfma_f32_16x16x32_bf16 v[208:211], a[112:115], v[168:171], v[208:211]
    ds_read_b128 v[148:151], v246 offset:16384
    buffer_load_dwordx4 a[224:227], v115, s[12:15], s81 offen sc1
    s_add_u32 s81, s81, 32768
    v_mfma_f32_16x16x32_bf16 v[188:191], v[168:171], a[116:119], v[188:191]
    ds_read_b128 v[152:155], v246 offset:20480
    v_mfma_f32_16x16x16_bf16 v[204:207], v[138:139], v[22:23], v[236:239]
    buffer_load_dwordx4 a[228:231], v115, s[12:15], s81 offen sc1
    s_add_u32 s81, s81, 32768
    v_mfma_f32_16x16x32_bf16 v[224:227], a[108:111], v[168:171], v[224:227]
    v_cvt_pk_bf16_f32 v156, v176, v177
    v_cvt_pk_bf16_f32 v157, v178, v179
    v_mfma_f32_16x16x16_bf16 v[216:219], v[140:141], v[22:23], v[240:243]
    v_cvt_pk_bf16_f32 v158, v180, v181
    v_cvt_pk_bf16_f32 v159, v182, v183
    s_waitcnt lgkmcnt(2)
    v_mfma_f32_16x16x32_bf16 v[212:215], a[112:115], v[172:175], v[212:215]
    v_mfma_f32_16x16x32_bf16 v[192:195], v[172:175], a[116:119], v[192:195]
    v_mfma_f32_16x16x32_bf16 v[228:231], a[108:111], v[172:175], v[228:231]
    s_waitcnt lgkmcnt(1)
    v_mfma_f32_16x16x32_bf16 v[208:211], a[124:127], v[148:151], v[208:211]
    v_cvt_pk_bf16_f32 v160, v184, v185
    v_cvt_pk_bf16_f32 v161, v186, v187
    v_add_f32 v196, s91, v196
    v_mfma_f32_16x16x32_bf16 v[188:191], v[148:151], a[128:131], v[188:191]
    ds_read_b128 v[168:171], v247 offset:16384
    v_add_f32 v197, s91, v197
    v_add_f32 v198, s91, v198
    v_mfma_f32_16x16x32_bf16 v[224:227], a[120:123], v[148:151], v[224:227]
    ds_read_b128 v[172:175], v247 offset:20480
    buffer_load_dwordx4 a[232:235], v115, s[12:15], s81 offen sc1
    s_add_u32 s81, s81, 32768
    s_waitcnt lgkmcnt(2)
    v_mfma_f32_16x16x32_bf16 v[212:215], a[124:127], v[152:155], v[212:215]
    v_add_f32 v199, s91, v199
    v_max3_f32 v24, v196, v197, v200
    v_max3_f32 v25, v198, v199, v202
    v_mfma_f32_16x16x32_bf16 v[192:195], v[152:155], a[128:131], v[192:195]
    v_max_f32 v24, v24, v201
    v_max_f32 v25, v25, v203
    v_max_f32 v32, v24, v25
    v_mfma_f32_16x16x32_bf16 v[228:231], a[120:123], v[152:155], v[228:231]
    v_max3_f32 v26, v204, v205, v216
    v_max3_f32 v27, v206, v207, v218
    v_max_f32 v26, v26, v217
    v_max_f32 v27, v27, v219
    s_waitcnt lgkmcnt(1)
    v_mfma_f32_16x16x32_bf16 v[208:211], a[136:139], v[168:171], v[208:211]
    buffer_load_dwordx4 a[236:239], v115, s[12:15], s81 offen sc1
    s_add_u32 s81, s81, 32768
    v_max_f32 v33, v26, v27
    v_mfma_f32_16x16x32_bf16 v[188:191], v[168:171], a[140:143], v[188:191]
    s_nop 0
    v_permlane32_swap_b32 v32, v33
    ds_read_b128 v[148:151], v244 offset:24576
    v_max_f32 v32, v32, v33
    v_mfma_f32_16x16x32_bf16 v[224:227], a[132:135], v[168:171], v[224:227]
    v_mov_b32 v33, v32
    ds_read_b128 v[152:155], v244 offset:28672
    s_nop 0
    v_permlane16_swap_b32 v32, v33
    s_waitcnt lgkmcnt(2)
    v_mfma_f32_16x16x32_bf16 v[212:215], a[136:139], v[172:175], v[212:215]
    v_max_f32 v32, v32, v33
    v_mul_f32 v32, s88, v32
    v_mov_b32 v33, v32
    v_mfma_f32_16x16x32_bf16 v[192:195], v[172:175], a[140:143], v[192:195]
    buffer_load_dwordx4 a[240:243], v115, s[12:15], s81 offen sc1
    s_add_u32 s81, s81, 32768
    v_permlane32_swap_b32 v32, v33
    v_mfma_f32_16x16x32_bf16 v[228:231], a[132:135], v[172:175], v[228:231]
    v_fma_f32 v24, v24, s88, -v32
    v_fma_f32 v25, v25, s88, -v32
    v_fma_f32 v26, v26, s88, -v33
    s_waitcnt lgkmcnt(1)
    v_mfma_f32_16x16x32_bf16 v[208:211], a[148:151], v[148:151], v[208:211]
    v_fma_f32 v27, v27, s88, -v33
    v_exp_f32 v24, v24
    v_mfma_f32_16x16x32_bf16 v[188:191], v[148:151], a[152:155], v[188:191]
    ds_read_b128 v[168:171], v245 offset:24576
    v_exp_f32 v25, v25
    v_mfma_f32_16x16x32_bf16 v[224:227], a[144:147], v[148:151], v[224:227]
    ds_read_b128 v[172:175], v245 offset:28672
    buffer_load_dwordx4 a[244:247], v115, s[12:15], s81 offen sc1
    s_add_u32 s81, s81, 32768
    s_waitcnt lgkmcnt(2)
    v_mfma_f32_16x16x32_bf16 v[212:215], a[148:151], v[152:155], v[212:215]
    v_exp_f32 v26, v26
    v_exp_f32 v27, v27
    v_mfma_f32_16x16x32_bf16 v[192:195], v[152:155], a[152:155], v[192:195]
    v_cvt_pk_bf16_f32 v24, v24, v24
    v_cvt_pk_bf16_f32 v25, v25, v25
    v_cvt_pk_bf16_f32 v26, v26, v26
    v_mfma_f32_16x16x32_bf16 v[228:231], a[144:147], v[152:155], v[228:231]
    v_cvt_pk_bf16_f32 v27, v27, v27
    v_and_b32 v176, v24, v232
    v_and_b32 v178, v24, v234
    s_waitcnt lgkmcnt(1)
    v_mfma_f32_16x16x32_bf16 v[208:211], a[160:163], v[168:171], v[208:211]
    buffer_load_dwordx4 a[248:251], v115, s[12:15], s81 offen sc1
    s_add_u32 s81, s81, 32768
    v_mfma_f32_16x16x32_bf16 v[188:191], v[168:171], a[164:167], v[188:191]
    v_and_b32 v177, v25, v233
    v_and_b32 v179, v25, v235
    v_mfma_f32_16x16x32_bf16 v[224:227], a[156:159], v[168:171], v[224:227]
    ds_read_b128 v[148:151], v246 offset:24576
    v_and_b32 v180, v26, v232
    v_mfma_f32_16x16x32_bf16 v[200:203], v[248:251], v[176:179], 0
    v_and_b32 v182, v26, v234
    v_and_b32 v181, v27, v233
    s_waitcnt lgkmcnt(1)
    v_mfma_f32_16x16x32_bf16 v[212:215], a[160:163], v[172:175], v[212:215]
    ds_read_b128 v[152:155], v246 offset:28672
    v_and_b32 v183, v27, v235
    v_mfma_f32_16x16x32_bf16 v[192:195], v[172:175], a[164:167], v[192:195]
    buffer_load_dwordx4 a[252:255], v115, s[12:15], s81 offen sc1
    s_add_u32 s81, s81, 32768
    v_mfma_f32_16x16x32_bf16 v[216:219], v[248:251], v[180:183], 0
    v_mfma_f32_16x16x32_bf16 v[228:231], a[156:159], v[172:175], v[228:231]
    v_mfma_f32_16x16x32_bf16 v[196:199], v[156:159], v[176:179], 0
    s_waitcnt lgkmcnt(1)
    v_mfma_f32_16x16x32_bf16 v[208:211], a[172:175], v[148:151], v[208:211]
    ds_read_b128 v[168:171], v247 offset:24576
    buffer_load_dwordx4 v[36:39], v15, s[12:15], s92 offen sc1
    v_mfma_f32_16x16x32_bf16 v[188:191], v[148:151], a[176:179], v[188:191]
    ds_read_b128 v[172:175], v247 offset:28672
    v_rcp_f32 v32, v200
    v_mfma_f32_16x16x32_bf16 v[204:207], v[158:161], v[180:183], 0
    v_rcp_f32 v33, v216
    v_mfma_f32_16x16x32_bf16 v[224:227], a[168:171], v[148:151], v[224:227]
    v_mul_f32 v196, v196, v32
    s_waitcnt lgkmcnt(2)
    v_mfma_f32_16x16x32_bf16 v[212:215], a[172:175], v[152:155], v[212:215]
    buffer_load_dwordx4 v[40:43], v252, s[12:15], s92 offen sc1
    v_mul_f32 v197, v197, v32
    v_mfma_f32_16x16x32_bf16 v[192:195], v[152:155], a[176:179], v[192:195]
    v_mul_f32 v198, v198, v32
    v_mul_f32 v199, v199, v32
    v_mfma_f32_16x16x32_bf16 v[228:231], a[168:171], v[152:155], v[228:231]
    s_waitcnt lgkmcnt(1)
    v_mfma_f32_16x16x32_bf16 v[208:211], a[184:187], v[168:171], v[208:211]
    v_mul_f32 v204, v204, v33
    v_mul_f32 v205, v205, v33
    v_mul_f32 v206, v206, v33
    v_mul_f32_e64 v207, v207, v33
    v_cvt_pk_bf16_f32 v28, v196, v197
    v_cvt_pk_bf16_f32 v30, v204, v205
    v_cvt_pk_bf16_f32 v29, v198, v199
    buffer_load_dwordx4 v[44:47], v253, s[12:15], s92 offen sc1
    s_add_u32 s92, s92, 90112
    v_cvt_pk_bf16_f32 v31, v206, v207
    v_permlane16_swap_b32 v28, v30
    s_nop 0
    v_permlane16_swap_b32 v29, v31
    buffer_store_dwordx4 v[28:31], v5, s[12:15], s89 offen nt
    v_mfma_f32_16x16x32_bf16 v[188:191], v[168:171], a[188:191], v[188:191]
    s_add_u32 s89, s89, 32768
    v_cvt_pk_bf16_f32 v142, v208, v209
    v_cvt_pk_bf16_f32 v143, v210, v211
    v_mfma_f32_16x16x32_bf16 v[224:227], a[180:183], v[168:171], v[224:227]
    s_waitcnt lgkmcnt(0)
    v_mfma_f32_16x16x32_bf16 v[212:215], a[184:187], v[172:175], v[212:215]
    s_nop 7
    v_cvt_pk_bf16_f32 v144, v212, v213
    v_cvt_pk_bf16_f32 v145, v214, v215
    v_cvt_pk_bf16_f32 v20, v224, v225
    v_cvt_pk_bf16_f32 v21, v226, v227
    v_mfma_f32_16x16x32_bf16 v[192:195], v[172:175], a[188:191], v[192:195]
    v_mfma_f32_16x16x32_bf16 v[228:231], a[180:183], v[172:175], v[228:231]
    s_nop 7
    v_cvt_pk_bf16_f32 v22, v228, v229
    v_cvt_pk_bf16_f32 v23, v230, v231
    s_waitcnt vmcnt(21)
    v_xor_b32 v84, s72, v84
    v_xor_b32 v85, s73, v85
    v_xor_b32 v86, s74, v86
    v_xor_b32 v87, s75, v87
    s_waitcnt vmcnt(19)
    v_xor_b32 v88, s72, v88
    v_xor_b32 v89, s73, v89
    v_xor_b32 v90, s74, v90
    v_xor_b32 v91, s75, v91
    s_waitcnt vmcnt(18)
    v_xor_b32 v92, s72, v92
    v_xor_b32 v93, s73, v93
    v_xor_b32 v94, s74, v94
    v_xor_b32 v95, s75, v95
    s_waitcnt vmcnt(17)
    v_xor_b32 v96, s72, v96
    v_xor_b32 v97, s73, v97
    v_xor_b32 v98, s74, v98
    v_xor_b32 v99, s75, v99
    v_or3_b32 v150, v84, v85, v86
    v_or3_b32 v151, v87, v88, v89
    v_or3_b32 v152, v90, v91, v92
    v_or3_b32 v153, v93, v94, v95
    v_or3_b32 v154, v96, v97, v98
    v_or3_b32 v150, v150, v151, v152
    v_or3_b32 v153, v153, v154, v99
    v_or_b32 v150, v150, v153
    v_and_b32 v150, 0xff, v150
    v_cmp_ne_u32 vcc, 0, v150
    s_nop 0
    s_cbranch_vccnz retry_10
ready_11:
    v_mfma_f32_16x16x16_bf16 v[196:199], v[140:141], v[20:21], v[236:239]
    buffer_load_dwordx4 v[48:51], v15, s[12:15], s92 offen sc1
    v_cvt_pk_bf16_f32 v162, v188, v189
    v_mfma_f32_16x16x16_bf16 v[200:203], v[142:143], v[20:21], v[240:243]
    v_cvt_pk_bf16_f32 v163, v190, v191
    v_cvt_pk_bf16_f32 v164, v192, v193
    v_cvt_pk_bf16_f32 v165, v194, v195
    s_nop 4
    v_max3_f32 v24, v196, v197, v200
    v_max3_f32 v25, v198, v199, v202
    v_max_f32 v24, v24, v201
    v_max_f32 v25, v25, v203
    v_max_f32 v32, v24, v25
    v_mfma_f32_16x16x16_bf16 v[204:207], v[142:143], v[22:23], v[236:239]
    v_mfma_f32_16x16x16_bf16 v[216:219], v[144:145], v[22:23], v[240:243]
    s_nop 7
    v_max3_f32 v26, v204, v205, v216
    v_max3_f32 v27, v206, v207, v218
    v_max_f32 v26, v26, v217
    v_max_f32 v27, v27, v219
    v_max_f32 v33, v26, v27
    s_nop 1
    v_permlane32_swap_b32 v32, v33
    buffer_load_dwordx4 v[52:55], v252, s[12:15], s92 offen sc1
    v_max_f32 v32, v32, v33
    v_mov_b32 v33, v32
    s_nop 1
    v_permlane16_swap_b32 v32, v33
    v_max_f32 v32, v32, v33
    v_mul_f32 v32, s88, v32
    v_mov_b32 v33, v32
    s_nop 1
    v_permlane32_swap_b32 v32, v33
    v_add_f32 v84, v84, v88
    v_fma_f32 v24, v24, s88, -v32
    v_fma_f32 v25, v25, s88, -v32
    v_add_f32 v85, v85, v89
    v_fma_f32 v26, v26, s88, -v33
    v_add_f32 v86, v86, v90
    buffer_load_dwordx4 v[56:59], v253, s[12:15], s92 offen sc1
    s_add_u32 s92, s92, 90112
    v_fma_f32 v27, v27, s88, -v33
    v_exp_f32 v24, v24
    v_add_f32 v87, v87, v91
    v_add_f32 v92, v92, v96
    v_exp_f32 v25, v25
    v_add_f32 v93, v93, v97
    v_exp_f32 v26, v26
    v_add_f32 v94, v94, v98
    s_waitcnt vmcnt(3)
    s_mov_b64 exec, 1
    buffer_store_dword v2, v4, s[12:15], s17 offen nt
    s_mov_b64 exec, -1
    s_add_u32 s17, s17, 128
    v_exp_f32 v27, v27
    v_add_f32 v95, v95, v99
    v_cvt_pk_bf16_f32 v24, v24, v24
    v_cvt_pk_bf16_f32 v25, v25, v25
    v_add_f32 v84, v84, v92
    v_cvt_pk_bf16_f32 v26, v26, v26
    v_cvt_pk_bf16_f32 v27, v27, v27
    v_add_f32 v85, v85, v93
    v_and_b32 v176, v24, v232
    v_and_b32 v178, v24, v234
    v_add_f32 v86, v86, v94
    v_and_b32 v177, v25, v233
    buffer_load_dwordx4 v[60:63], v15, s[12:15], s92 offen sc1
    v_add_f32 v87, v87, v95
    v_and_b32 v179, v25, v235
    s_nop 1
    v_mfma_f32_16x16x32_bf16 v[200:203], v[248:251], v[176:179], 0
    v_and_b32 v180, v26, v232
    v_cvt_pk_bf16_f32 v88, v84, v85
    v_and_b32 v182, v26, v234
    v_and_b32 v181, v27, v233
    v_cvt_pk_bf16_f32 v89, v86, v87
    v_and_b32 v183, v27, v235
    s_nop 1
    v_mfma_f32_16x16x32_bf16 v[216:219], v[248:251], v[180:183], 0
    v_mfma_f32_16x16x32_bf16 v[196:199], v[160:163], v[176:179], 0
    v_mfma_f32_16x16x32_bf16 v[204:207], v[162:165], v[180:183], 0
    v_lshlrev_b32 v84, 16, v88
    v_and_b32 v85, s16, v88
    v_lshlrev_b32 v86, 16, v89
    v_and_b32 v87, s16, v89
    buffer_load_dwordx4 v[64:67], v252, s[12:15], s92 offen sc1
    v_add_f32 v84, v129, v84
    v_add_f32 v85, v129, v85
    v_add_f32 v86, v129, v86
    v_add_f32 v87, v129, v87
    v_cvt_pk_bf16_f32 v88, v84, v85
    v_cvt_pk_bf16_f32 v89, v86, v87
    v_rcp_f32 v32, v200
    v_mul_u32_u24 v148, 1088, v130
    v_rcp_f32 v33, v216
    buffer_load_dwordx4 v[68:71], v253, s[12:15], s92 offen sc1
    s_add_u32 s92, s92, 90112
    v_lshl_add_u32 v148, v11, 4, v148
    v_mul_f32 v196, v196, v32
    v_mul_f32 v197, v197, v32
    v_and_b32 v149, 1, v12
    v_mul_f32 v198, v198, v32
    v_mul_f32 v199, v199, v32
    v_lshl_add_u32 v148, v149, 3, v148
    v_mul_f32 v204, v204, v33
    s_lshl_b32 s65, s3, 8
    v_mul_f32 v205, v205, v33
    v_mul_f32 v206, v206, v33
    s_add_u32 s65, s65, 155648
    v_mul_f32 v207, v207, v33
    v_cvt_pk_bf16_f32 v28, v196, v197
    buffer_load_dwordx4 v[72:75], v15, s[12:15], s92 offen sc1
    v_add_u32_e64 v148, s65, v148
    v_cvt_pk_bf16_f32 v30, v204, v205
    v_cvt_pk_bf16_f32 v29, v198, v199
    ds_write_b64 v148, v[88:89]
    v_cvt_pk_bf16_f32 v31, v206, v207
    v_and_b32 v149, 0x3ff, v0
    v_permlane16_swap_b32 v28, v30
    v_add_u32 v149, 157824, v149
    v_permlane16_swap_b32 v29, v31
    ds_write_b32 v149, v7
    buffer_store_dwordx4 v[28:31], v5, s[12:15], s89 offen nt
    buffer_load_dword v14, v3, s[12:15], s22 offen sc1
    s_lshr_b32 s64, s8, 1
    s_lshl_b32 s64, s64, 11
    s_add_u32 s11, s10, s64
    s_and_b32 s64, s8, 1
    s_lshl_b32 s64, s64, 9
    s_add_u32 s11, s11, s64
    s_add_u32 s11, s11, 0x25000
    s_lshl_b32 s64, s4, 10
    s_add_u32 s18, s10, s64
    s_add_u32 s18, s18, 0x1000
    s_lshl_b32 s64, s3, 4
    s_lshl_b64 s[20:21], 0xffff, s64
    s_lshl_b32 s64, s3, 10
    s_add_u32 s64, s64, 69632
    v_add_u32 v112, s64, v15
    buffer_load_dwordx4 v[76:79], v252, s[12:15], s92 offen sc1
    v_add_u32 v113, 69632, v15
    s_and_b32 s64, s3, 1
    s_lshl_b32 s64, s64, 9
    v_add_u32 v116, s64, v5
    v_add_u32 v117, 0x10000, v116
    v_add_u32 v118, 0x20000, v116
    s_lshl_b32 s64, s3, 11
    s_add_u32 s64, s64, 49152
    v_add_u32 v9, s64, v15
    v_xor_b32 v10, 2048, v9
    s_waitcnt vmcnt(2)
    s_mov_b64 exec, 1
    buffer_store_dword v2, v4, s[12:15], s17 offen nt
    s_mov_b64 exec, -1
    s_add_u32 s17, s17, 128
    s_waitcnt vmcnt(2)
    v_cmp_ne_u32 vcc, s6, v14
    s_nop 0
    s_cbranch_vccnz retry_14
ready_15:
    s_add_u32 s22, s22, 128
    s_lshl_b32 s39, s3, 12
    s_add_u32 s38, s10, s39
    s_add_u32 s38, s38, 0x3a800
    s_add_u32 m0, s39, 81920
    s_nop 0
    buffer_load_dwordx4 v15, s[12:15], s38 offen offset:0 sc1 lds
    buffer_load_dwordx4 v15, s[12:15], s38 offen offset:1024 sc1 lds
    buffer_load_dwordx4 v15, s[12:15], s38 offen offset:2048 sc1 lds
    buffer_load_dwordx4 v15, s[12:15], s38 offen offset:3072 sc1 lds
    s_add_u32 s38, s38, 16384
    s_waitcnt lgkmcnt(0)
    s_barrier
    s_add_u32 m0, s39, 98304
    s_nop 0
    buffer_load_dwordx4 v15, s[12:15], s38 offen offset:0 sc1 lds
    v_min_u32 v114, 2, v11
    v_mul_u32_u24 v114, 1088, v114
    v_lshl_add_u32 v114, v12, 4, v114
    v_add_u32 v114, 155648, v114
    v_xor_b32 v100, s72, v100
    v_xor_b32 v101, s73, v101
    v_xor_b32 v102, s74, v102
    v_xor_b32 v103, s75, v103
    v_or3_b32 v122, v100, v101, v102
    v_or_b32 v122, v122, v103
    v_and_b32 v122, 0xff, v122
    s_mov_b32 exec_lo, 0xf00ff00f
    s_mov_b32 exec_hi, exec_lo
    v_cmp_ne_u32 vcc, 0, v122
    s_mov_b64 exec, -1
    s_cbranch_vccnz retry_8
ready_9:
    buffer_load_dwordx4 v15, s[12:15], s38 offen offset:1024 sc1 lds
    v_xor_b32 v126, 16, v127
    ds_read_b64 v[86:87], v127 offset:0
    ds_read_b64 v[90:91], v126 offset:0
    ds_read_b64 v[94:95], v127 offset:4096
    ds_read_b64 v[98:99], v126 offset:4096
    buffer_load_dwordx4 v15, s[12:15], s38 offen offset:2048 sc1 lds
    v_add_f32_dpp v100, v100, v100 quad_perm:[1,0,3,2] row_mask:0xf bank_mask:0xf
    v_add_f32_dpp v101, v101, v101 quad_perm:[1,0,3,2] row_mask:0xf bank_mask:0xf
    v_add_f32_dpp v102, v102, v102 quad_perm:[1,0,3,2] row_mask:0xf bank_mask:0xf
    v_add_f32_dpp v103, v103, v103 quad_perm:[1,0,3,2] row_mask:0xf bank_mask:0xf
    v_add_f32_dpp v100, v100, v100 quad_perm:[2,3,0,1] row_mask:0xf bank_mask:0xf
    v_add_f32_dpp v101, v101, v101 quad_perm:[2,3,0,1] row_mask:0xf bank_mask:0xf
    v_add_f32_dpp v102, v102, v102 quad_perm:[2,3,0,1] row_mask:0xf bank_mask:0xf
    buffer_load_dwordx4 v15, s[12:15], s38 offen offset:3072 sc1 lds
    s_add_u32 s38, s38, 16384
    v_add_f32_dpp v103, v103, v103 quad_perm:[2,3,0,1] row_mask:0xf bank_mask:0xf
    v_cvt_pk_bf16_f32 v122, v100, v101
    v_cvt_pk_bf16_f32 v123, v102, v103
    s_mov_b32 exec_lo, 0xff00ff0
    s_mov_b32 exec_hi, exec_lo
    ds_read_b64 v[122:123], v121
    s_mov_b64 exec, -1
    s_waitcnt lgkmcnt(4)
    v_lshlrev_b32 v84, 16, v86
    v_and_b32 v85, s16, v86
    v_lshlrev_b32 v86, 16, v87
    v_and_b32 v87, s16, v87
    s_waitcnt lgkmcnt(3)
    v_lshlrev_b32 v88, 16, v90
    v_and_b32 v89, s16, v90
    v_lshlrev_b32 v90, 16, v91
    buffer_load_dword v14, v3, s[12:15], s22 offen sc1
    v_and_b32 v91, s16, v91
    s_waitcnt lgkmcnt(2)
    v_lshlrev_b32 v92, 16, v94
    v_and_b32 v93, s16, v94
    v_lshlrev_b32 v94, 16, v95
    v_and_b32 v95, s16, v95
    s_waitcnt lgkmcnt(1)
    v_lshlrev_b32 v96, 16, v98
    v_and_b32 v97, s16, v98
    v_lshlrev_b32 v98, 16, v99
    v_and_b32 v99, s16, v99
    v_lshlrev_b32 v108, 16, v110
    v_and_b32 v109, s16, v110
    v_lshlrev_b32 v110, 16, v111
    v_and_b32 v111, s16, v111
    s_waitcnt lgkmcnt(0)
    v_mov_b32 v124, v122
    v_mov_b32 v125, v123
    buffer_load_dwordx4 v[80:83], v253, s[12:15], s92 offen sc1
    s_add_u32 s92, s92, 90112
    v_permlane16_swap_b32 v122, v124
    v_permlane16_swap_b32 v123, v125
    v_lshlrev_b32 v100, 16, v122
    v_and_b32 v101, s16, v122
    v_lshlrev_b32 v102, 16, v123
    v_and_b32 v103, s16, v123
    v_lshlrev_b32 v104, 16, v124
    v_and_b32 v105, s16, v124
    v_lshlrev_b32 v106, 16, v125
    v_and_b32 v107, s16, v125
    s_waitcnt vmcnt(6)
    s_barrier
    s_nop 0
    buffer_load_dwordx4 a[0:3], v15, s[12:15], s92 offen sc1
    ds_read_b128 v[180:183], v117 offset:16384
    ds_read_b128 v[184:187], v117 offset:18432
    ds_read_b128 v[188:191], v117 offset:20480
    ds_read_b128 v[192:195], v117 offset:22528
    s_waitcnt lgkmcnt(2)
    v_mfma_f32_32x32x16_bf16 v[220:235], a[192:195], v[180:183], 0
    ds_read_b128 v[196:199], v117 offset:24576
    ds_read_b128 v[180:183], v117 offset:26624
    buffer_load_dwordx4 a[4:7], v252, s[12:15], s92 offen sc1
    v_mfma_f32_32x32x16_bf16 v[220:235], a[196:199], v[184:187], v[220:235]
    s_waitcnt lgkmcnt(2)
    v_mfma_f32_32x32x16_bf16 v[220:235], a[200:203], v[188:191], v[220:235]
    ds_read_b128 v[184:187], v117 offset:28672
    ds_read_b128 v[188:191], v117 offset:30720
    buffer_load_dwordx4 a[8:11], v253, s[12:15], s92 offen sc1
    s_add_u32 s92, s92, 90112
    v_mfma_f32_32x32x16_bf16 v[220:235], a[204:207], v[192:195], v[220:235]
    s_waitcnt lgkmcnt(2)
    v_mfma_f32_32x32x16_bf16 v[220:235], a[208:211], v[196:199], v[220:235]
    s_waitcnt vmcnt(4)
    v_cmp_ne_u32 vcc, s6, v14
    s_nop 0
    s_cbranch_vccnz retry_16
ready_17:
    buffer_load_dwordx4 a[12:15], v15, s[12:15], s92 offen sc1
    s_barrier
    v_mfma_f32_32x32x16_bf16 v[220:235], a[212:215], v[180:183], v[220:235]
    ds_read_b128 v[192:195], v117 offset:32768
    ds_read_b128 v[196:199], v117 offset:34816
    s_waitcnt lgkmcnt(2)
    v_mfma_f32_32x32x16_bf16 v[220:235], a[216:219], v[184:187], v[220:235]
    s_add_u32 s22, s22, 128
    s_lshl_b32 s39, s3, 12
    s_add_u32 s38, s10, s39
    s_add_u32 s38, s38, 0x42800
    s_add_u32 m0, s39, 114688
    s_nop 0
    buffer_load_dwordx4 v15, s[12:15], s38 offen offset:0 sc1 lds
    v_mfma_f32_32x32x16_bf16 v[220:235], a[220:223], v[188:191], v[220:235]
    ds_read_b128 v[180:183], v117 offset:36864
    ds_read_b128 v[120:123], v114 offset:512
    ds_read_b128 v[184:187], v117 offset:38912
    s_waitcnt lgkmcnt(3)
    v_mfma_f32_32x32x16_bf16 v[220:235], a[224:227], v[192:195], v[220:235]
    ds_read_b128 v[124:127], v114 offset:576
    ds_read_b128 v[188:191], v117 offset:40960
    buffer_load_dwordx4 v15, s[12:15], s38 offen offset:1024 sc1 lds
    ds_read_b128 v[128:131], v114 offset:640
    ds_read_b128 v[192:195], v117 offset:43008
    v_mfma_f32_32x32x16_bf16 v[220:235], a[228:231], v[196:199], v[220:235]
    s_waitcnt lgkmcnt(4)
    v_mfma_f32_32x32x16_bf16 v[220:235], a[232:235], v[180:183], v[220:235]
    buffer_load_dwordx4 v15, s[12:15], s38 offen offset:2048 sc1 lds
    ds_read_b128 v[132:135], v114 offset:704
    ds_read_b128 v[196:199], v117 offset:45056
    buffer_load_dwordx4 v15, s[12:15], s38 offen offset:3072 sc1 lds
    s_add_u32 s38, s38, 16384
    ds_read_b128 v[136:139], v114 offset:768
    v_mfma_f32_32x32x16_bf16 v[220:235], a[236:239], v[184:187], v[220:235]
    ds_read_b128 v[180:183], v117 offset:47104
    s_waitcnt lgkmcnt(4)
    v_mfma_f32_32x32x16_bf16 v[220:235], a[240:243], v[188:191], v[220:235]
    s_add_u32 m0, s39, 131072
    s_nop 0
    buffer_load_dwordx4 v15, s[12:15], s38 offen offset:0 sc1 lds
    ds_read_b128 v[140:143], v114 offset:832
    buffer_load_dwordx4 v15, s[12:15], s38 offen offset:1024 sc1 lds
    ds_read_b128 v[144:147], v114 offset:896
    v_mfma_f32_32x32x16_bf16 v[220:235], a[244:247], v[192:195], v[220:235]
    s_waitcnt lgkmcnt(2)
    v_mfma_f32_32x32x16_bf16 v[220:235], a[248:251], v[196:199], v[220:235]
    buffer_load_dwordx4 v15, s[12:15], s38 offen offset:2048 sc1 lds
    buffer_load_dwordx4 v15, s[12:15], s38 offen offset:3072 sc1 lds
    s_add_u32 s38, s38, 16384
    ds_read_b128 v[148:151], v114 offset:960
    s_lshr_b32 s64, s8, 1
    s_lshl_b32 s64, s64, 11
    s_add_u32 s76, s10, s64
    s_and_b32 s64, s8, 1
    v_mfma_f32_32x32x16_bf16 v[220:235], a[252:255], v[180:183], v[220:235]
    s_lshl_b32 s64, s64, 9
    s_add_u32 s76, s76, s64
    s_add_u32 s76, s76, 0x25000
    s_add_u32 s77, s76, 32768
    s_lshr_b32 s64, s9, 1
    buffer_load_dwordx4 a[16:19], v252, s[12:15], s92 offen sc1
    s_lshl_b32 s64, s64, 11
    s_add_u32 s78, s10, s64
    v_mfma_f32_16x16x32_bf16 v[176:179], v[120:123], v[120:123], 0
    s_and_b32 s64, s9, 1
    s_lshl_b32 s64, s64, 9
    s_add_u32 s78, s78, s64
    v_mfma_f32_16x16x32_bf16 v[176:179], v[124:127], v[124:127], v[176:179]
    s_add_u32 s78, s78, 0x25000
    s_cmp_lt_u32 s9, 86
    s_cselect_b32 s78, s78, 0x40000000
    v_mfma_f32_16x16x32_bf16 v[176:179], v[128:131], v[128:131], v[176:179]
    buffer_load_dwordx4 a[20:23], v253, s[12:15], s92 offen sc1
    s_add_u32 s92, s92, 90112
    v_mfma_f32_16x16x32_bf16 v[176:179], v[132:135], v[132:135], v[176:179]
    buffer_load_dwordx4 a[24:27], v15, s[12:15], s92 offen sc1
    ds_read_b128 v[120:123], v114 offset:0
    ds_read_b128 v[124:127], v114 offset:64
    v_mfma_f32_16x16x32_bf16 v[176:179], v[136:139], v[136:139], v[176:179]
    ds_read_b128 v[128:131], v114 offset:128
    ds_read_b128 v[132:135], v114 offset:192
    ds_read_b128 v[136:139], v114 offset:256
    s_waitcnt lgkmcnt(7)
    v_mfma_f32_16x16x32_bf16 v[176:179], v[140:143], v[140:143], v[176:179]
    ds_read_b128 v[140:143], v114 offset:320
    s_waitcnt lgkmcnt(7)
    v_mfma_f32_16x16x32_bf16 v[176:179], v[144:147], v[144:147], v[176:179]
    ds_read_b128 v[144:147], v114 offset:384
    s_waitcnt lgkmcnt(7)
    v_mfma_f32_16x16x32_bf16 v[176:179], v[148:151], v[148:151], v[176:179]
    ds_read_b128 v[148:151], v114 offset:448
    ds_write_b128 v9, v[228:231] offset:0
    s_waitcnt lgkmcnt(8)
    v_mfma_f32_16x16x32_bf16 v[176:179], v[120:123], v[120:123], v[176:179]
    s_waitcnt lgkmcnt(7)
    v_mfma_f32_16x16x32_bf16 v[176:179], v[124:127], v[124:127], v[176:179]
    ds_write_b128 v9, v[232:235] offset:1024
    s_waitcnt lgkmcnt(7)
    v_mfma_f32_16x16x32_bf16 v[176:179], v[128:131], v[128:131], v[176:179]
    s_waitcnt lgkmcnt(6)
    v_mfma_f32_16x16x32_bf16 v[176:179], v[132:135], v[132:135], v[176:179]
    s_waitcnt lgkmcnt(5)
    v_mfma_f32_16x16x32_bf16 v[176:179], v[136:139], v[136:139], v[176:179]
    buffer_load_dwordx4 a[28:31], v252, s[12:15], s92 offen sc1
    buffer_load_dwordx4 a[32:35], v253, s[12:15], s92 offen sc1
    s_add_u32 s92, s92, 90112
    s_waitcnt lgkmcnt(4)
    v_mfma_f32_16x16x32_bf16 v[176:179], v[140:143], v[140:143], v[176:179]
    s_waitcnt vmcnt(9)
    s_waitcnt lgkmcnt(0)
    s_barrier
    v_mfma_f32_16x16x32_bf16 v[176:179], v[144:147], v[144:147], v[176:179]
    buffer_load_dwordx4 a[36:39], v15, s[12:15], s92 offen sc1
    v_mfma_f32_16x16x32_bf16 v[176:179], v[148:151], v[148:151], v[176:179]
    ds_read_b128 v[228:231], v10 offset:0
    ds_read_b128 v[232:235], v10 offset:1024
    ds_read_b128 v[180:183], v117 offset:49152
    ds_read_b128 v[184:187], v117 offset:51200
    ds_read_b128 v[188:191], v117 offset:53248
    ds_read_b128 v[192:195], v117 offset:55296
    s_waitcnt lgkmcnt(2)
    v_mfma_f32_32x32x16_bf16 v[236:251], a[192:195], v[180:183], 0
    ds_read_b128 v[196:199], v117 offset:57344
    buffer_load_dwordx4 a[40:43], v252, s[12:15], s92 offen sc1
    v_add_f32 v220, v220, v228
    v_add_f32 v221, v221, v229
    v_add_f32 v222, v222, v230
    ds_read_b128 v[180:183], v117 offset:59392
    v_mfma_f32_32x32x16_bf16 v[236:251], a[196:199], v[184:187], v[236:251]
    s_waitcnt lgkmcnt(2)
    v_mfma_f32_32x32x16_bf16 v[236:251], a[200:203], v[188:191], v[236:251]
    v_add_f32 v223, v223, v231
    v_add_f32 v224, v224, v232
    v_add_f32 v225, v225, v233
    v_add_f32 v226, v226, v234
    v_add_f32 v227, v227, v235
    ds_read_b128 v[184:187], v117 offset:61440
    v_fmac_f32_dpp v84, v100, v220 row_newbcast:0 row_mask:0xf bank_mask:0xf
    v_mfma_f32_32x32x16_bf16 v[236:251], a[204:207], v[192:195], v[236:251]
    buffer_load_dwordx4 a[44:47], v253, s[12:15], s92 offen sc1
    s_add_u32 s92, s92, 90112
    v_fmac_f32_dpp v85, v101, v221 row_newbcast:0 row_mask:0xf bank_mask:0xf
    v_fmac_f32_dpp v86, v102, v222 row_newbcast:0 row_mask:0xf bank_mask:0xf
    v_fmac_f32_dpp v87, v103, v223 row_newbcast:0 row_mask:0xf bank_mask:0xf
    v_fmac_f32_dpp v88, v104, v224 row_newbcast:0 row_mask:0xf bank_mask:0xf
    ds_read_b128 v[188:191], v117 offset:63488
    s_waitcnt lgkmcnt(2)
    v_mfma_f32_32x32x16_bf16 v[236:251], a[208:211], v[196:199], v[236:251]
    v_fmac_f32_dpp v89, v105, v225 row_newbcast:0 row_mask:0xf bank_mask:0xf
    v_fmac_f32_dpp v90, v106, v226 row_newbcast:0 row_mask:0xf bank_mask:0xf
    v_fmac_f32_dpp v91, v107, v227 row_newbcast:0 row_mask:0xf bank_mask:0xf
    v_mul_f32_dpp v228, v100, v84 row_newbcast:8 row_mask:0xf bank_mask:0xf
    v_mul_f32_dpp v229, v101, v85 row_newbcast:8 row_mask:0xf bank_mask:0xf
    s_waitcnt vmcnt(8)
    s_barrier
    v_mfma_f32_32x32x16_bf16 v[236:251], a[212:215], v[180:183], v[236:251]
    buffer_load_dwordx4 a[48:51], v15, s[12:15], s92 offen sc1
    ds_read_b128 v[192:195], v118 offset:0
    v_mul_f32_dpp v230, v102, v86 row_newbcast:8 row_mask:0xf bank_mask:0xf
    v_mul_f32_dpp v231, v103, v87 row_newbcast:8 row_mask:0xf bank_mask:0xf
    v_mul_f32_dpp v232, v104, v88 row_newbcast:8 row_mask:0xf bank_mask:0xf
    v_mul_f32_dpp v233, v105, v89 row_newbcast:8 row_mask:0xf bank_mask:0xf
    ds_read_b128 v[196:199], v118 offset:2048
    s_waitcnt lgkmcnt(2)
    v_mfma_f32_32x32x16_bf16 v[236:251], a[216:219], v[184:187], v[236:251]
    v_mul_f32_dpp v234, v106, v90 row_newbcast:8 row_mask:0xf bank_mask:0xf
    v_mul_f32_dpp v235, v107, v91 row_newbcast:8 row_mask:0xf bank_mask:0xf
    v_cvt_pk_bf16_f32 v220, v228, v229
    v_cvt_pk_bf16_f32 v222, v232, v233
    buffer_load_dwordx4 a[52:55], v252, s[12:15], s92 offen sc1
    v_cvt_pk_bf16_f32 v221, v230, v231
    ds_read_b128 v[180:183], v118 offset:4096
    v_mfma_f32_32x32x16_bf16 v[236:251], a[220:223], v[188:191], v[236:251]
    v_cvt_pk_bf16_f32 v223, v234, v235
    v_permlane32_swap_b32 v220, v222
    s_nop 0
    v_permlane32_swap_b32 v221, v223
    buffer_store_dwordx4 v[220:223], v5, s[12:15], s11 offen nt
    ds_read_b128 v[184:187], v118 offset:6144
    s_waitcnt lgkmcnt(2)
    v_mfma_f32_32x32x16_bf16 v[236:251], a[224:227], v[192:195], v[236:251]
    s_add_u32 s11, s11, 153600
    v_add_f32 v20, v84, v85
    v_mul_f32 v21, v84, v84
    v_add_f32 v22, v228, v229
    v_mul_f32 v23, v228, v228
    ds_read_b128 v[188:191], v118 offset:8192
    v_mfma_f32_32x32x16_bf16 v[236:251], a[228:231], v[196:199], v[236:251]
    v_mul_f32_dpp v24, v100, v228 row_newbcast:8 row_mask:0xf bank_mask:0xf
    v_mul_f32_dpp v25, v100, v228 row_newbcast:4 row_mask:0xf bank_mask:0xf
    v_fmac_f32 v21, v85, v85
    v_fmac_f32 v23, v229, v229
    v_fmac_f32_dpp v24, v101, v229 row_newbcast:8 row_mask:0xf bank_mask:0xf
    ds_read_b128 v[192:195], v118 offset:10240
    s_waitcnt lgkmcnt(2)
    v_mfma_f32_32x32x16_bf16 v[236:251], a[232:235], v[180:183], v[236:251]
    v_fmac_f32_dpp v25, v101, v229 row_newbcast:4 row_mask:0xf bank_mask:0xf
    v_add_f32 v20, v20, v86
    v_add_f32 v22, v22, v230
    v_fmac_f32 v21, v86, v86
    buffer_load_dwordx4 a[56:59], v253, s[12:15], s92 offen sc1
    s_add_u32 s92, s92, 90112
    v_fmac_f32 v23, v230, v230
    v_mfma_f32_32x32x16_bf16 v[236:251], a[236:239], v[184:187], v[236:251]
    ds_read_b128 v[196:199], v118 offset:12288
    v_fmac_f32_dpp v24, v102, v230 row_newbcast:8 row_mask:0xf bank_mask:0xf
    v_fmac_f32_dpp v25, v102, v230 row_newbcast:4 row_mask:0xf bank_mask:0xf
    v_add_f32 v20, v20, v87
    v_add_f32 v22, v22, v231
    v_fmac_f32 v21, v87, v87
    ds_read_b128 v[180:183], v118 offset:14336
    s_waitcnt lgkmcnt(2)
    v_mfma_f32_32x32x16_bf16 v[236:251], a[240:243], v[188:191], v[236:251]
    v_fmac_f32 v23, v231, v231
    v_fmac_f32_dpp v24, v103, v231 row_newbcast:8 row_mask:0xf bank_mask:0xf
    v_fmac_f32_dpp v25, v103, v231 row_newbcast:4 row_mask:0xf bank_mask:0xf
    v_add_f32 v20, v20, v88
    v_add_f32 v22, v22, v232
    buffer_load_dwordx4 a[60:63], v15, s[12:15], s92 offen sc1
    v_mfma_f32_32x32x16_bf16 v[236:251], a[244:247], v[192:195], v[236:251]
    v_fmac_f32 v21, v88, v88
    v_fmac_f32 v23, v232, v232
    v_fmac_f32_dpp v24, v104, v232 row_newbcast:8 row_mask:0xf bank_mask:0xf
    v_fmac_f32_dpp v25, v104, v232 row_newbcast:4 row_mask:0xf bank_mask:0xf
    v_add_f32 v20, v20, v89
    s_waitcnt lgkmcnt(0)
    v_mfma_f32_32x32x16_bf16 v[236:251], a[248:251], v[196:199], v[236:251]
    v_add_f32 v22, v22, v233
    v_fmac_f32 v21, v89, v89
    v_fmac_f32 v23, v233, v233
    v_fmac_f32_dpp v24, v105, v233 row_newbcast:8 row_mask:0xf bank_mask:0xf
    v_fmac_f32_dpp v25, v105, v233 row_newbcast:4 row_mask:0xf bank_mask:0xf
    v_add_f32 v20, v20, v90
    v_add_f32 v22, v22, v234
    v_fmac_f32 v21, v90, v90
    v_fmac_f32 v23, v234, v234
    buffer_load_dwordx4 a[64:67], v252, s[12:15], s92 offen sc1
    v_fmac_f32_dpp v24, v106, v234 row_newbcast:8 row_mask:0xf bank_mask:0xf
    v_fmac_f32_dpp v25, v106, v234 row_newbcast:4 row_mask:0xf bank_mask:0xf
    v_add_f32 v20, v20, v91
    v_add_f32 v22, v22, v235
    v_fmac_f32 v21, v91, v91
    v_fmac_f32 v23, v235, v235
    v_fmac_f32_dpp v24, v107, v235 row_newbcast:8 row_mask:0xf bank_mask:0xf
    v_fmac_f32_dpp v25, v107, v235 row_newbcast:4 row_mask:0xf bank_mask:0xf
    v_permlane32_swap_b32 v20, v21
    v_permlane32_swap_b32 v22, v23
    v_permlane32_swap_b32 v24, v25
    v_mfma_f32_32x32x16_bf16 v[236:251], a[252:255], v[180:183], v[236:251]
    v_add_f32 v20, v20, v21
    v_add_f32 v21, v22, v23
    v_add_f32 v22, v24, v25
    ds_write_b96 v112, v[20:22] offset:0
    s_nop 7
    ds_write_b128 v9, v[244:247] offset:8192
    buffer_load_dwordx4 a[68:71], v253, s[12:15], s92 offen sc1
    s_add_u32 s92, s92, 90112
    ds_write_b128 v9, v[248:251] offset:9216
    s_waitcnt vmcnt(4)
    s_mov_b64 exec, 1
    buffer_store_dword v2, v4, s[12:15], s17 offen nt
    s_mov_b64 exec, -1
    s_add_u32 s17, s17, 128
    s_waitcnt lgkmcnt(0)
    s_barrier
    s_nop 0
    ds_read_b128 v[244:247], v10 offset:8192
    ds_read_b128 v[248:251], v10 offset:9216
    ds_read_b128 v[20:23], v113 offset:0
    ds_read_b128 v[24:27], v113 offset:1024
    ds_read_b128 v[28:31], v113 offset:2048
    ds_read_b128 v[32:35], v113 offset:3072
    s_getpc_b64 s[40:41]
L_pf3:
    v_min_u32 v19, pf_last3, v0
    global_load_dword v18, v19, s[40:41]
    s_waitcnt lgkmcnt(5)
    v_add_f32 v236, v236, v244
    v_mfma_f32_16x16x32_bf16 v[164:167], v[36:39], v[120:123], 0
    v_add_f32 v237, v237, v245
    v_add_f32 v238, v238, v246
    v_add_f32 v239, v239, v247
    s_waitcnt lgkmcnt(4)
    v_add_f32 v240, v240, v248
    v_add_f32 v241, v241, v249
    v_add_f32 v242, v242, v250
    v_add_f32 v243, v243, v251
    v_mfma_f32_16x16x32_bf16 v[168:171], v[40:43], v[120:123], 0
    v_fmac_f32_dpp v92, v100, v236 row_newbcast:0 row_mask:0xf bank_mask:0xf
    buffer_load_dwordx4 a[72:75], v15, s[12:15], s92 offen sc1
    v_fmac_f32_dpp v93, v101, v237 row_newbcast:0 row_mask:0xf bank_mask:0xf
    v_fmac_f32_dpp v94, v102, v238 row_newbcast:0 row_mask:0xf bank_mask:0xf
    v_fmac_f32_dpp v95, v103, v239 row_newbcast:0 row_mask:0xf bank_mask:0xf
    v_fmac_f32_dpp v96, v104, v240 row_newbcast:0 row_mask:0xf bank_mask:0xf
    v_fmac_f32_dpp v97, v105, v241 row_newbcast:0 row_mask:0xf bank_mask:0xf
    v_fmac_f32_dpp v98, v106, v242 row_newbcast:0 row_mask:0xf bank_mask:0xf
    v_mfma_f32_16x16x32_bf16 v[172:175], v[44:47], v[120:123], 0
    v_fmac_f32_dpp v99, v107, v243 row_newbcast:0 row_mask:0xf bank_mask:0xf
    v_mul_f32_dpp v244, v100, v92 row_newbcast:8 row_mask:0xf bank_mask:0xf
    v_mul_f32_dpp v245, v101, v93 row_newbcast:8 row_mask:0xf bank_mask:0xf
    v_mul_f32_dpp v246, v102, v94 row_newbcast:8 row_mask:0xf bank_mask:0xf
    v_mul_f32_dpp v247, v103, v95 row_newbcast:8 row_mask:0xf bank_mask:0xf
    buffer_load_dwordx4 a[76:79], v252, s[12:15], s92 offen sc1
    v_mul_f32_dpp v248, v104, v96 row_newbcast:8 row_mask:0xf bank_mask:0xf
    v_mul_f32_dpp v249, v105, v97 row_newbcast:8 row_mask:0xf bank_mask:0xf
    v_mfma_f32_16x16x32_bf16 v[164:167], v[48:51], v[124:127], v[164:167]
    v_mul_f32_dpp v250, v106, v98 row_newbcast:8 row_mask:0xf bank_mask:0xf
    v_mul_f32_dpp v251, v107, v99 row_newbcast:8 row_mask:0xf bank_mask:0xf
    v_cvt_pk_bf16_f32 v236, v244, v245
    v_cvt_pk_bf16_f32 v238, v248, v249
    v_cvt_pk_bf16_f32 v237, v246, v247
    v_cvt_pk_bf16_f32 v239, v250, v251
    v_permlane32_swap_b32 v236, v238
    v_mfma_f32_16x16x32_bf16 v[168:171], v[52:55], v[124:127], v[168:171]
    v_permlane32_swap_b32 v237, v239
    buffer_load_dwordx4 a[80:83], v253, s[12:15], s92 offen sc1
    s_add_u32 s92, s92, 90112
    buffer_store_dwordx4 v[236:239], v5, s[12:15], s11 offen sc1
    s_waitcnt lgkmcnt(2)
    v_add_f32 v20, v20, v24
    v_add_f32 v21, v21, v25
    v_add_f32 v22, v22, v26
    v_mfma_f32_16x16x32_bf16 v[172:175], v[56:59], v[124:127], v[172:175]
    s_waitcnt lgkmcnt(0)
    v_add_f32 v28, v28, v32
    v_add_f32 v29, v29, v33
    v_add_f32 v30, v30, v34
    v_add_f32 v20, v20, v28
    v_add_f32 v21, v21, v29
    v_add_f32 v22, v22, v30
    s_mov_b64 exec, s[20:21]
    buffer_store_dwordx4 v[20:23], v15, s[12:15], s18 offen nt
    s_mov_b64 exec, -1
    v_mfma_f32_16x16x32_bf16 v[164:167], v[60:63], v[128:131], v[164:167]
    s_add_u32 s18, s18, 8192
    buffer_load_dword v14, v3, s[12:15], s22 offen sc1
    v_add_f32 v20, v92, v93
    v_mul_f32 v21, v92, v92
    v_add_f32 v22, v244, v245
    v_mul_f32 v23, v244, v244
    v_mul_f32_dpp v24, v100, v244 row_newbcast:8 row_mask:0xf bank_mask:0xf
    v_mfma_f32_16x16x32_bf16 v[168:171], v[64:67], v[128:131], v[168:171]
    v_mul_f32_dpp v25, v100, v244 row_newbcast:4 row_mask:0xf bank_mask:0xf
    v_fmac_f32 v21, v93, v93
    v_fmac_f32 v23, v245, v245
    v_fmac_f32_dpp v24, v101, v245 row_newbcast:8 row_mask:0xf bank_mask:0xf
    buffer_load_dwordx4 a[84:87], v15, s[12:15], s92 offen sc1
    v_fmac_f32_dpp v25, v101, v245 row_newbcast:4 row_mask:0xf bank_mask:0xf
    v_add_f32 v20, v20, v94
    v_add_f32 v22, v22, v246
    v_mfma_f32_16x16x32_bf16 v[172:175], v[68:71], v[128:131], v[172:175]
    v_fmac_f32 v21, v94, v94
    v_fmac_f32 v23, v246, v246
    v_fmac_f32_dpp v24, v102, v246 row_newbcast:8 row_mask:0xf bank_mask:0xf
    v_fmac_f32_dpp v25, v102, v246 row_newbcast:4 row_mask:0xf bank_mask:0xf
    v_add_f32 v20, v20, v95
    v_add_f32 v22, v22, v247
    v_fmac_f32 v21, v95, v95
    v_fmac_f32 v23, v247, v247
    v_mfma_f32_16x16x32_bf16 v[164:167], v[72:75], v[132:135], v[164:167]
    buffer_load_dwordx4 a[88:91], v252, s[12:15], s92 offen sc1
    v_fmac_f32_dpp v24, v103, v247 row_newbcast:8 row_mask:0xf bank_mask:0xf
    v_fmac_f32_dpp v25, v103, v247 row_newbcast:4 row_mask:0xf bank_mask:0xf
    v_add_f32 v20, v20, v96
    v_add_f32 v22, v22, v248
    v_fmac_f32 v21, v96, v96
    v_fmac_f32 v23, v248, v248
    v_fmac_f32_dpp v24, v104, v248 row_newbcast:8 row_mask:0xf bank_mask:0xf
    v_mfma_f32_16x16x32_bf16 v[168:171], v[76:79], v[132:135], v[168:171]
    v_fmac_f32_dpp v25, v104, v248 row_newbcast:4 row_mask:0xf bank_mask:0xf
    v_add_f32 v20, v20, v97
    v_add_f32 v22, v22, v249
    v_fmac_f32 v21, v97, v97
    buffer_load_dwordx4 a[92:95], v253, s[12:15], s92 offen sc1
    s_add_u32 s92, s92, 90112
    v_fmac_f32 v23, v249, v249
    v_fmac_f32_dpp v24, v105, v249 row_newbcast:8 row_mask:0xf bank_mask:0xf
    v_mfma_f32_16x16x32_bf16 v[172:175], v[80:83], v[132:135], v[172:175]
    v_fmac_f32_dpp v25, v105, v249 row_newbcast:4 row_mask:0xf bank_mask:0xf
    v_add_f32 v20, v20, v98
    v_add_f32 v22, v22, v250
    v_fmac_f32 v21, v98, v98
    v_fmac_f32 v23, v250, v250
    v_fmac_f32_dpp v24, v106, v250 row_newbcast:8 row_mask:0xf bank_mask:0xf
    buffer_load_dwordx4 a[96:99], v15, s[12:15], s92 offen sc1
    v_fmac_f32_dpp v25, v106, v250 row_newbcast:4 row_mask:0xf bank_mask:0xf
    v_mfma_f32_16x16x32_bf16 v[164:167], a[0:3], v[136:139], v[164:167]
    v_add_f32 v20, v20, v99
    v_add_f32 v22, v22, v251
    v_fmac_f32 v21, v99, v99
    v_fmac_f32 v23, v251, v251
    v_fmac_f32_dpp v24, v107, v251 row_newbcast:8 row_mask:0xf bank_mask:0xf
    v_fmac_f32_dpp v25, v107, v251 row_newbcast:4 row_mask:0xf bank_mask:0xf
    v_permlane32_swap_b32 v20, v21
    v_mfma_f32_16x16x32_bf16 v[168:171], a[4:7], v[136:139], v[168:171]
    v_permlane32_swap_b32 v22, v23
    buffer_load_dwordx4 a[100:103], v252, s[12:15], s92 offen sc1
    v_permlane32_swap_b32 v24, v25
    v_add_f32 v20, v20, v21
    v_add_f32 v21, v22, v23
    v_add_f32 v22, v24, v25
    v_mfma_f32_16x16x32_bf16 v[172:175], a[8:11], v[136:139], v[172:175]
    ds_write_b96 v112, v[20:22] offset:4096
    s_waitcnt vmcnt(5)
    v_cmp_ne_u32 vcc, s6, v14
    s_nop 0
    s_cbranch_vccnz retry_18
ready_19:
    buffer_load_dwordx4 a[104:107], v253, s[12:15], s92 offen sc1
    s_add_u32 s92, s92, 90112
    s_add_u32 s22, s22, 128
    s_mov_b64 exec, 1
    buffer_store_dword v2, v4, s[12:15], s17 offen nt
    s_mov_b64 exec, -1
    s_add_u32 s17, s17, 128
    v_mfma_f32_16x16x32_bf16 v[164:167], a[12:15], v[140:143], v[164:167]
    s_lshl_b32 s39, s3, 12
    s_add_u32 s38, s10, s39
    s_add_u32 s38, s38, 0x25000
    s_add_u32 m0, s39, 0
    s_nop 0
    buffer_load_dwordx4 v15, s[12:15], s38 offen offset:0 sc1 lds
    v_mfma_f32_16x16x32_bf16 v[168:171], a[16:19], v[140:143], v[168:171]
    buffer_load_dwordx4 v15, s[12:15], s38 offen offset:1024 sc1 lds
    buffer_load_dwordx4 v15, s[12:15], s38 offen offset:2048 sc1 lds
    buffer_load_dwordx4 v15, s[12:15], s38 offen offset:3072 sc1 lds
    s_add_u32 s38, s38, 16384
    s_add_u32 m0, s39, 16384
    s_nop 0
    buffer_load_dwordx4 v15, s[12:15], s38 offen offset:0 sc1 lds
    buffer_load_dwordx4 v15, s[12:15], s38 offen offset:1024 sc1 lds
    buffer_load_dwordx4 v15, s[12:15], s38 offen offset:2048 sc1 lds
    v_mfma_f32_16x16x32_bf16 v[172:175], a[20:23], v[140:143], v[172:175]
    buffer_load_dwordx4 v15, s[12:15], s38 offen offset:3072 sc1 lds
    s_add_u32 s38, s38, 16384
    v_mov_b32_dpp v24, v108 row_newbcast:3 row_mask:0xf bank_mask:0xf
    v_mov_b32_dpp v25, v109 row_newbcast:3 row_mask:0xf bank_mask:0xf
    v_mov_b32_dpp v26, v110 row_newbcast:3 row_mask:0xf bank_mask:0xf
    v_mov_b32_dpp v27, v111 row_newbcast:3 row_mask:0xf bank_mask:0xf
    v_mov_b32 v28, v24
    v_mov_b32 v29, v25
    v_mfma_f32_16x16x32_bf16 v[164:167], a[24:27], v[144:147], v[164:167]
    v_mov_b32 v30, v26
    v_mov_b32 v31, v27
    v_permlane16_swap_b32 v24, v28
    v_permlane16_swap_b32 v25, v29
    v_permlane16_swap_b32 v26, v30
    v_mfma_f32_16x16x32_bf16 v[168:171], a[28:31], v[144:147], v[168:171]
    v_permlane16_swap_b32 v27, v31
    s_nop 0
    v_fmac_f32_dpp v84, v100, v24 row_newbcast:12 row_mask:0xf bank_mask:0xf
    v_fmac_f32_dpp v85, v101, v25 row_newbcast:12 row_mask:0xf bank_mask:0xf
    v_fmac_f32_dpp v86, v102, v26 row_newbcast:12 row_mask:0xf bank_mask:0xf
    v_fmac_f32_dpp v87, v103, v27 row_newbcast:12 row_mask:0xf bank_mask:0xf
    v_fmac_f32_dpp v88, v104, v28 row_newbcast:12 row_mask:0xf bank_mask:0xf
    v_fmac_f32_dpp v89, v105, v29 row_newbcast:12 row_mask:0xf bank_mask:0xf
    v_mfma_f32_16x16x32_bf16 v[172:175], a[32:35], v[144:147], v[172:175]
    v_fmac_f32_dpp v90, v106, v30 row_newbcast:12 row_mask:0xf bank_mask:0xf
    v_fmac_f32_dpp v91, v107, v31 row_newbcast:12 row_mask:0xf bank_mask:0xf
    v_fmac_f32_dpp v92, v100, v24 row_newbcast:12 row_mask:0xf bank_mask:0xf
    v_fmac_f32_dpp v93, v101, v25 row_newbcast:12 row_mask:0xf bank_mask:0xf
    v_fmac_f32_dpp v94, v102, v26 row_newbcast:12 row_mask:0xf bank_mask:0xf
    v_fmac_f32_dpp v95, v103, v27 row_newbcast:12 row_mask:0xf bank_mask:0xf
    v_fmac_f32_dpp v96, v104, v28 row_newbcast:12 row_mask:0xf bank_mask:0xf
    v_fmac_f32_dpp v97, v105, v29 row_newbcast:12 row_mask:0xf bank_mask:0xf
    v_mfma_f32_16x16x32_bf16 v[164:167], a[36:39], v[148:151], v[164:167]
    v_fmac_f32_dpp v98, v106, v30 row_newbcast:12 row_mask:0xf bank_mask:0xf
    v_fmac_f32_dpp v99, v107, v31 row_newbcast:12 row_mask:0xf bank_mask:0xf
    v_add_u32 v9, 106496, v9
    v_add_u32 v10, 106496, v10
    v_mul_f32 v176, 0x3b000000, v176
    v_mul_f32 v177, 0x3b000000, v177
    s_nop 0
    v_readlane_b32 s84, v177, 2
    v_readlane_b32 s85, v177, 1
    v_mfma_f32_16x16x32_bf16 v[168:171], a[40:43], v[148:151], v[168:171]
    v_readlane_b32 s86, v176, 1
    v_readlane_b32 s87, v176, 2
    v_readlane_b32 s88, v176, 0
    s_mov_b32 s42, 0xbdd2d3e8
    s_mov_b32 s43, 0xc0135761
    s_waitcnt vmcnt(4)
    s_waitcnt lgkmcnt(0)
    s_barrier
    v_mfma_f32_16x16x32_bf16 v[172:175], a[44:47], v[148:151], v[172:175]
    buffer_load_dwordx4 a[108:111], v15, s[12:15], s92 offen sc1
    ds_read_b128 v[20:23], v113 offset:4096
    ds_read_b128 v[24:27], v113 offset:5120
    ds_read_b128 v[180:183], v15 offset:0
    ds_read_b128 v[184:187], v15 offset:1024
    ds_read_b128 v[188:191], v15 offset:2048
    ds_read_b128 v[192:195], v15 offset:3072
    s_waitcnt lgkmcnt(2)
    v_mfma_f32_16x16x32_bf16 v[220:223], v[36:39], v[180:183], 0
    ds_read_b128 v[196:199], v15 offset:4096
    ds_read_b128 v[200:203], v15 offset:5120
    v_mfma_f32_16x16x32_bf16 v[224:227], v[36:39], v[184:187], 0
    buffer_load_dwordx4 a[112:115], v252, s[12:15], s92 offen sc1
    ds_read_b128 v[28:31], v113 offset:6144
    v_mfma_f32_16x16x32_bf16 v[228:231], v[40:43], v[180:183], 0
    ds_read_b128 v[32:35], v113 offset:7168
    buffer_load_dword v14, v3, s[12:15], s22 offen sc1
    v_mfma_f32_16x16x32_bf16 v[232:235], v[40:43], v[184:187], 0
    v_add_f32 v20, v20, v24
    v_mfma_f32_16x16x32_bf16 v[236:239], v[44:47], v[180:183], 0
    v_mfma_f32_16x16x32_bf16 v[240:243], v[44:47], v[184:187], 0
    s_waitcnt lgkmcnt(4)
    v_mfma_f32_16x16x32_bf16 v[220:223], v[48:51], v[188:191], v[220:223]
    v_add_f32 v21, v21, v25
    ds_read_b128 v[180:183], v15 offset:6144
    v_mfma_f32_16x16x32_bf16 v[224:227], v[48:51], v[192:195], v[224:227]
    v_add_f32 v22, v22, v26
    ds_read_b128 v[184:187], v15 offset:7168
    v_mfma_f32_16x16x32_bf16 v[228:231], v[52:55], v[188:191], v[228:231]
    buffer_load_dwordx4 a[116:119], v253, s[12:15], s92 offen sc1
    s_add_u32 s92, s92, 90112
    v_mfma_f32_16x16x32_bf16 v[232:235], v[52:55], v[192:195], v[232:235]
    s_waitcnt lgkmcnt(2)
    v_add_f32 v28, v28, v32
    v_add_f32 v29, v29, v33
    v_mfma_f32_16x16x32_bf16 v[236:239], v[56:59], v[188:191], v[236:239]
    v_add_f32 v30, v30, v34
    v_add_f32 v20, v20, v28
    v_mfma_f32_16x16x32_bf16 v[240:243], v[56:59], v[192:195], v[240:243]
    v_add_f32 v21, v21, v29
    v_add_f32 v22, v22, v30
    v_mfma_f32_16x16x32_bf16 v[220:223], v[60:63], v[196:199], v[220:223]
    s_mov_b64 exec, s[20:21]
    buffer_store_dwordx4 v[20:23], v15, s[12:15], s18 offen nt
    s_mov_b64 exec, -1
    v_mfma_f32_16x16x32_bf16 v[224:227], v[60:63], v[200:203], v[224:227]
    ds_read_b128 v[188:191], v15 offset:8192
    v_mfma_f32_16x16x32_bf16 v[228:231], v[64:67], v[196:199], v[228:231]
    ds_read_b128 v[192:195], v15 offset:9216
    buffer_load_dwordx4 a[120:123], v15, s[12:15], s92 offen sc1
    v_mfma_f32_16x16x32_bf16 v[232:235], v[64:67], v[200:203], v[232:235]
    v_mov_b32_dpp v120, v108 row_newbcast:0 row_mask:0xf bank_mask:0xf
    v_mfma_f32_16x16x32_bf16 v[236:239], v[68:71], v[196:199], v[236:239]
    v_mfma_f32_16x16x32_bf16 v[240:243], v[68:71], v[200:203], v[240:243]
    s_waitcnt lgkmcnt(2)
    v_mfma_f32_16x16x32_bf16 v[220:223], v[72:75], v[180:183], v[220:223]
    v_mov_b32_dpp v121, v109 row_newbcast:0 row_mask:0xf bank_mask:0xf
    ds_read_b128 v[196:199], v15 offset:10240
    v_mfma_f32_16x16x32_bf16 v[224:227], v[72:75], v[184:187], v[224:227]
    v_mov_b32_dpp v122, v110 row_newbcast:0 row_mask:0xf bank_mask:0xf
    ds_read_b128 v[200:203], v15 offset:11264
    v_mfma_f32_16x16x32_bf16 v[228:231], v[76:79], v[180:183], v[228:231]
    buffer_load_dwordx4 a[124:127], v252, s[12:15], s92 offen sc1
    v_mov_b32_dpp v123, v111 row_newbcast:0 row_mask:0xf bank_mask:0xf
    v_mfma_f32_16x16x32_bf16 v[232:235], v[76:79], v[184:187], v[232:235]
    v_mov_b32_dpp v124, v108 row_newbcast:1 row_mask:0xf bank_mask:0xf
    v_mov_b32_dpp v125, v109 row_newbcast:1 row_mask:0xf bank_mask:0xf
    v_mfma_f32_16x16x32_bf16 v[236:239], v[80:83], v[180:183], v[236:239]
    v_mov_b32_dpp v126, v110 row_newbcast:1 row_mask:0xf bank_mask:0xf
    v_mfma_f32_16x16x32_bf16 v[240:243], v[80:83], v[184:187], v[240:243]
    s_waitcnt lgkmcnt(2)
    v_mfma_f32_16x16x32_bf16 v[220:223], a[0:3], v[188:191], v[220:223]
    buffer_load_dwordx4 a[128:131], v253, s[12:15], s92 offen sc1
    s_add_u32 s92, s92, 90112
    v_mfma_f32_16x16x32_bf16 v[224:227], a[0:3], v[192:195], v[224:227]
    v_mov_b32_dpp v127, v111 row_newbcast:1 row_mask:0xf bank_mask:0xf
    ds_read_b128 v[180:183], v15 offset:12288
    v_mfma_f32_16x16x32_bf16 v[228:231], a[4:7], v[188:191], v[228:231]
    v_mov_b32_dpp v128, v108 row_newbcast:2 row_mask:0xf bank_mask:0xf
    ds_read_b128 v[184:187], v15 offset:13312
    v_mfma_f32_16x16x32_bf16 v[232:235], a[4:7], v[192:195], v[232:235]
    v_mov_b32_dpp v129, v109 row_newbcast:2 row_mask:0xf bank_mask:0xf
    v_mov_b32_dpp v130, v110 row_newbcast:2 row_mask:0xf bank_mask:0xf
    v_mfma_f32_16x16x32_bf16 v[236:239], a[8:11], v[188:191], v[236:239]
    buffer_load_dwordx4 a[132:135], v15, s[12:15], s92 offen sc1
    v_mov_b32_dpp v131, v111 row_newbcast:2 row_mask:0xf bank_mask:0xf
    v_mfma_f32_16x16x32_bf16 v[240:243], a[8:11], v[192:195], v[240:243]
    s_waitcnt lgkmcnt(2)
    v_mfma_f32_16x16x32_bf16 v[220:223], a[12:15], v[196:199], v[220:223]
    ds_read_b128 v[188:191], v15 offset:14336
    ds_read_b128 v[192:195], v15 offset:15360
    v_mfma_f32_16x16x32_bf16 v[224:227], a[12:15], v[200:203], v[224:227]
    buffer_load_dwordx4 a[136:139], v252, s[12:15], s92 offen sc1
    v_mfma_f32_16x16x32_bf16 v[228:231], a[16:19], v[196:199], v[228:231]
    v_mfma_f32_16x16x32_bf16 v[232:235], a[16:19], v[200:203], v[232:235]
    v_mfma_f32_16x16x32_bf16 v[236:239], a[20:23], v[196:199], v[236:239]
    v_mfma_f32_16x16x32_bf16 v[240:243], a[20:23], v[200:203], v[240:243]
    s_waitcnt lgkmcnt(2)
    v_mfma_f32_16x16x32_bf16 v[220:223], a[24:27], v[180:183], v[220:223]
    buffer_load_dwordx4 a[140:143], v253, s[12:15], s92 offen sc1
    s_add_u32 s92, s92, 90112
    v_mfma_f32_16x16x32_bf16 v[224:227], a[24:27], v[184:187], v[224:227]
    s_waitcnt vmcnt(11)
    s_barrier
    v_mfma_f32_16x16x32_bf16 v[228:231], a[28:31], v[180:183], v[228:231]
    s_waitcnt vmcnt(6)
    s_mov_b64 exec, 1
    buffer_store_dword v2, v4, s[12:15], s17 offen nt
    s_mov_b64 exec, -1
    s_add_u32 s17, s17, 128
    v_mfma_f32_16x16x32_bf16 v[232:235], a[28:31], v[184:187], v[232:235]
    v_mfma_f32_16x16x32_bf16 v[236:239], a[32:35], v[180:183], v[236:239]
    ds_read_b128 v[152:155], v114 offset:512
    v_mfma_f32_16x16x32_bf16 v[240:243], a[32:35], v[184:187], v[240:243]
    ds_read_b128 v[196:199], v15 offset:16384
    ds_read_b128 v[200:203], v15 offset:17408
    s_waitcnt lgkmcnt(3)
    v_mfma_f32_16x16x32_bf16 v[220:223], a[36:39], v[188:191], v[220:223]
    ds_read_b128 v[244:247], v114 offset:576
    v_cmp_ne_u32 vcc, s6, v14
    s_nop 0
    s_cbranch_vccnz retry_20
ready_21:
    v_mfma_f32_16x16x32_bf16 v[224:227], a[36:39], v[192:195], v[224:227]
    buffer_load_dwordx4 a[144:147], v115, s[12:15], s95 offen sc1
    s_add_u32 s95, s95, 32768
    v_mfma_f32_16x16x32_bf16 v[228:231], a[40:43], v[188:191], v[228:231]
    ds_read_b128 v[180:183], v15 offset:18432
    ds_read_b128 v[184:187], v15 offset:19456
    v_mfma_f32_16x16x32_bf16 v[232:235], a[40:43], v[192:195], v[232:235]
    s_add_u32 s22, s22, 128
    s_lshl_b32 s39, s3, 11
    s_add_u32 s38, s10, s39
    s_add_u32 s38, s38, 0x1000
    s_add_u32 m0, s39, 81920
    s_nop 0
    buffer_load_dwordx4 v15, s[12:15], s38 offen offset:0 sc1 lds
    v_mfma_f32_16x16x32_bf16 v[236:239], a[44:47], v[188:191], v[236:239]
    v_mfma_f32_16x16x32_bf16 v[240:243], a[44:47], v[192:195], v[240:243]
    s_waitcnt lgkmcnt(3)
    v_mfma_f32_16x16x32_bf16 v[220:223], a[48:51], v[196:199], v[220:223]
    buffer_load_dwordx4 v15, s[12:15], s38 offen offset:1024 sc1 lds
    ds_read_b128 v[248:251], v114 offset:640
    v_mfma_f32_16x16x32_bf16 v[224:227], a[48:51], v[200:203], v[224:227]
    ds_read_b128 v[188:191], v15 offset:20480
    ds_read_b128 v[192:195], v15 offset:21504
    v_mfma_f32_16x16x32_bf16 v[164:167], a[48:51], v[152:155], v[164:167]
    buffer_load_dwordx4 a[148:151], v115, s[12:15], s95 offen sc1
    s_add_u32 s95, s95, 32768
    v_mfma_f32_16x16x32_bf16 v[228:231], a[52:55], v[196:199], v[228:231]
    v_mfma_f32_16x16x32_bf16 v[232:235], a[52:55], v[200:203], v[232:235]
    v_mfma_f32_16x16x32_bf16 v[168:171], a[52:55], v[152:155], v[168:171]
    v_mfma_f32_16x16x32_bf16 v[236:239], a[56:59], v[196:199], v[236:239]
    v_mfma_f32_16x16x32_bf16 v[240:243], a[56:59], v[200:203], v[240:243]
    v_mfma_f32_16x16x32_bf16 v[172:175], a[56:59], v[152:155], v[172:175]
    s_waitcnt lgkmcnt(3)
    v_mfma_f32_16x16x32_bf16 v[220:223], a[60:63], v[180:183], v[220:223]
    ds_read_b128 v[152:155], v114 offset:704
    buffer_load_dwordx4 a[152:155], v115, s[12:15], s95 offen sc1
    s_add_u32 s95, s95, 32768
    v_mfma_f32_16x16x32_bf16 v[224:227], a[60:63], v[184:187], v[224:227]
    ds_read_b128 v[196:199], v15 offset:22528
    v_mfma_f32_16x16x32_bf16 v[164:167], a[60:63], v[244:247], v[164:167]
    ds_read_b128 v[200:203], v15 offset:23552
    buffer_load_dwordx4 a[156:159], v115, s[12:15], s95 offen sc1
    s_add_u32 s95, s95, 32768
    v_mfma_f32_16x16x32_bf16 v[228:231], a[64:67], v[180:183], v[228:231]
    v_mfma_f32_16x16x32_bf16 v[232:235], a[64:67], v[184:187], v[232:235]
    v_mfma_f32_16x16x32_bf16 v[168:171], a[64:67], v[244:247], v[168:171]
    v_mfma_f32_16x16x32_bf16 v[236:239], a[68:71], v[180:183], v[236:239]
    v_mfma_f32_16x16x32_bf16 v[240:243], a[68:71], v[184:187], v[240:243]
    v_mfma_f32_16x16x32_bf16 v[172:175], a[68:71], v[244:247], v[172:175]
    s_waitcnt lgkmcnt(3)
    v_mfma_f32_16x16x32_bf16 v[220:223], a[72:75], v[188:191], v[220:223]
    ds_read_b128 v[244:247], v114 offset:768
    ds_read_b128 v[180:183], v15 offset:24576
    v_mfma_f32_16x16x32_bf16 v[224:227], a[72:75], v[192:195], v[224:227]
    buffer_load_dwordx4 a[160:163], v115, s[12:15], s95 offen sc1
    s_add_u32 s95, s95, 32768
    v_mfma_f32_16x16x32_bf16 v[164:167], a[72:75], v[248:251], v[164:167]
    ds_read_b128 v[184:187], v15 offset:25600
    s_waitcnt vmcnt(4)
    s_barrier
    v_mfma_f32_16x16x32_bf16 v[228:231], a[76:79], v[188:191], v[228:231]
    v_mfma_f32_16x16x32_bf16 v[232:235], a[76:79], v[192:195], v[232:235]
    buffer_load_dwordx4 a[164:167], v115, s[12:15], s95 offen sc1
    s_add_u32 s95, s95, 32768
    v_mfma_f32_16x16x32_bf16 v[168:171], a[76:79], v[248:251], v[168:171]
    ds_read_b128 v[20:23], v16 offset:16384
    ds_read_b128 v[24:27], v16 offset:17408
    v_mfma_f32_16x16x32_bf16 v[236:239], a[80:83], v[188:191], v[236:239]
    ds_read_b128 v[28:31], v16 offset:18432
    ds_read_b128 v[32:35], v16 offset:19456
    v_mfma_f32_16x16x32_bf16 v[240:243], a[80:83], v[192:195], v[240:243]
    buffer_load_dwordx4 a[168:171], v115, s[12:15], s95 offen sc1
    s_add_u32 s95, s95, 32768
    v_mfma_f32_16x16x32_bf16 v[172:175], a[80:83], v[248:251], v[172:175]
    ds_read_b128 v[204:207], v16 offset:20480
    ds_read_b128 v[208:211], v16 offset:21504
    s_waitcnt lgkmcnt(9)
    v_mfma_f32_16x16x32_bf16 v[220:223], a[84:87], v[196:199], v[220:223]
    ds_read_b128 v[212:215], v16 offset:22528
    ds_read_b128 v[248:251], v114 offset:832
    v_mfma_f32_16x16x32_bf16 v[224:227], a[84:87], v[200:203], v[224:227]
    ds_read_b128 v[216:219], v16 offset:23552
    ds_read_b128 v[188:191], v15 offset:26624
    v_mfma_f32_16x16x32_bf16 v[164:167], a[84:87], v[152:155], v[164:167]
    buffer_load_dword v14, v3, s[12:15], s22 offen sc1
    ds_read_b128 v[192:195], v15 offset:27648
    v_mfma_f32_16x16x32_bf16 v[228:231], a[88:91], v[196:199], v[228:231]
    buffer_load_dwordx4 a[172:175], v115, s[12:15], s95 offen sc1
    s_add_u32 s95, s95, 32768
    v_mfma_f32_16x16x32_bf16 v[232:235], a[88:91], v[200:203], v[232:235]
    s_waitcnt lgkmcnt(6)
    v_add_f32 v20, v20, v204
    v_add_f32 v21, v21, v205
    v_mfma_f32_16x16x32_bf16 v[168:171], a[88:91], v[152:155], v[168:171]
    v_add_f32 v22, v22, v206
    v_mfma_f32_16x16x32_bf16 v[236:239], a[92:95], v[196:199], v[236:239]
    v_mfma_f32_16x16x32_bf16 v[240:243], a[92:95], v[200:203], v[240:243]
    v_mfma_f32_16x16x32_bf16 v[172:175], a[92:95], v[152:155], v[172:175]
    v_mfma_f32_16x16x32_bf16 v[220:223], a[96:99], v[180:183], v[220:223]
    s_waitcnt lgkmcnt(5)
    v_add_f32 v24, v24, v208
    ds_read_b128 v[152:155], v114 offset:896
    v_mfma_f32_16x16x32_bf16 v[224:227], a[96:99], v[184:187], v[224:227]
    v_add_f32 v25, v25, v209
    v_add_f32 v26, v26, v210
    ds_read_b128 v[196:199], v15 offset:28672
    v_mfma_f32_16x16x32_bf16 v[164:167], a[96:99], v[244:247], v[164:167]
    s_waitcnt lgkmcnt(6)
    v_add_f32 v28, v28, v212
    buffer_load_dwordx4 a[176:179], v115, s[12:15], s95 offen sc1
    s_add_u32 s95, s95, 32768
    v_mfma_f32_16x16x32_bf16 v[228:231], a[100:103], v[180:183], v[228:231]
    ds_read_b128 v[200:203], v15 offset:29696
    v_add_f32 v29, v29, v213
    v_mfma_f32_16x16x32_bf16 v[232:235], a[100:103], v[184:187], v[232:235]
    v_add_f32 v30, v30, v214
    s_waitcnt lgkmcnt(5)
    v_add_f32 v32, v32, v216
    v_mfma_f32_16x16x32_bf16 v[168:171], a[100:103], v[244:247], v[168:171]
    v_add_f32 v33, v33, v217
    v_add_f32 v34, v34, v218
    v_add_f32 v20, v20, v28
    v_mfma_f32_16x16x32_bf16 v[236:239], a[104:107], v[180:183], v[236:239]
    v_add_f32 v21, v21, v29
    buffer_load_dwordx4 a[180:183], v115, s[12:15], s95 offen sc1
    s_add_u32 s95, s95, 32768
    v_mfma_f32_16x16x32_bf16 v[240:243], a[104:107], v[184:187], v[240:243]
    v_add_f32 v22, v22, v30
    v_add_f32 v24, v24, v32
    v_mfma_f32_16x16x32_bf16 v[172:175], a[104:107], v[244:247], v[172:175]
    v_add_f32 v25, v25, v33
    v_add_f32 v26, v26, v34
    s_waitcnt lgkmcnt(3)
    v_mfma_f32_16x16x32_bf16 v[220:223], a[108:111], v[188:191], v[220:223]
    v_add_f32 v20, v20, v24
    ds_read_b128 v[244:247], v114 offset:960
    v_mfma_f32_16x16x32_bf16 v[224:227], a[108:111], v[192:195], v[224:227]
    v_add_f32 v21, v21, v25
    ds_read_b128 v[180:183], v15 offset:30720
    buffer_load_dwordx4 a[184:187], v115, s[12:15], s95 offen sc1
    s_add_u32 s95, s95, 32768
    v_mfma_f32_16x16x32_bf16 v[164:167], a[108:111], v[248:251], v[164:167]
    v_add_f32 v22, v22, v26
    v_mfma_f32_16x16x32_bf16 v[228:231], a[112:115], v[188:191], v[228:231]
    ds_read_b128 v[184:187], v15 offset:31744
    v_mul_f32 v20, 0x3b000000, v20
    v_mul_f32 v21, 0x3b000000, v21
    v_mfma_f32_16x16x32_bf16 v[232:235], a[112:115], v[192:195], v[232:235]
    v_mul_f32 v22, 0x3b000000, v22
    v_mov_b32 v24, v20
    v_mfma_f32_16x16x32_bf16 v[168:171], a[112:115], v[248:251], v[168:171]
    v_mov_b32 v25, v21
    v_mov_b32 v26, v22
    buffer_load_dwordx4 a[188:191], v115, s[12:15], s95 offen sc1
    s_add_u32 s95, s95, 32768
    v_mfma_f32_16x16x32_bf16 v[236:239], a[116:119], v[188:191], v[236:239]
    v_permlane32_swap_b32 v20, v24
    v_mfma_f32_16x16x32_bf16 v[240:243], a[116:119], v[192:195], v[240:243]
    v_permlane32_swap_b32 v21, v25
    v_mfma_f32_16x16x32_bf16 v[172:175], a[116:119], v[248:251], v[172:175]
    v_permlane32_swap_b32 v22, v26
    s_waitcnt lgkmcnt(3)
    v_mfma_f32_16x16x32_bf16 v[220:223], a[120:123], v[196:199], v[220:223]
    v_fma_f32 v24, -v20, v20, v24
    v_max_f32 v24, 0, v24
    v_mfma_f32_16x16x32_bf16 v[224:227], a[120:123], v[200:203], v[224:227]
    buffer_load_dwordx4 a[192:195], v115, s[12:15], s95 offen sc1
    s_add_u32 s95, s95, 32768
    v_mfma_f32_16x16x32_bf16 v[164:167], a[120:123], v[152:155], v[164:167]
    v_add_f32 v24, 0x3727c5ac, v24
    v_rsq_f32 v28, v24
    v_mfma_f32_16x16x32_bf16 v[228:231], a[124:127], v[196:199], v[228:231]
    v_fma_f32 v21, -v20, s84, v21
    v_mul_f32 v31, s85, v20
    v_mfma_f32_16x16x32_bf16 v[232:235], a[124:127], v[200:203], v[232:235]
    v_fma_f32 v29, v28, v21, s87
    v_fma_f32 v31, v22, -2.0, v31
    v_mfma_f32_16x16x32_bf16 v[168:171], a[124:127], v[152:155], v[168:171]
    v_fma_f32 v25, v20, v31, v25
    v_fma_f32 v26, -v20, s86, v26
    v_mfma_f32_16x16x32_bf16 v[236:239], a[128:131], v[196:199], v[236:239]
    buffer_load_dwordx4 a[196:199], v115, s[12:15], s95 offen sc1
    s_add_u32 s95, s95, 32768
    v_mfma_f32_16x16x32_bf16 v[240:243], a[128:131], v[200:203], v[240:243]
    v_add_f32 v26, v26, v26
    v_fma_f32 v30, v28, v25, v26
    v_mfma_f32_16x16x32_bf16 v[172:175], a[128:131], v[152:155], v[172:175]
    v_fma_f32 v30, v28, v30, s88
    v_fma_f32 v30, -v29, v29, v30
    v_max_f32 v30, 0, v30
    v_add_f32 v30, 0x3727c5ac, v30
    s_waitcnt lgkmcnt(0)
    v_mfma_f32_16x16x32_bf16 v[220:223], a[132:135], v[180:183], v[220:223]
    v_rsq_f32 v158, v30
    buffer_load_dwordx4 a[200:203], v115, s[12:15], s95 offen sc1
    s_add_u32 s95, s95, 32768
    v_mul_f32 v156, v28, v158
    v_mul_f32 v162, -v29, v158
    v_mul_f32 v160, -v20, v156
    v_mov_b32 v157, v156
    v_mfma_f32_16x16x32_bf16 v[224:227], a[132:135], v[184:187], v[224:227]
    v_mov_b32 v159, v158
    v_mov_b32 v161, v160
    v_mov_b32 v163, v162
    v_permlane16_swap_b32 v156, v157
    buffer_load_dwordx4 a[204:207], v115, s[12:15], s95 offen sc1
    s_add_u32 s95, s95, 32768
    s_waitcnt vmcnt(9)
    v_cmp_ne_u32 vcc, s6, v14
    s_nop 0
    s_cbranch_vccnz retry_22
ready_23:
    v_mfma_f32_16x16x32_bf16 v[164:167], a[132:135], v[244:247], v[164:167]
    v_permlane16_swap_b32 v158, v159
    s_add_u32 s22, s22, 128
    s_lshl_b32 s39, s3, 11
    s_add_u32 s38, s10, s39
    s_add_u32 s38, s38, 0x3000
    s_add_u32 m0, s39, 139264
    s_nop 0
    buffer_load_dwordx4 v15, s[12:15], s38 offen offset:0 sc1 lds
    v_permlane16_swap_b32 v160, v161
    v_mfma_f32_16x16x32_bf16 v[228:231], a[136:139], v[180:183], v[228:231]
    buffer_load_dwordx4 v15, s[12:15], s38 offen offset:1024 sc1 lds
    s_lshl_b32 s39, s3, 12
    s_add_u32 s38, s10, s39
    s_add_u32 s38, s38, 0x4a800
    s_add_u32 m0, s39, 32768
    s_nop 0
    buffer_load_dwordx4 v15, s[12:15], s38 offen offset:0 sc1 lds
    v_permlane16_swap_b32 v162, v163
    v_mfma_f32_16x16x32_bf16 v[232:235], a[136:139], v[184:187], v[232:235]
    v_mov_b32_dpp v132, v164 row_newbcast:0 row_mask:0xf bank_mask:0xf
    v_mov_b32_dpp v133, v165 row_newbcast:0 row_mask:0xf bank_mask:0xf
    v_mov_b32_dpp v134, v166 row_newbcast:0 row_mask:0xf bank_mask:0xf
    v_mov_b32_dpp v135, v167 row_newbcast:0 row_mask:0xf bank_mask:0xf
    v_mfma_f32_16x16x32_bf16 v[168:171], a[136:139], v[244:247], v[168:171]
    s_nop 7
    v_mov_b32_dpp v136, v168 row_newbcast:0 row_mask:0xf bank_mask:0xf
    v_mov_b32_dpp v137, v169 row_newbcast:0 row_mask:0xf bank_mask:0xf
    v_mov_b32_dpp v138, v170 row_newbcast:0 row_mask:0xf bank_mask:0xf
    v_mov_b32_dpp v139, v171 row_newbcast:0 row_mask:0xf bank_mask:0xf
    v_mfma_f32_16x16x32_bf16 v[236:239], a[140:143], v[180:183], v[236:239]
    v_mfma_f32_16x16x32_bf16 v[240:243], a[140:143], v[184:187], v[240:243]
    v_mfma_f32_16x16x32_bf16 v[172:175], a[140:143], v[244:247], v[172:175]
    s_nop 7
    s_nop 0
    v_mov_b32_dpp v140, v172 row_newbcast:0 row_mask:0xf bank_mask:0xf
    v_mov_b32_dpp v141, v173 row_newbcast:0 row_mask:0xf bank_mask:0xf
    v_mov_b32_dpp v142, v174 row_newbcast:0 row_mask:0xf bank_mask:0xf
    v_mov_b32_dpp v143, v175 row_newbcast:0 row_mask:0xf bank_mask:0xf
    v_mov_b32_dpp v144, v164 row_newbcast:1 row_mask:0xf bank_mask:0xf
    v_mov_b32_dpp v145, v165 row_newbcast:1 row_mask:0xf bank_mask:0xf
    v_mov_b32_dpp v146, v166 row_newbcast:1 row_mask:0xf bank_mask:0xf
    v_mov_b32_dpp v147, v167 row_newbcast:1 row_mask:0xf bank_mask:0xf
    buffer_load_dwordx4 a[208:211], v115, s[12:15], s95 offen sc1
    s_add_u32 s95, s95, 32768
    v_mov_b32_dpp v148, v168 row_newbcast:1 row_mask:0xf bank_mask:0xf
    v_mov_b32_dpp v149, v169 row_newbcast:1 row_mask:0xf bank_mask:0xf
    v_mov_b32_dpp v150, v170 row_newbcast:1 row_mask:0xf bank_mask:0xf
    v_mov_b32_dpp v151, v171 row_newbcast:1 row_mask:0xf bank_mask:0xf
    v_mov_b32_dpp v152, v172 row_newbcast:1 row_mask:0xf bank_mask:0xf
    v_mov_b32_dpp v153, v173 row_newbcast:1 row_mask:0xf bank_mask:0xf
    v_mov_b32_dpp v154, v174 row_newbcast:1 row_mask:0xf bank_mask:0xf
    v_mov_b32_dpp v155, v175 row_newbcast:1 row_mask:0xf bank_mask:0xf
    v_mov_b32_dpp v164, v164 row_newbcast:2 row_mask:0xf bank_mask:0xf
    v_mov_b32_dpp v165, v165 row_newbcast:2 row_mask:0xf bank_mask:0xf
    v_mov_b32_dpp v166, v166 row_newbcast:2 row_mask:0xf bank_mask:0xf
    v_mov_b32_dpp v167, v167 row_newbcast:2 row_mask:0xf bank_mask:0xf
    v_mov_b32_dpp v168, v168 row_newbcast:2 row_mask:0xf bank_mask:0xf
    v_mov_b32_dpp v169, v169 row_newbcast:2 row_mask:0xf bank_mask:0xf
    v_mov_b32_dpp v170, v170 row_newbcast:2 row_mask:0xf bank_mask:0xf
    v_mov_b32_dpp v171, v171 row_newbcast:2 row_mask:0xf bank_mask:0xf
    v_mov_b32_dpp v172, v172 row_newbcast:2 row_mask:0xf bank_mask:0xf
    buffer_load_dwordx4 a[212:215], v115, s[12:15], s95 offen sc1
    s_add_u32 s95, s95, 32768
    v_mov_b32_dpp v173, v173 row_newbcast:2 row_mask:0xf bank_mask:0xf
    v_mov_b32_dpp v174, v174 row_newbcast:2 row_mask:0xf bank_mask:0xf
    v_mov_b32_dpp v175, v175 row_newbcast:2 row_mask:0xf bank_mask:0xf
    s_getpc_b64 s[40:41]
L_pf4:
    s_nop 0
    v_min_u32 v19, pf_last4, v0
    global_load_dword v18, v19, s[40:41]
    buffer_load_dwordx4 v15, s[12:15], s38 offen offset:1024 sc1 lds
    v_pk_fma_f32 v[220:221], v[220:221], v[156:157], v[120:121] op_sel:[0,0,0] op_sel_hi:[1,0,1]
    v_pk_fma_f32 v[222:223], v[222:223], v[156:157], v[122:123] op_sel:[0,0,0] op_sel_hi:[1,0,1]
    v_pk_fma_f32 v[224:225], v[224:225], v[156:157], v[120:121] op_sel:[0,1,0] op_sel_hi:[1,1,1]
    v_pk_fma_f32 v[226:227], v[226:227], v[156:157], v[122:123] op_sel:[0,1,0] op_sel_hi:[1,1,1]
    v_pk_fma_f32 v[220:221], v[132:133], v[158:159], v[220:221] op_sel:[0,0,0] op_sel_hi:[1,0,1]
    v_pk_fma_f32 v[222:223], v[134:135], v[158:159], v[222:223] op_sel:[0,0,0] op_sel_hi:[1,0,1]
    v_pk_fma_f32 v[224:225], v[132:133], v[158:159], v[224:225] op_sel:[0,1,0] op_sel_hi:[1,1,1]
    v_pk_fma_f32 v[226:227], v[134:135], v[158:159], v[226:227] op_sel:[0,1,0] op_sel_hi:[1,1,1]
    v_pk_fma_f32 v[220:221], v[144:145], v[160:161], v[220:221] op_sel:[0,0,0] op_sel_hi:[1,0,1]
    v_pk_fma_f32 v[222:223], v[146:147], v[160:161], v[222:223] op_sel:[0,0,0] op_sel_hi:[1,0,1]
    buffer_load_dwordx4 v15, s[12:15], s38 offen offset:2048 sc1 lds
    v_pk_fma_f32 v[224:225], v[144:145], v[160:161], v[224:225] op_sel:[0,1,0] op_sel_hi:[1,1,1]
    v_pk_fma_f32 v[226:227], v[146:147], v[160:161], v[226:227] op_sel:[0,1,0] op_sel_hi:[1,1,1]
    v_pk_fma_f32 v[220:221], v[164:165], v[162:163], v[220:221] op_sel:[0,0,0] op_sel_hi:[1,0,1]
    v_pk_fma_f32 v[222:223], v[166:167], v[162:163], v[222:223] op_sel:[0,0,0] op_sel_hi:[1,0,1]
    v_pk_fma_f32 v[224:225], v[164:165], v[162:163], v[224:225] op_sel:[0,1,0] op_sel_hi:[1,1,1]
    v_pk_fma_f32 v[226:227], v[166:167], v[162:163], v[226:227] op_sel:[0,1,0] op_sel_hi:[1,1,1]
    v_pk_mul_f32 v[20:21], v[220:221], v[220:221]
    v_pk_mul_f32 v[22:23], v[222:223], v[222:223]
    v_pk_mul_f32 v[24:25], v[224:225], v[224:225]
    buffer_load_dwordx4 v15, s[12:15], s38 offen offset:3072 sc1 lds
    s_add_u32 s38, s38, 16384
    v_pk_mul_f32 v[26:27], v[226:227], v[226:227]
    v_pk_fma_f32 v[20:21], v[20:21], s[42:43], s[42:43] op_sel:[0,0,1] op_sel_hi:[1,0,1]
    v_pk_fma_f32 v[22:23], v[22:23], s[42:43], s[42:43] op_sel:[0,0,1] op_sel_hi:[1,0,1]
    v_pk_fma_f32 v[24:25], v[24:25], s[42:43], s[42:43] op_sel:[0,0,1] op_sel_hi:[1,0,1]
    v_pk_fma_f32 v[26:27], v[26:27], s[42:43], s[42:43] op_sel:[0,0,1] op_sel_hi:[1,0,1]
    v_pk_mul_f32 v[20:21], v[20:21], v[220:221]
    v_pk_mul_f32 v[22:23], v[22:23], v[222:223]
    v_pk_mul_f32 v[24:25], v[24:25], v[224:225]
    v_pk_mul_f32 v[26:27], v[26:27], v[226:227]
    v_exp_f32 v20, v20
    v_exp_f32 v21, v21
    v_exp_f32 v22, v22
    v_exp_f32 v23, v23
    v_exp_f32 v24, v24
    s_add_u32 m0, s39, 49152
    s_nop 0
    buffer_load_dwordx4 v15, s[12:15], s38 offen offset:0 sc1 lds
    v_exp_f32 v25, v25
    v_exp_f32 v26, v26
    v_exp_f32 v27, v27
    v_pk_add_f32 v[20:21], v[20:21], 1.0 op_sel_hi:[1,0]
    v_pk_add_f32 v[22:23], v[22:23], 1.0 op_sel_hi:[1,0]
    v_pk_add_f32 v[24:25], v[24:25], 1.0 op_sel_hi:[1,0]
    v_pk_add_f32 v[26:27], v[26:27], 1.0 op_sel_hi:[1,0]
    v_rcp_f32 v20, v20
    v_rcp_f32 v21, v21
    v_rcp_f32 v22, v22
    v_rcp_f32 v23, v23
    v_rcp_f32 v24, v24
    buffer_load_dwordx4 v15, s[12:15], s38 offen offset:1024 sc1 lds
    v_rcp_f32 v25, v25
    v_rcp_f32 v26, v26
    v_rcp_f32_e64 v27, v27
    v_pk_mul_f32 v[20:21], v[20:21], v[220:221]
    v_pk_mul_f32 v[22:23], v[22:23], v[222:223]
    buffer_load_dwordx4 v15, s[12:15], s38 offen offset:2048 sc1 lds
    v_pk_mul_f32 v[24:25], v[24:25], v[224:225]
    v_pk_mul_f32 v[26:27], v[26:27], v[226:227]
    v_cvt_pk_bf16_f32 v204, v20, v21
    v_cvt_pk_bf16_f32 v206, v24, v25
    v_cvt_pk_bf16_f32 v205, v22, v23
    v_cvt_pk_bf16_f32 v207, v26, v27
    v_permlane16_swap_b32 v204, v206
    s_nop 0
    v_permlane16_swap_b32 v205, v207
    s_nop 0
    buffer_load_dwordx4 v15, s[12:15], s38 offen offset:3072 sc1 lds
    s_add_u32 s38, s38, 16384
    buffer_store_dwordx4 v[204:207], v5, s[12:15], s76 offen nt
    s_add_u32 s76, s76, 88064
    v_pk_fma_f32 v[228:229], v[228:229], v[156:157], v[124:125] op_sel:[0,0,0] op_sel_hi:[1,0,1]
    v_pk_fma_f32 v[230:231], v[230:231], v[156:157], v[126:127] op_sel:[0,0,0] op_sel_hi:[1,0,1]
    v_pk_fma_f32 v[232:233], v[232:233], v[156:157], v[124:125] op_sel:[0,1,0] op_sel_hi:[1,1,1]
    v_pk_fma_f32 v[234:235], v[234:235], v[156:157], v[126:127] op_sel:[0,1,0] op_sel_hi:[1,1,1]
    v_pk_fma_f32 v[228:229], v[136:137], v[158:159], v[228:229] op_sel:[0,0,0] op_sel_hi:[1,0,1]
    v_pk_fma_f32 v[230:231], v[138:139], v[158:159], v[230:231] op_sel:[0,0,0] op_sel_hi:[1,0,1]
    v_pk_fma_f32 v[232:233], v[136:137], v[158:159], v[232:233] op_sel:[0,1,0] op_sel_hi:[1,1,1]
    v_pk_fma_f32 v[234:235], v[138:139], v[158:159], v[234:235] op_sel:[0,1,0] op_sel_hi:[1,1,1]
    v_pk_fma_f32 v[228:229], v[148:149], v[160:161], v[228:229] op_sel:[0,0,0] op_sel_hi:[1,0,1]
    v_pk_fma_f32 v[230:231], v[150:151], v[160:161], v[230:231] op_sel:[0,0,0] op_sel_hi:[1,0,1]
    v_pk_fma_f32 v[232:233], v[148:149], v[160:161], v[232:233] op_sel:[0,1,0] op_sel_hi:[1,1,1]
    v_pk_fma_f32 v[234:235], v[150:151], v[160:161], v[234:235] op_sel:[0,1,0] op_sel_hi:[1,1,1]
    v_pk_fma_f32 v[228:229], v[168:169], v[162:163], v[228:229] op_sel:[0,0,0] op_sel_hi:[1,0,1]
    v_pk_fma_f32 v[230:231], v[170:171], v[162:163], v[230:231] op_sel:[0,0,0] op_sel_hi:[1,0,1]
    v_pk_fma_f32 v[232:233], v[168:169], v[162:163], v[232:233] op_sel:[0,1,0] op_sel_hi:[1,1,1]
    v_pk_fma_f32 v[234:235], v[170:171], v[162:163], v[234:235] op_sel:[0,1,0] op_sel_hi:[1,1,1]
    v_pk_mul_f32 v[28:29], v[228:229], v[228:229]
    v_pk_mul_f32 v[30:31], v[230:231], v[230:231]
    v_pk_mul_f32 v[32:33], v[232:233], v[232:233]
    v_pk_mul_f32 v[34:35], v[234:235], v[234:235]
    v_pk_fma_f32 v[28:29], v[28:29], s[42:43], s[42:43] op_sel:[0,0,1] op_sel_hi:[1,0,1]
    v_pk_fma_f32 v[30:31], v[30:31], s[42:43], s[42:43] op_sel:[0,0,1] op_sel_hi:[1,0,1]
    v_pk_fma_f32 v[32:33], v[32:33], s[42:43], s[42:43] op_sel:[0,0,1] op_sel_hi:[1,0,1]
    v_pk_fma_f32 v[34:35], v[34:35], s[42:43], s[42:43] op_sel:[0,0,1] op_sel_hi:[1,0,1]
    v_pk_mul_f32 v[28:29], v[28:29], v[228:229]
    v_pk_mul_f32 v[30:31], v[30:31], v[230:231]
    v_pk_mul_f32 v[32:33], v[32:33], v[232:233]
    v_pk_mul_f32 v[34:35], v[34:35], v[234:235]
    v_exp_f32 v28, v28
    v_exp_f32 v29, v29
    v_exp_f32 v30, v30
    v_exp_f32 v31, v31
    v_exp_f32 v32, v32
    v_exp_f32 v33, v33
    buffer_load_dwordx4 a[216:219], v115, s[12:15], s95 offen sc1
    s_add_u32 s95, s95, 32768
    v_exp_f32 v34, v34
    v_exp_f32 v35, v35
    v_pk_add_f32 v[28:29], v[28:29], 1.0 op_sel_hi:[1,0]
    v_pk_add_f32 v[30:31], v[30:31], 1.0 op_sel_hi:[1,0]
    v_pk_add_f32 v[32:33], v[32:33], 1.0 op_sel_hi:[1,0]
    v_pk_add_f32 v[34:35], v[34:35], 1.0 op_sel_hi:[1,0]
    v_rcp_f32 v28, v28
    v_rcp_f32 v29, v29
    v_rcp_f32 v30, v30
    v_rcp_f32 v31, v31
    v_rcp_f32 v32, v32
    v_rcp_f32 v33, v33
    buffer_load_dwordx4 a[220:223], v115, s[12:15], s95 offen sc1
    s_add_u32 s95, s95, 32768
    v_rcp_f32 v34, v34
    v_rcp_f32 v35, v35
    v_pk_mul_f32 v[28:29], v[28:29], v[228:229]
    v_pk_mul_f32 v[30:31], v[30:31], v[230:231]
    v_pk_mul_f32 v[32:33], v[32:33], v[232:233]
    v_pk_mul_f32 v[34:35], v[34:35], v[234:235]
    v_cvt_pk_bf16_f32 v208, v28, v29
    v_cvt_pk_bf16_f32 v210, v32, v33
    v_cvt_pk_bf16_f32 v209, v30, v31
    v_cvt_pk_bf16_f32 v211, v34, v35
    v_permlane16_swap_b32 v208, v210
    s_nop 0
    v_permlane16_swap_b32 v209, v211
    s_nop 0
    buffer_store_dwordx4 v[208:211], v5, s[12:15], s77 offen sc1
    s_add_u32 s77, s77, 88064
    v_pk_fma_f32 v[236:237], v[236:237], v[156:157], v[128:129] op_sel:[0,0,0] op_sel_hi:[1,0,1]
    v_pk_fma_f32 v[238:239], v[238:239], v[156:157], v[130:131] op_sel:[0,0,0] op_sel_hi:[1,0,1]
    v_pk_fma_f32 v[240:241], v[240:241], v[156:157], v[128:129] op_sel:[0,1,0] op_sel_hi:[1,1,1]
    v_pk_fma_f32 v[242:243], v[242:243], v[156:157], v[130:131] op_sel:[0,1,0] op_sel_hi:[1,1,1]
    v_pk_fma_f32 v[236:237], v[140:141], v[158:159], v[236:237] op_sel:[0,0,0] op_sel_hi:[1,0,1]
    v_pk_fma_f32 v[238:239], v[142:143], v[158:159], v[238:239] op_sel:[0,0,0] op_sel_hi:[1,0,1]
    v_pk_fma_f32 v[240:241], v[140:141], v[158:159], v[240:241] op_sel:[0,1,0] op_sel_hi:[1,1,1]
    v_pk_fma_f32 v[242:243], v[142:143], v[158:159], v[242:243] op_sel:[0,1,0] op_sel_hi:[1,1,1]
    v_pk_fma_f32 v[236:237], v[152:153], v[160:161], v[236:237] op_sel:[0,0,0] op_sel_hi:[1,0,1]
    v_pk_fma_f32 v[238:239], v[154:155], v[160:161], v[238:239] op_sel:[0,0,0] op_sel_hi:[1,0,1]
    v_pk_fma_f32 v[240:241], v[152:153], v[160:161], v[240:241] op_sel:[0,1,0] op_sel_hi:[1,1,1]
    v_pk_fma_f32 v[242:243], v[154:155], v[160:161], v[242:243] op_sel:[0,1,0] op_sel_hi:[1,1,1]
    v_pk_fma_f32 v[236:237], v[172:173], v[162:163], v[236:237] op_sel:[0,0,0] op_sel_hi:[1,0,1]
    v_pk_fma_f32 v[238:239], v[174:175], v[162:163], v[238:239] op_sel:[0,0,0] op_sel_hi:[1,0,1]
    v_pk_fma_f32 v[240:241], v[172:173], v[162:163], v[240:241] op_sel:[0,1,0] op_sel_hi:[1,1,1]
    v_pk_fma_f32 v[242:243], v[174:175], v[162:163], v[242:243] op_sel:[0,1,0] op_sel_hi:[1,1,1]
    v_pk_mul_f32 v[20:21], v[236:237], v[236:237]
    v_pk_mul_f32 v[22:23], v[238:239], v[238:239]
    buffer_load_dwordx4 a[224:227], v115, s[12:15], s95 offen sc1
    s_add_u32 s95, s95, 32768
    v_pk_mul_f32 v[24:25], v[240:241], v[240:241]
    v_pk_mul_f32 v[26:27], v[242:243], v[242:243]
    v_pk_fma_f32 v[20:21], v[20:21], s[42:43], s[42:43] op_sel:[0,0,1] op_sel_hi:[1,0,1]
    v_pk_fma_f32 v[22:23], v[22:23], s[42:43], s[42:43] op_sel:[0,0,1] op_sel_hi:[1,0,1]
    v_pk_fma_f32 v[24:25], v[24:25], s[42:43], s[42:43] op_sel:[0,0,1] op_sel_hi:[1,0,1]
    v_pk_fma_f32 v[26:27], v[26:27], s[42:43], s[42:43] op_sel:[0,0,1] op_sel_hi:[1,0,1]
    v_pk_mul_f32 v[20:21], v[20:21], v[236:237]
    v_pk_mul_f32 v[22:23], v[22:23], v[238:239]
    v_pk_mul_f32 v[24:25], v[24:25], v[240:241]
    v_pk_mul_f32 v[26:27], v[26:27], v[242:243]
    v_exp_f32 v20, v20
    v_exp_f32 v21, v21
    s_waitcnt vmcnt(9)
    s_barrier
    buffer_load_dwordx4 a[228:231], v115, s[12:15], s95 offen sc1
    s_add_u32 s95, s95, 32768
    v_exp_f32 v22, v22
    v_exp_f32 v23, v23
    v_exp_f32 v24, v24
    v_exp_f32 v25, v25
    v_exp_f32 v26, v26
    v_exp_f32 v27, v27
    ds_read_b128 v[180:183], v15 offset:32768
    v_pk_add_f32 v[20:21], v[20:21], 1.0 op_sel_hi:[1,0]
    v_pk_add_f32 v[22:23], v[22:23], 1.0 op_sel_hi:[1,0]
    ds_read_b128 v[184:187], v15 offset:33792
    v_pk_add_f32 v[24:25], v[24:25], 1.0 op_sel_hi:[1,0]
    buffer_load_dwordx4 a[232:235], v115, s[12:15], s95 offen sc1
    s_add_u32 s95, s95, 32768
    v_pk_add_f32 v[26:27], v[26:27], 1.0 op_sel_hi:[1,0]
    v_rcp_f32 v20, v20
    ds_read_b128 v[188:191], v15 offset:34816
    v_rcp_f32 v21, v21
    ds_read_b128 v[192:195], v15 offset:35840
    v_rcp_f32 v22, v22
    v_rcp_f32 v23, v23
    v_rcp_f32 v24, v24
    v_rcp_f32 v25, v25
    v_rcp_f32 v26, v26
    buffer_load_dwordx4 a[236:239], v115, s[12:15], s95 offen sc1
    s_add_u32 s95, s95, 32768
    v_rcp_f32 v27, v27
    v_pk_mul_f32 v[20:21], v[20:21], v[236:237]
    v_pk_mul_f32 v[22:23], v[22:23], v[238:239]
    v_pk_mul_f32 v[24:25], v[24:25], v[240:241]
    v_pk_mul_f32 v[26:27], v[26:27], v[242:243]
    v_cvt_pk_bf16_f32 v212, v20, v21
    v_cvt_pk_bf16_f32 v214, v24, v25
    v_cvt_pk_bf16_f32 v213, v22, v23
    v_cvt_pk_bf16_f32 v215, v26, v27
    v_permlane16_swap_b32 v212, v214
    s_nop 0
    v_permlane16_swap_b32 v213, v215
    buffer_store_dwordx4 v[212:215], v5, s[12:15], s78 offen sc1
    s_add_u32 s78, s78, 88064
    s_waitcnt lgkmcnt(2)
    v_mfma_f32_16x16x32_bf16 v[220:223], v[36:39], v[180:183], 0
    ds_read_b128 v[196:199], v15 offset:36864
    ds_read_b128 v[20:23], v17 offset:8192
    v_mfma_f32_16x16x32_bf16 v[224:227], v[36:39], v[184:187], 0
    ds_read_b128 v[200:203], v15 offset:37888
    ds_read_b128 v[24:27], v17 offset:9216
    v_mfma_f32_16x16x32_bf16 v[228:231], v[40:43], v[180:183], 0
    ds_read_b128 v[28:31], v17 offset:10240
    buffer_load_dwordx4 a[240:243], v115, s[12:15], s95 offen sc1
    s_add_u32 s95, s95, 32768
    v_mfma_f32_16x16x32_bf16 v[232:235], v[40:43], v[184:187], 0
    ds_read_b128 v[32:35], v17 offset:11264
    v_mfma_f32_16x16x32_bf16 v[236:239], v[44:47], v[180:183], 0
    ds_read_b128 v[204:207], v17 offset:12288
    v_mfma_f32_16x16x32_bf16 v[240:243], v[44:47], v[184:187], 0
    s_waitcnt lgkmcnt(7)
    v_mfma_f32_16x16x32_bf16 v[220:223], v[48:51], v[188:191], v[220:223]
    ds_read_b128 v[208:211], v17 offset:13312
    ds_read_b128 v[180:183], v15 offset:38912
    v_mfma_f32_16x16x32_bf16 v[224:227], v[48:51], v[192:195], v[224:227]
    ds_read_b128 v[212:215], v17 offset:14336
    ds_read_b128 v[184:187], v15 offset:39936
    v_mfma_f32_16x16x32_bf16 v[228:231], v[52:55], v[188:191], v[228:231]
    ds_read_b128 v[216:219], v17 offset:15360
    buffer_load_dwordx4 a[244:247], v115, s[12:15], s95 offen sc1
    s_add_u32 s95, s95, 32768
    v_mfma_f32_16x16x32_bf16 v[232:235], v[52:55], v[192:195], v[232:235]
    v_mfma_f32_16x16x32_bf16 v[236:239], v[56:59], v[188:191], v[236:239]
    v_mfma_f32_16x16x32_bf16 v[240:243], v[56:59], v[192:195], v[240:243]
    s_waitcnt lgkmcnt(9)
    v_mfma_f32_16x16x32_bf16 v[220:223], v[60:63], v[196:199], v[220:223]
    ds_read_b128 v[188:191], v15 offset:40960
    ds_read_b128 v[192:195], v15 offset:41984
    v_mfma_f32_16x16x32_bf16 v[224:227], v[60:63], v[200:203], v[224:227]
    buffer_load_dwordx4 a[248:251], v115, s[12:15], s95 offen sc1
    s_add_u32 s95, s95, 32768
    v_mfma_f32_16x16x32_bf16 v[228:231], v[64:67], v[196:199], v[228:231]
    s_waitcnt lgkmcnt(7)
    v_add_f32 v20, v20, v204
    v_add_f32 v21, v21, v205
    v_mfma_f32_16x16x32_bf16 v[232:235], v[64:67], v[200:203], v[232:235]
    v_add_f32 v22, v22, v206
    s_waitcnt lgkmcnt(6)
    v_add_f32 v24, v24, v208
    v_mfma_f32_16x16x32_bf16 v[236:239], v[68:71], v[196:199], v[236:239]
    v_mfma_f32_16x16x32_bf16 v[240:243], v[68:71], v[200:203], v[240:243]
    s_waitcnt lgkmcnt(3)
    v_mfma_f32_16x16x32_bf16 v[220:223], v[72:75], v[180:183], v[220:223]
    v_add_f32 v25, v25, v209
    ds_read_b128 v[196:199], v15 offset:43008
    v_mfma_f32_16x16x32_bf16 v[224:227], v[72:75], v[184:187], v[224:227]
    buffer_load_dwordx4 a[252:255], v115, s[12:15], s95 offen sc1
    s_add_u32 s95, s95, 32768
    v_mfma_f32_16x16x32_bf16 v[228:231], v[76:79], v[180:183], v[228:231]
    v_add_f32 v26, v26, v210
    ds_read_b128 v[200:203], v15 offset:44032
    v_mfma_f32_16x16x32_bf16 v[232:235], v[76:79], v[184:187], v[232:235]
    v_add_f32 v28, v28, v212
    v_add_f32 v29, v29, v213
    v_mfma_f32_16x16x32_bf16 v[236:239], v[80:83], v[180:183], v[236:239]
    v_add_f32 v30, v30, v214
    buffer_load_dwordx4 v[36:39], v115, s[12:15], s95 offen sc1
    s_add_u32 s95, s95, 32768
    v_mfma_f32_16x16x32_bf16 v[240:243], v[80:83], v[184:187], v[240:243]
    s_waitcnt lgkmcnt(2)
    v_mfma_f32_16x16x32_bf16 v[220:223], a[0:3], v[188:191], v[220:223]
    v_add_f32 v32, v32, v216
    ds_read_b128 v[180:183], v15 offset:45056
    v_mfma_f32_16x16x32_bf16 v[224:227], a[0:3], v[192:195], v[224:227]
    v_add_f32 v33, v33, v217
    ds_read_b128 v[184:187], v15 offset:46080
    v_mfma_f32_16x16x32_bf16 v[228:231], a[4:7], v[188:191], v[228:231]
    v_add_f32 v34, v34, v218
    v_add_f32 v20, v20, v28
    v_mfma_f32_16x16x32_bf16 v[232:235], a[4:7], v[192:195], v[232:235]
    buffer_load_dwordx4 v[40:43], v115, s[12:15], s95 offen sc1
    s_add_u32 s95, s95, 32768
    v_mfma_f32_16x16x32_bf16 v[236:239], a[8:11], v[188:191], v[236:239]
    v_add_f32 v21, v21, v29
    v_add_f32 v22, v22, v30
    v_mfma_f32_16x16x32_bf16 v[240:243], a[8:11], v[192:195], v[240:243]
    s_waitcnt lgkmcnt(2)
    v_mfma_f32_16x16x32_bf16 v[220:223], a[12:15], v[196:199], v[220:223]
    v_add_f32 v24, v24, v32
    ds_read_b128 v[188:191], v15 offset:47104
    v_mfma_f32_16x16x32_bf16 v[224:227], a[12:15], v[200:203], v[224:227]
    v_add_f32 v25, v25, v33
    ds_read_b128 v[192:195], v15 offset:48128
    v_mfma_f32_16x16x32_bf16 v[228:231], a[16:19], v[196:199], v[228:231]
    v_add_f32 v26, v26, v34
    buffer_load_dwordx4 v[44:47], v115, s[12:15], s95 offen sc1
    s_add_u32 s95, s95, 32768
    v_mfma_f32_16x16x32_bf16 v[232:235], a[16:19], v[200:203], v[232:235]
    v_add_f32 v20, v20, v24
    v_mfma_f32_16x16x32_bf16 v[236:239], a[20:23], v[196:199], v[236:239]
    v_add_f32 v21, v21, v25
    v_add_f32 v22, v22, v26
    v_mfma_f32_16x16x32_bf16 v[240:243], a[20:23], v[200:203], v[240:243]
    s_waitcnt lgkmcnt(2)
    v_mfma_f32_16x16x32_bf16 v[220:223], a[24:27], v[180:183], v[220:223]
    v_mul_f32 v20, 0x3b000000, v20
    s_waitcnt vmcnt(16)
    s_barrier
    v_mfma_f32_16x16x32_bf16 v[224:227], a[24:27], v[184:187], v[224:227]
    v_mfma_f32_16x16x32_bf16 v[228:231], a[28:31], v[180:183], v[228:231]
    buffer_load_dwordx4 v[48:51], v115, s[12:15], s95 offen sc1
    s_add_u32 s95, s95, 32768
    v_mfma_f32_16x16x32_bf16 v[232:235], a[28:31], v[184:187], v[232:235]
    v_mul_f32 v21, 0x3b000000, v21
    v_mul_f32 v22, 0x3b000000, v22
    v_mfma_f32_16x16x32_bf16 v[236:239], a[32:35], v[180:183], v[236:239]
    ds_read_b128 v[196:199], v15 offset:49152
    v_mov_b32 v24, v20
    v_mfma_f32_16x16x32_bf16 v[240:243], a[32:35], v[184:187], v[240:243]
    ds_read_b128 v[200:203], v15 offset:50176
    v_mov_b32 v25, v21
    s_waitcnt lgkmcnt(2)
    v_mfma_f32_16x16x32_bf16 v[220:223], a[36:39], v[188:191], v[220:223]
    buffer_load_dwordx4 v[52:55], v115, s[12:15], s95 offen sc1
    s_add_u32 s95, s95, 32768
    v_mfma_f32_16x16x32_bf16 v[224:227], a[36:39], v[192:195], v[224:227]
    v_mov_b32 v26, v22
    ds_read_b128 v[180:183], v15 offset:51200
    s_waitcnt vmcnt(9)
    s_mov_b64 exec, 1
    buffer_store_dword v2, v4, s[12:15], s17 offen nt
    s_mov_b64 exec, -1
    s_add_u32 s17, s17, 128
    v_mfma_f32_16x16x32_bf16 v[228:231], a[40:43], v[188:191], v[228:231]
    v_mfma_f32_16x16x32_bf16 v[232:235], a[40:43], v[192:195], v[232:235]
    ds_read_b128 v[184:187], v15 offset:52224
    v_permlane32_swap_b32 v20, v24
    v_mfma_f32_16x16x32_bf16 v[236:239], a[44:47], v[188:191], v[236:239]
    v_permlane32_swap_b32 v21, v25
    v_mfma_f32_16x16x32_bf16 v[240:243], a[44:47], v[192:195], v[240:243]
    buffer_load_dwordx4 v[56:59], v115, s[12:15], s95 offen sc1
    s_add_u32 s95, s95, 32768
    s_waitcnt lgkmcnt(2)
    v_mfma_f32_16x16x32_bf16 v[220:223], a[48:51], v[196:199], v[220:223]
    v_permlane32_swap_b32 v22, v26
    v_mfma_f32_16x16x32_bf16 v[224:227], a[48:51], v[200:203], v[224:227]
    ds_read_b128 v[188:191], v15 offset:53248
    ds_read_b128 v[192:195], v15 offset:54272
    v_mfma_f32_16x16x32_bf16 v[228:231], a[52:55], v[196:199], v[228:231]
    v_fma_f32 v24, -v20, v20, v24
    v_max_f32 v24, 0, v24
    v_mfma_f32_16x16x32_bf16 v[232:235], a[52:55], v[200:203], v[232:235]
    buffer_load_dwordx4 v[60:63], v115, s[12:15], s95 offen sc1
    s_add_u32 s95, s95, 32768
    v_mfma_f32_16x16x32_bf16 v[236:239], a[56:59], v[196:199], v[236:239]
    v_add_f32 v24, 0x3727c5ac, v24
    v_rsq_f32 v28, v24
    v_mfma_f32_16x16x32_bf16 v[240:243], a[56:59], v[200:203], v[240:243]
    s_waitcnt lgkmcnt(2)
    v_mfma_f32_16x16x32_bf16 v[220:223], a[60:63], v[180:183], v[220:223]
    ds_read_b128 v[196:199], v15 offset:55296
    v_fma_f32 v21, -v20, s84, v21
    v_mfma_f32_16x16x32_bf16 v[224:227], a[60:63], v[184:187], v[224:227]
    ds_read_b128 v[200:203], v15 offset:56320
    v_mul_f32 v31, s85, v20
    v_mfma_f32_16x16x32_bf16 v[228:231], a[64:67], v[180:183], v[228:231]
    buffer_load_dwordx4 v[64:67], v115, s[12:15], s95 offen sc1
    s_add_u32 s95, s95, 32768
    v_mfma_f32_16x16x32_bf16 v[232:235], a[64:67], v[184:187], v[232:235]
    v_fma_f32 v29, v28, v21, s87
    v_fma_f32 v31, v22, -2.0, v31
    v_mfma_f32_16x16x32_bf16 v[236:239], a[68:71], v[180:183], v[236:239]
    v_fma_f32 v25, v20, v31, v25
    v_mfma_f32_16x16x32_bf16 v[240:243], a[68:71], v[184:187], v[240:243]
    s_waitcnt lgkmcnt(2)
    v_mfma_f32_16x16x32_bf16 v[220:223], a[72:75], v[188:191], v[220:223]
    v_fma_f32 v26, -v20, s86, v26
    ds_read_b128 v[180:183], v15 offset:57344
    v_mfma_f32_16x16x32_bf16 v[224:227], a[72:75], v[192:195], v[224:227]
    v_add_f32 v26, v26, v26
    ds_read_b128 v[184:187], v15 offset:58368
    v_mfma_f32_16x16x32_bf16 v[228:231], a[76:79], v[188:191], v[228:231]
    buffer_load_dwordx4 v[68:71], v115, s[12:15], s95 offen sc1
    s_add_u32 s95, s95, 32768
    v_mfma_f32_16x16x32_bf16 v[232:235], a[76:79], v[192:195], v[232:235]
    v_fma_f32 v30, v28, v25, v26
    v_fma_f32 v30, v28, v30, s88
    v_mfma_f32_16x16x32_bf16 v[236:239], a[80:83], v[188:191], v[236:239]
    v_fma_f32 v30, -v29, v29, v30
    v_max_f32 v30, 0, v30
    v_mfma_f32_16x16x32_bf16 v[240:243], a[80:83], v[192:195], v[240:243]
    s_waitcnt lgkmcnt(2)
    v_mfma_f32_16x16x32_bf16 v[220:223], a[84:87], v[196:199], v[220:223]
    buffer_load_dwordx4 v[72:75], v115, s[12:15], s95 offen sc1
    s_add_u32 s95, s95, 32768
    v_mfma_f32_16x16x32_bf16 v[224:227], a[84:87], v[200:203], v[224:227]
    ds_read_b128 v[188:191], v15 offset:59392
    v_add_f32 v30, 0x3727c5ac, v30
    v_mfma_f32_16x16x32_bf16 v[228:231], a[88:91], v[196:199], v[228:231]
    ds_read_b128 v[192:195], v15 offset:60416
    v_rsq_f32 v158, v30
    v_mfma_f32_16x16x32_bf16 v[232:235], a[88:91], v[200:203], v[232:235]
    v_mul_f32 v156, v28, v158
    v_mfma_f32_16x16x32_bf16 v[236:239], a[92:95], v[196:199], v[236:239]
    buffer_load_dwordx4 v[76:79], v115, s[12:15], s95 offen sc1
    s_add_u32 s95, s95, 32768
    v_mfma_f32_16x16x32_bf16 v[240:243], a[92:95], v[200:203], v[240:243]
    v_mul_f32 v162, -v29, v158
    s_waitcnt lgkmcnt(2)
    v_mfma_f32_16x16x32_bf16 v[220:223], a[96:99], v[180:183], v[220:223]
    v_mul_f32 v160, -v20, v156
    ds_read_b128 v[196:199], v15 offset:61440
    v_mfma_f32_16x16x32_bf16 v[224:227], a[96:99], v[184:187], v[224:227]
    v_mov_b32 v157, v156
    ds_read_b128 v[200:203], v15 offset:62464
    v_mfma_f32_16x16x32_bf16 v[228:231], a[100:103], v[180:183], v[228:231]
    v_mov_b32 v159, v158
    v_mov_b32 v161, v160
    v_mfma_f32_16x16x32_bf16 v[232:235], a[100:103], v[184:187], v[232:235]
    buffer_load_dwordx4 v[80:83], v115, s[12:15], s95 offen sc1
    s_add_u32 s95, s95, 32768
    v_mfma_f32_16x16x32_bf16 v[236:239], a[104:107], v[180:183], v[236:239]
    v_mov_b32 v163, v162
    v_permlane16_swap_b32 v156, v157
    v_mfma_f32_16x16x32_bf16 v[240:243], a[104:107], v[184:187], v[240:243]
    s_waitcnt lgkmcnt(2)
    v_mfma_f32_16x16x32_bf16 v[220:223], a[108:111], v[188:191], v[220:223]
    ds_read_b128 v[180:183], v15 offset:63488
    v_permlane16_swap_b32 v158, v159
    v_mfma_f32_16x16x32_bf16 v[224:227], a[108:111], v[192:195], v[224:227]
    ds_read_b128 v[184:187], v15 offset:64512
    v_mfma_f32_16x16x32_bf16 v[228:231], a[112:115], v[188:191], v[228:231]
    buffer_load_dwordx4 a[0:3], v115, s[12:15], s95 offen sc1
    s_add_u32 s95, s95, 32768
    v_mfma_f32_16x16x32_bf16 v[232:235], a[112:115], v[192:195], v[232:235]
    v_permlane16_swap_b32 v160, v161
    v_mfma_f32_16x16x32_bf16 v[236:239], a[116:119], v[188:191], v[236:239]
    v_mfma_f32_16x16x32_bf16 v[240:243], a[116:119], v[192:195], v[240:243]
    s_waitcnt lgkmcnt(2)
    v_mfma_f32_16x16x32_bf16 v[220:223], a[120:123], v[196:199], v[220:223]
    v_permlane16_swap_b32 v162, v163
    v_mfma_f32_16x16x32_bf16 v[224:227], a[120:123], v[200:203], v[224:227]
    buffer_load_dword v14, v3, s[12:15], s22 offen sc1
    v_mfma_f32_16x16x32_bf16 v[228:231], a[124:127], v[196:199], v[228:231]
    v_mfma_f32_16x16x32_bf16 v[232:235], a[124:127], v[200:203], v[232:235]
    v_mfma_f32_16x16x32_bf16 v[236:239], a[128:131], v[196:199], v[236:239]
    v_mfma_f32_16x16x32_bf16 v[240:243], a[128:131], v[200:203], v[240:243]
    s_waitcnt lgkmcnt(0)
    v_mfma_f32_16x16x32_bf16 v[220:223], a[132:135], v[180:183], v[220:223]
    buffer_load_dwordx4 a[4:7], v115, s[12:15], s95 offen sc1
    s_add_u32 s95, s95, 32768
    v_mfma_f32_16x16x32_bf16 v[224:227], a[132:135], v[184:187], v[224:227]
    v_mfma_f32_16x16x32_bf16 v[228:231], a[136:139], v[180:183], v[228:231]
    v_mfma_f32_16x16x32_bf16 v[232:235], a[136:139], v[184:187], v[232:235]
    v_mfma_f32_16x16x32_bf16 v[236:239], a[140:143], v[180:183], v[236:239]
    v_mfma_f32_16x16x32_bf16 v[240:243], a[140:143], v[184:187], v[240:243]
    s_nop 0
    v_pk_fma_f32 v[220:221], v[220:221], v[156:157], v[120:121] op_sel:[0,0,0] op_sel_hi:[1,0,1]
    v_pk_fma_f32 v[222:223], v[222:223], v[156:157], v[122:123] op_sel:[0,0,0] op_sel_hi:[1,0,1]
    s_nop 0
    v_pk_fma_f32 v[224:225], v[224:225], v[156:157], v[120:121] op_sel:[0,1,0] op_sel_hi:[1,1,1]
    buffer_load_dwordx4 a[8:11], v115, s[12:15], s95 offen sc1
    s_add_u32 s95, s95, 32768
    v_pk_fma_f32 v[226:227], v[226:227], v[156:157], v[122:123] op_sel:[0,1,0] op_sel_hi:[1,1,1]
    v_pk_fma_f32 v[220:221], v[132:133], v[158:159], v[220:221] op_sel:[0,0,0] op_sel_hi:[1,0,1]
    v_pk_fma_f32 v[222:223], v[134:135], v[158:159], v[222:223] op_sel:[0,0,0] op_sel_hi:[1,0,1]
    v_pk_fma_f32 v[224:225], v[132:133], v[158:159], v[224:225] op_sel:[0,1,0] op_sel_hi:[1,1,1]
    v_pk_fma_f32 v[226:227], v[134:135], v[158:159], v[226:227] op_sel:[0,1,0] op_sel_hi:[1,1,1]
    v_pk_fma_f32 v[220:221], v[144:145], v[160:161], v[220:221] op_sel:[0,0,0] op_sel_hi:[1,0,1]
    v_pk_fma_f32 v[222:223], v[146:147], v[160:161], v[222:223] op_sel:[0,0,0] op_sel_hi:[1,0,1]
    v_pk_fma_f32 v[224:225], v[144:145], v[160:161], v[224:225] op_sel:[0,1,0] op_sel_hi:[1,1,1]
    v_pk_fma_f32 v[226:227], v[146:147], v[160:161], v[226:227] op_sel:[0,1,0] op_sel_hi:[1,1,1]
    v_pk_fma_f32 v[220:221], v[164:165], v[162:163], v[220:221] op_sel:[0,0,0] op_sel_hi:[1,0,1]
    v_pk_fma_f32 v[222:223], v[166:167], v[162:163], v[222:223] op_sel:[0,0,0] op_sel_hi:[1,0,1]
    v_pk_fma_f32 v[224:225], v[164:165], v[162:163], v[224:225] op_sel:[0,1,0] op_sel_hi:[1,1,1]
    v_pk_fma_f32 v[226:227], v[166:167], v[162:163], v[226:227] op_sel:[0,1,0] op_sel_hi:[1,1,1]
    v_pk_mul_f32 v[20:21], v[220:221], v[220:221]
    v_pk_mul_f32 v[22:23], v[222:223], v[222:223]
    v_pk_mul_f32 v[24:25], v[224:225], v[224:225]
    v_pk_mul_f32 v[26:27], v[226:227], v[226:227]
    v_pk_fma_f32 v[20:21], v[20:21], s[42:43], s[42:43] op_sel:[0,0,1] op_sel_hi:[1,0,1]
    v_pk_fma_f32 v[22:23], v[22:23], s[42:43], s[42:43] op_sel:[0,0,1] op_sel_hi:[1,0,1]
    v_pk_fma_f32 v[24:25], v[24:25], s[42:43], s[42:43] op_sel:[0,0,1] op_sel_hi:[1,0,1]
    v_pk_fma_f32 v[26:27], v[26:27], s[42:43], s[42:43] op_sel:[0,0,1] op_sel_hi:[1,0,1]
    v_pk_mul_f32 v[20:21], v[20:21], v[220:221]
    v_pk_mul_f32 v[22:23], v[22:23], v[222:223]
    v_pk_mul_f32 v[24:25], v[24:25], v[224:225]
    v_pk_mul_f32 v[26:27], v[26:27], v[226:227]
    v_exp_f32 v20, v20
    v_exp_f32 v21, v21
    v_exp_f32 v22, v22
    v_exp_f32 v23, v23
    v_exp_f32 v24, v24
    v_exp_f32 v25, v25
    v_exp_f32 v26, v26
    v_exp_f32 v27, v27
    v_pk_add_f32 v[20:21], v[20:21], 1.0 op_sel_hi:[1,0]
    v_pk_add_f32 v[22:23], v[22:23], 1.0 op_sel_hi:[1,0]
    v_pk_add_f32 v[24:25], v[24:25], 1.0 op_sel_hi:[1,0]
    s_waitcnt vmcnt(2)
    v_cmp_ne_u32 vcc, s6, v14
    s_nop 0
    s_cbranch_vccnz retry_24
ready_25:
    v_pk_add_f32 v[26:27], v[26:27], 1.0 op_sel_hi:[1,0]
    v_rcp_f32 v20, v20
    v_rcp_f32 v21, v21
    v_rcp_f32 v22, v22
    v_rcp_f32 v23, v23
    v_rcp_f32 v24, v24
    v_rcp_f32 v25, v25
    s_add_u32 s22, s22, 128
    v_rcp_f32 v26, v26
    v_rcp_f32 v27, v27
    v_pk_mul_f32 v[20:21], v[20:21], v[220:221]
    v_pk_mul_f32 v[22:23], v[22:23], v[222:223]
    v_pk_mul_f32 v[24:25], v[24:25], v[224:225]
    s_lshl_b32 s39, s3, 12
    s_add_u32 s38, s10, s39
    s_add_u32 s38, s38, 0x25000
    s_add_u32 m0, s39, 65536
    s_nop 0
    s_nop 0
    buffer_load_dwordx4 v15, s[12:15], s38 offen offset:0 sc1 lds
    v_pk_mul_f32 v[26:27], v[26:27], v[226:227]
    v_cvt_pk_bf16_f32 v204, v20, v21
    v_cvt_pk_bf16_f32 v206, v24, v25
    v_cvt_pk_bf16_f32 v205, v22, v23
    v_cvt_pk_bf16_f32 v207, v26, v27
    v_permlane16_swap_b32 v204, v206
    s_nop 0
    v_permlane16_swap_b32 v205, v207
    s_nop 0
    buffer_store_dwordx4 v[204:207], v5, s[12:15], s76 offen nt
    v_pk_fma_f32 v[228:229], v[228:229], v[156:157], v[124:125] op_sel:[0,0,0] op_sel_hi:[1,0,1]
    v_pk_fma_f32 v[230:231], v[230:231], v[156:157], v[126:127] op_sel:[0,0,0] op_sel_hi:[1,0,1]
    v_pk_fma_f32 v[232:233], v[232:233], v[156:157], v[124:125] op_sel:[0,1,0] op_sel_hi:[1,1,1]
    v_pk_fma_f32 v[234:235], v[234:235], v[156:157], v[126:127] op_sel:[0,1,0] op_sel_hi:[1,1,1]
    v_pk_fma_f32 v[228:229], v[136:137], v[158:159], v[228:229] op_sel:[0,0,0] op_sel_hi:[1,0,1]
    v_pk_fma_f32 v[230:231], v[138:139], v[158:159], v[230:231] op_sel:[0,0,0] op_sel_hi:[1,0,1]
    v_pk_fma_f32 v[232:233], v[136:137], v[158:159], v[232:233] op_sel:[0,1,0] op_sel_hi:[1,1,1]
    v_pk_fma_f32 v[234:235], v[138:139], v[158:159], v[234:235] op_sel:[0,1,0] op_sel_hi:[1,1,1]
    v_pk_fma_f32 v[228:229], v[148:149], v[160:161], v[228:229] op_sel:[0,0,0] op_sel_hi:[1,0,1]
    v_pk_fma_f32 v[230:231], v[150:151], v[160:161], v[230:231] op_sel:[0,0,0] op_sel_hi:[1,0,1]
    v_pk_fma_f32 v[232:233], v[148:149], v[160:161], v[232:233] op_sel:[0,1,0] op_sel_hi:[1,1,1]
    v_pk_fma_f32 v[234:235], v[150:151], v[160:161], v[234:235] op_sel:[0,1,0] op_sel_hi:[1,1,1]
    v_pk_fma_f32 v[228:229], v[168:169], v[162:163], v[228:229] op_sel:[0,0,0] op_sel_hi:[1,0,1]
    v_pk_fma_f32 v[230:231], v[170:171], v[162:163], v[230:231] op_sel:[0,0,0] op_sel_hi:[1,0,1]
    v_pk_fma_f32 v[232:233], v[168:169], v[162:163], v[232:233] op_sel:[0,1,0] op_sel_hi:[1,1,1]
    v_pk_fma_f32 v[234:235], v[170:171], v[162:163], v[234:235] op_sel:[0,1,0] op_sel_hi:[1,1,1]
    v_pk_mul_f32 v[28:29], v[228:229], v[228:229]
    v_pk_mul_f32 v[30:31], v[230:231], v[230:231]
    v_pk_mul_f32 v[32:33], v[232:233], v[232:233]
    v_pk_mul_f32 v[34:35], v[234:235], v[234:235]
    v_pk_fma_f32 v[28:29], v[28:29], s[42:43], s[42:43] op_sel:[0,0,1] op_sel_hi:[1,0,1]
    v_pk_fma_f32 v[30:31], v[30:31], s[42:43], s[42:43] op_sel:[0,0,1] op_sel_hi:[1,0,1]
    v_pk_fma_f32 v[32:33], v[32:33], s[42:43], s[42:43] op_sel:[0,0,1] op_sel_hi:[1,0,1]
    v_pk_fma_f32 v[34:35], v[34:35], s[42:43], s[42:43] op_sel:[0,0,1] op_sel_hi:[1,0,1]
    buffer_load_dwordx4 v15, s[12:15], s38 offen offset:1024 sc1 lds
    v_pk_mul_f32 v[28:29], v[28:29], v[228:229]
    v_pk_mul_f32 v[30:31], v[30:31], v[230:231]
    v_pk_mul_f32 v[32:33], v[32:33], v[232:233]
    v_pk_mul_f32 v[34:35], v[34:35], v[234:235]
    v_exp_f32 v28, v28
    v_exp_f32 v29, v29
    buffer_load_dwordx4 v15, s[12:15], s38 offen offset:2048 sc1 lds
    v_exp_f32 v30, v30
    v_exp_f32 v31, v31
    v_exp_f32 v32, v32
    buffer_load_dwordx4 v15, s[12:15], s38 offen offset:3072 sc1 lds
    s_add_u32 s38, s38, 16384
    v_exp_f32 v33, v33
    v_exp_f32 v34, v34
    v_exp_f32 v35, v35
    v_pk_add_f32 v[28:29], v[28:29], 1.0 op_sel_hi:[1,0]
    v_pk_add_f32 v[30:31], v[30:31], 1.0 op_sel_hi:[1,0]
    v_pk_add_f32 v[32:33], v[32:33], 1.0 op_sel_hi:[1,0]
    v_pk_add_f32 v[34:35], v[34:35], 1.0 op_sel_hi:[1,0]
    v_rcp_f32 v28, v28
    v_rcp_f32 v29, v29
    s_add_u32 m0, s39, 81920
    s_nop 0
    buffer_load_dwordx4 v15, s[12:15], s38 offen offset:0 sc1 lds
    v_rcp_f32 v30, v30
    v_rcp_f32 v31, v31
    v_rcp_f32 v32, v32
    v_rcp_f32 v33, v33
    v_rcp_f32 v34, v34
    v_rcp_f32_e64 v35, v35
    v_pk_mul_f32 v[28:29], v[28:29], v[228:229]
    v_pk_mul_f32 v[30:31], v[30:31], v[230:231]
    buffer_load_dwordx4 v15, s[12:15], s38 offen offset:1024 sc1 lds
    v_pk_mul_f32 v[32:33], v[32:33], v[232:233]
    v_pk_mul_f32 v[34:35], v[34:35], v[234:235]
    v_cvt_pk_bf16_f32 v208, v28, v29
    v_cvt_pk_bf16_f32 v210, v32, v33
    v_cvt_pk_bf16_f32 v209, v30, v31
    v_cvt_pk_bf16_f32 v211, v34, v35
    buffer_load_dwordx4 v15, s[12:15], s38 offen offset:2048 sc1 lds
    v_permlane16_swap_b32 v208, v210
    v_permlane16_swap_b32 v209, v211
    buffer_store_dwordx4 v[208:211], v5, s[12:15], s77 offen nt
    v_pk_fma_f32 v[236:237], v[236:237], v[156:157], v[128:129] op_sel:[0,0,0] op_sel_hi:[1,0,1]
    v_pk_fma_f32 v[238:239], v[238:239], v[156:157], v[130:131] op_sel:[0,0,0] op_sel_hi:[1,0,1]
    buffer_load_dwordx4 v15, s[12:15], s38 offen offset:3072 sc1 lds
    s_add_u32 s38, s38, 16384
    v_pk_fma_f32 v[240:241], v[240:241], v[156:157], v[128:129] op_sel:[0,1,0] op_sel_hi:[1,1,1]
    v_pk_fma_f32 v[242:243], v[242:243], v[156:157], v[130:131] op_sel:[0,1,0] op_sel_hi:[1,1,1]
    v_pk_fma_f32 v[236:237], v[140:141], v[158:159], v[236:237] op_sel:[0,0,0] op_sel_hi:[1,0,1]
    v_pk_fma_f32 v[238:239], v[142:143], v[158:159], v[238:239] op_sel:[0,0,0] op_sel_hi:[1,0,1]
    v_pk_fma_f32 v[240:241], v[140:141], v[158:159], v[240:241] op_sel:[0,1,0] op_sel_hi:[1,1,1]
    v_pk_fma_f32 v[242:243], v[142:143], v[158:159], v[242:243] op_sel:[0,1,0] op_sel_hi:[1,1,1]
    v_pk_fma_f32 v[236:237], v[152:153], v[160:161], v[236:237] op_sel:[0,0,0] op_sel_hi:[1,0,1]
    v_pk_fma_f32 v[238:239], v[154:155], v[160:161], v[238:239] op_sel:[0,0,0] op_sel_hi:[1,0,1]
    v_pk_fma_f32 v[240:241], v[152:153], v[160:161], v[240:241] op_sel:[0,1,0] op_sel_hi:[1,1,1]
    v_pk_fma_f32 v[242:243], v[154:155], v[160:161], v[242:243] op_sel:[0,1,0] op_sel_hi:[1,1,1]
    v_pk_fma_f32 v[236:237], v[172:173], v[162:163], v[236:237] op_sel:[0,0,0] op_sel_hi:[1,0,1]
    v_pk_fma_f32 v[238:239], v[174:175], v[162:163], v[238:239] op_sel:[0,0,0] op_sel_hi:[1,0,1]
    v_pk_fma_f32 v[240:241], v[172:173], v[162:163], v[240:241] op_sel:[0,1,0] op_sel_hi:[1,1,1]
    v_pk_fma_f32 v[242:243], v[174:175], v[162:163], v[242:243] op_sel:[0,1,0] op_sel_hi:[1,1,1]
    s_add_u32 m0, s39, 98304
    s_nop 0
    s_nop 0
    buffer_load_dwordx4 v15, s[12:15], s38 offen offset:0 sc1 lds
    v_pk_mul_f32 v[20:21], v[236:237], v[236:237]
    v_pk_mul_f32 v[22:23], v[238:239], v[238:239]
    v_pk_mul_f32 v[24:25], v[240:241], v[240:241]
    v_pk_mul_f32 v[26:27], v[242:243], v[242:243]
    v_pk_fma_f32 v[20:21], v[20:21], s[42:43], s[42:43] op_sel:[0,0,1] op_sel_hi:[1,0,1]
    v_pk_fma_f32 v[22:23], v[22:23], s[42:43], s[42:43] op_sel:[0,0,1] op_sel_hi:[1,0,1]
    v_pk_fma_f32 v[24:25], v[24:25], s[42:43], s[42:43] op_sel:[0,0,1] op_sel_hi:[1,0,1]
    v_pk_fma_f32 v[26:27], v[26:27], s[42:43], s[42:43] op_sel:[0,0,1] op_sel_hi:[1,0,1]
    v_pk_mul_f32 v[20:21], v[20:21], v[236:237]
    v_pk_mul_f32 v[22:23], v[22:23], v[238:239]
    v_pk_mul_f32 v[24:25], v[24:25], v[240:241]
    v_pk_mul_f32 v[26:27], v[26:27], v[242:243]
    v_exp_f32 v20, v20
    buffer_load_dwordx4 v15, s[12:15], s38 offen offset:1024 sc1 lds
    v_exp_f32 v21, v21
    s_waitcnt vmcnt(7)
    s_barrier
    v_exp_f32 v22, v22
    v_exp_f32 v23, v23
    buffer_load_dwordx4 v15, s[12:15], s38 offen offset:2048 sc1 lds
    v_exp_f32 v24, v24
    v_exp_f32 v25, v25
    v_exp_f32 v26, v26
    ds_read_b128 v[180:183], v117 offset:0
    v_exp_f32 v27, v27
    buffer_load_dwordx4 v15, s[12:15], s38 offen offset:3072 sc1 lds
    s_add_u32 s38, s38, 16384
    v_pk_add_f32 v[20:21], v[20:21], 1.0 op_sel_hi:[1,0]
    ds_read_b128 v[184:187], v117 offset:2048
    v_pk_add_f32 v[22:23], v[22:23], 1.0 op_sel_hi:[1,0]
    v_pk_add_f32 v[24:25], v[24:25], 1.0 op_sel_hi:[1,0]
    v_pk_add_f32 v[26:27], v[26:27], 1.0 op_sel_hi:[1,0]
    ds_read_b128 v[188:191], v117 offset:4096
    v_rcp_f32 v20, v20
    v_rcp_f32 v21, v21
    ds_read_b128 v[192:195], v117 offset:6144
    v_rcp_f32 v22, v22
    v_rcp_f32 v23, v23
    v_rcp_f32 v24, v24
    s_add_u32 m0, s39, 114688
    s_nop 0
    buffer_load_dwordx4 v15, s[12:15], s38 offen offset:0 sc1 lds
    v_rcp_f32 v25, v25
    v_rcp_f32 v26, v26
    v_rcp_f32_e64 v27, v27
    v_pk_mul_f32 v[20:21], v[20:21], v[236:237]
    v_pk_mul_f32 v[22:23], v[22:23], v[238:239]
    v_pk_mul_f32 v[24:25], v[24:25], v[240:241]
    v_pk_mul_f32 v[26:27], v[26:27], v[242:243]
    v_cvt_pk_bf16_f32 v212, v20, v21
    v_cvt_pk_bf16_f32 v214, v24, v25
    v_cvt_pk_bf16_f32 v213, v22, v23
    buffer_load_dwordx4 v15, s[12:15], s38 offen offset:1024 sc1 lds
    v_cvt_pk_bf16_f32 v215, v26, v27
    v_permlane16_swap_b32 v212, v214
    s_nop 0
    v_permlane16_swap_b32 v213, v215
    buffer_store_dwordx4 v[212:215], v5, s[12:15], s78 offen nt
    s_waitcnt vmcnt(8)
    s_mov_b64 exec, 1
    buffer_store_dword v2, v4, s[12:15], s17 offen nt
    s_mov_b64 exec, -1
    s_add_u32 s17, s17, 128
    buffer_load_dwordx4 v15, s[12:15], s38 offen offset:2048 sc1 lds
    s_waitcnt lgkmcnt(2)
    v_mfma_f32_32x32x16_bf16 v[220:235], a[144:147], v[180:183], 0
    buffer_load_dwordx4 v15, s[12:15], s38 offen offset:3072 sc1 lds
    s_add_u32 s38, s38, 16384
    ds_read_b128 v[196:199], v117 offset:8192
    ds_read_b128 v[180:183], v117 offset:10240
    v_mfma_f32_32x32x16_bf16 v[220:235], a[148:151], v[184:187], v[220:235]
    s_waitcnt lgkmcnt(2)
    v_mfma_f32_32x32x16_bf16 v[220:235], a[152:155], v[188:191], v[220:235]
    s_add_u32 m0, s39, 131072
    s_nop 0
    buffer_load_dwordx4 v15, s[12:15], s38 offen offset:0 sc1 lds
    ds_read_b128 v[184:187], v117 offset:12288
    buffer_load_dwordx4 v15, s[12:15], s38 offen offset:1024 sc1 lds
    ds_read_b128 v[188:191], v117 offset:14336
    v_mfma_f32_32x32x16_bf16 v[220:235], a[156:159], v[192:195], v[220:235]
    s_waitcnt lgkmcnt(2)
    v_mfma_f32_32x32x16_bf16 v[220:235], a[160:163], v[196:199], v[220:235]
    buffer_load_dwordx4 v15, s[12:15], s38 offen offset:2048 sc1 lds
    buffer_load_dwordx4 v15, s[12:15], s38 offen offset:3072 sc1 lds
    s_add_u32 s38, s38, 16384
    s_waitcnt vmcnt(14)
    s_barrier
    v_mfma_f32_32x32x16_bf16 v[220:235], a[164:167], v[180:183], v[220:235]
    ds_read_b128 v[192:195], v117 offset:16384
    ds_read_b128 v[196:199], v117 offset:18432
    s_waitcnt lgkmcnt(2)
    v_mfma_f32_32x32x16_bf16 v[220:235], a[168:171], v[184:187], v[220:235]
    s_sub_u32 s38, s38, s39
    s_min_u32 s39, s3, 2
    s_lshl_b32 s39, s39, 11
    s_add_u32 s38, s38, s39
    s_add_u32 m0, s39, 147456
    s_nop 0
    buffer_load_dwordx4 v15, s[12:15], s38 offen offset:0 sc1 lds
    v_mfma_f32_32x32x16_bf16 v[220:235], a[172:175], v[188:191], v[220:235]
    ds_read_b128 v[180:183], v117 offset:20480
    ds_read_b128 v[184:187], v117 offset:22528
    s_waitcnt lgkmcnt(2)
    v_mfma_f32_32x32x16_bf16 v[220:235], a[176:179], v[192:195], v[220:235]
    ds_read_b128 v[188:191], v117 offset:24576
    ds_read_b128 v[192:195], v117 offset:26624
    v_mfma_f32_32x32x16_bf16 v[220:235], a[180:183], v[196:199], v[220:235]
    s_waitcnt lgkmcnt(2)
    v_mfma_f32_32x32x16_bf16 v[220:235], a[184:187], v[180:183], v[220:235]
    buffer_load_dwordx4 v15, s[12:15], s38 offen offset:1024 sc1 lds
    s_waitcnt vmcnt(9)
    s_mov_b64 exec, 1
    buffer_store_dword v2, v4, s[12:15], s17 offen nt
    s_mov_b64 exec, -1
    s_add_u32 s17, s17, 128
    v_mfma_f32_32x32x16_bf16 v[220:235], a[188:191], v[184:187], v[220:235]
    ds_read_b128 v[196:199], v117 offset:28672
    ds_read_b128 v[180:183], v117 offset:30720
    s_waitcnt lgkmcnt(2)
    v_mfma_f32_32x32x16_bf16 v[220:235], a[192:195], v[188:191], v[220:235]
    buffer_load_dword v14, v3, s[12:15], s22 offen sc1
    s_barrier
    ds_read_b128 v[184:187], v117 offset:32768
    v_mfma_f32_32x32x16_bf16 v[220:235], a[196:199], v[192:195], v[220:235]
    ds_read_b128 v[188:191], v117 offset:34816
    s_waitcnt lgkmcnt(2)
    v_mfma_f32_32x32x16_bf16 v[220:235], a[200:203], v[196:199], v[220:235]
    ds_read_b128 v[192:195], v117 offset:36864
    ds_read_b128 v[196:199], v117 offset:38912
    v_mfma_f32_32x32x16_bf16 v[220:235], a[204:207], v[180:183], v[220:235]
    s_waitcnt lgkmcnt(2)
    v_mfma_f32_32x32x16_bf16 v[220:235], a[208:211], v[184:187], v[220:235]
    ds_read_b128 v[180:183], v117 offset:40960
    ds_read_b128 v[184:187], v117 offset:43008
    v_mfma_f32_32x32x16_bf16 v[220:235], a[212:215], v[188:191], v[220:235]
    s_waitcnt lgkmcnt(2)
    v_mfma_f32_32x32x16_bf16 v[220:235], a[216:219], v[192:195], v[220:235]
    ds_read_b128 v[188:191], v117 offset:45056
    ds_read_b128 v[192:195], v117 offset:47104
    v_mfma_f32_32x32x16_bf16 v[220:235], a[220:223], v[196:199], v[220:235]
    s_waitcnt lgkmcnt(2)
    v_mfma_f32_32x32x16_bf16 v[220:235], a[224:227], v[180:183], v[220:235]
    s_waitcnt vmcnt(8)
    s_barrier
    ds_read_b128 v[196:199], v117 offset:49152
    ds_read_b128 v[180:183], v117 offset:51200
    v_mfma_f32_32x32x16_bf16 v[220:235], a[228:231], v[184:187], v[220:235]
    s_waitcnt lgkmcnt(2)
    v_mfma_f32_32x32x16_bf16 v[220:235], a[232:235], v[188:191], v[220:235]
    ds_read_b128 v[184:187], v117 offset:53248
    ds_read_b128 v[188:191], v117 offset:55296
    v_mfma_f32_32x32x16_bf16 v[220:235], a[236:239], v[192:195], v[220:235]
    s_waitcnt lgkmcnt(2)
    v_mfma_f32_32x32x16_bf16 v[220:235], a[240:243], v[196:199], v[220:235]
    ds_read_b128 v[192:195], v117 offset:57344
    s_waitcnt vmcnt(0)
    v_cmp_ne_u32 vcc, s6, v14
    s_nop 0
    s_cbranch_vccnz retry_26
ready_27:
    ds_read_b128 v[196:199], v117 offset:59392
    v_mfma_f32_32x32x16_bf16 v[220:235], a[244:247], v[180:183], v[220:235]
    s_waitcnt lgkmcnt(2)
    v_mfma_f32_32x32x16_bf16 v[220:235], a[248:251], v[184:187], v[220:235]
    ds_read_b128 v[180:183], v117 offset:61440
    s_add_u32 s22, s22, 128
    s_lshl_b32 s39, s3, 12
    s_add_u32 s38, s10, s39
    s_add_u32 s38, s38, 0x3a800
    s_add_u32 m0, s39, 0
    s_nop 0
    buffer_load_dwordx4 v15, s[12:15], s38 offen offset:0 sc1 lds
    v_mfma_f32_32x32x16_bf16 v[220:235], a[252:255], v[188:191], v[220:235]
    ds_read_b128 v[184:187], v117 offset:63488
    s_waitcnt lgkmcnt(2)
    v_mfma_f32_32x32x16_bf16 v[220:235], v[36:39], v[192:195], v[220:235]
    s_barrier
    ds_read_b128 v[188:191], v118 offset:0
    ds_read_b128 v[192:195], v118 offset:2048
    v_mfma_f32_32x32x16_bf16 v[220:235], v[40:43], v[196:199], v[220:235]
    s_waitcnt lgkmcnt(2)
    v_mfma_f32_32x32x16_bf16 v[220:235], v[44:47], v[180:183], v[220:235]
    ds_read_b128 v[196:199], v118 offset:4096
    buffer_load_dwordx4 v15, s[12:15], s38 offen offset:1024 sc1 lds
    ds_read_b128 v[180:183], v118 offset:6144
    v_mfma_f32_32x32x16_bf16 v[220:235], v[48:51], v[184:187], v[220:235]
    s_waitcnt lgkmcnt(2)
    v_mfma_f32_32x32x16_bf16 v[220:235], v[52:55], v[188:191], v[220:235]
    buffer_load_dwordx4 v15, s[12:15], s38 offen offset:2048 sc1 lds
    ds_read_b128 v[184:187], v118 offset:8192
    buffer_load_dwordx4 v15, s[12:15], s38 offen offset:3072 sc1 lds
    s_add_u32 s38, s38, 16384
    ds_read_b128 v[188:191], v118 offset:10240
    v_mfma_f32_32x32x16_bf16 v[220:235], v[56:59], v[192:195], v[220:235]
    s_waitcnt lgkmcnt(2)
    v_mfma_f32_32x32x16_bf16 v[220:235], v[60:63], v[196:199], v[220:235]
    s_add_u32 m0, s39, 16384
    s_nop 0
    buffer_load_dwordx4 v15, s[12:15], s38 offen offset:0 sc1 lds
    ds_read_b128 v[192:195], v118 offset:12288
    buffer_load_dwordx4 v15, s[12:15], s38 offen offset:1024 sc1 lds
    ds_read_b128 v[196:199], v118 offset:14336
    v_mfma_f32_32x32x16_bf16 v[220:235], v[64:67], v[180:183], v[220:235]
    s_waitcnt lgkmcnt(2)
    v_mfma_f32_32x32x16_bf16 v[220:235], v[68:71], v[184:187], v[220:235]
    buffer_load_dwordx4 v15, s[12:15], s38 offen offset:2048 sc1 lds
    s_barrier
    ds_read_b128 v[180:183], v118 offset:16384
    v_mfma_f32_32x32x16_bf16 v[220:235], v[72:75], v[188:191], v[220:235]
    buffer_load_dwordx4 v15, s[12:15], s38 offen offset:3072 sc1 lds
    s_add_u32 s38, s38, 16384
    ds_read_b128 v[184:187], v118 offset:18432
    s_waitcnt lgkmcnt(2)
    v_mfma_f32_32x32x16_bf16 v[220:235], v[76:79], v[192:195], v[220:235]
    buffer_load_dword v14, v3, s[12:15], s22 offen sc1
    ds_read_b128 v[188:191], v118 offset:20480
    v_mfma_f32_32x32x16_bf16 v[220:235], v[80:83], v[196:199], v[220:235]
    s_waitcnt lgkmcnt(1)
    v_mfma_f32_32x32x16_bf16 v[220:235], a[0:3], v[180:183], v[220:235]
    s_waitcnt vmcnt(5)
    s_barrier
    ds_read_b128 v[200:203], v116 offset:0
    ds_read_b128 v[204:207], v116 offset:2048
    v_mfma_f32_32x32x16_bf16 v[220:235], a[4:7], v[184:187], v[220:235]
    ds_read_b128 v[208:211], v116 offset:4096
    ds_read_b128 v[212:215], v116 offset:6144
    s_waitcnt lgkmcnt(4)
    v_mfma_f32_32x32x16_bf16 v[220:235], a[8:11], v[188:191], v[220:235]
    s_add_u32 m0, s39, 32768
    s_nop 0
    buffer_load_dwordx4 v15, s[12:15], s38 offen offset:0 sc1 lds
    s_waitcnt lgkmcnt(2)
    v_mfma_f32_32x32x16_bf16 v[236:251], a[144:147], v[200:203], 0
    ds_read_b128 v[216:219], v116 offset:8192
    buffer_load_dwordx4 v15, s[12:15], s38 offen offset:1024 sc1 lds
    ds_read_b128 v[200:203], v116 offset:10240
    v_mfma_f32_32x32x16_bf16 v[236:251], a[148:151], v[204:207], v[236:251]
    s_waitcnt lgkmcnt(2)
    v_mfma_f32_32x32x16_bf16 v[236:251], a[152:155], v[208:211], v[236:251]
    buffer_load_dwordx4 v15, s[12:15], s38 offen offset:2048 sc1 lds
    ds_write_b128 v9, v[228:231] offset:0
    v_mfma_f32_32x32x16_bf16 v[236:251], a[156:159], v[212:215], v[236:251]
    ds_read_b128 v[204:207], v116 offset:12288
    buffer_load_dwordx4 v15, s[12:15], s38 offen offset:3072 sc1 lds
    s_add_u32 s38, s38, 16384
    ds_read_b128 v[208:211], v116 offset:14336
    s_waitcnt lgkmcnt(3)
    v_mfma_f32_32x32x16_bf16 v[236:251], a[160:163], v[216:219], v[236:251]
    s_add_u32 m0, s39, 49152
    s_nop 0
    buffer_load_dwordx4 v15, s[12:15], s38 offen offset:0 sc1 lds
    s_waitcnt vmcnt(6)
    s_barrier
    ds_read_b128 v[212:215], v116 offset:16384
    buffer_load_dwordx4 v15, s[12:15], s38 offen offset:1024 sc1 lds
    v_mfma_f32_32x32x16_bf16 v[236:251], a[164:167], v[200:203], v[236:251]
    ds_write_b128 v9, v[232:235] offset:1024
    ds_read_b128 v[216:219], v116 offset:18432
    s_waitcnt lgkmcnt(3)
    v_mfma_f32_32x32x16_bf16 v[236:251], a[168:171], v[204:207], v[236:251]
    buffer_load_dwordx4 v15, s[12:15], s38 offen offset:2048 sc1 lds
    buffer_load_dwordx4 v15, s[12:15], s38 offen offset:3072 sc1 lds
    s_add_u32 s38, s38, 16384
    ds_read_b128 v[200:203], v116 offset:20480
    ds_read_b128 v[204:207], v116 offset:22528
    v_mfma_f32_32x32x16_bf16 v[236:251], a[172:175], v[208:211], v[236:251]
    s_waitcnt lgkmcnt(2)
    v_mfma_f32_32x32x16_bf16 v[236:251], a[176:179], v[212:215], v[236:251]
    s_waitcnt vmcnt(8)
    v_cmp_ne_u32 vcc, s6, v14
    s_nop 0
    s_cbranch_vccnz retry_28
ready_29:
    ds_read_b128 v[208:211], v116 offset:24576
    s_add_u32 s22, s22, 128
    ds_read_b128 v[212:215], v116 offset:26624
    v_mfma_f32_32x32x16_bf16 v[236:251], a[180:183], v[216:219], v[236:251]
    s_waitcnt lgkmcnt(2)
    v_mfma_f32_32x32x16_bf16 v[236:251], a[184:187], v[200:203], v[236:251]
    s_add_u32 m0, s39, 65536
    s_nop 0
    buffer_load_dwordx4 v15, s[12:15], s38 offen offset:0 sc1 lds
    ds_read_b128 v[216:219], v116 offset:28672
    buffer_load_dwordx4 v15, s[12:15], s38 offen offset:1024 sc1 lds
    ds_read_b128 v[200:203], v116 offset:30720
    v_mfma_f32_32x32x16_bf16 v[236:251], a[188:191], v[204:207], v[236:251]
    s_waitcnt lgkmcnt(2)
    v_mfma_f32_32x32x16_bf16 v[236:251], a[192:195], v[208:211], v[236:251]
    buffer_load_dwordx4 v15, s[12:15], s38 offen offset:2048 sc1 lds
    s_waitcnt vmcnt(7)
    s_barrier
    ds_read_b128 v[204:207], v116 offset:32768
    v_mfma_f32_32x32x16_bf16 v[236:251], a[196:199], v[212:215], v[236:251]
    buffer_load_dwordx4 v15, s[12:15], s38 offen offset:3072 sc1 lds
    s_add_u32 s38, s38, 16384
    ds_read_b128 v[208:211], v116 offset:34816
    s_waitcnt lgkmcnt(2)
    v_mfma_f32_32x32x16_bf16 v[236:251], a[200:203], v[216:219], v[236:251]
    s_sub_u32 s38, s38, s39
    s_min_u32 s39, s3, 2
    s_lshl_b32 s39, s39, 11
    s_add_u32 s38, s38, s39
    s_add_u32 m0, s39, 81920
    s_nop 0
    buffer_load_dwordx4 v15, s[12:15], s38 offen offset:0 sc1 lds
    v_mfma_f32_32x32x16_bf16 v[236:251], a[204:207], v[200:203], v[236:251]
    ds_read_b128 v[212:215], v116 offset:36864
    ds_read_b128 v[216:219], v116 offset:38912
    s_waitcnt lgkmcnt(2)
    v_mfma_f32_32x32x16_bf16 v[236:251], a[208:211], v[204:207], v[236:251]
    ds_read_b128 v[228:231], v10 offset:0
    ds_read_b128 v[200:203], v116 offset:40960
    ds_read_b128 v[232:235], v10 offset:1024
    ds_read_b128 v[204:207], v116 offset:43008
    v_mfma_f32_32x32x16_bf16 v[236:251], a[212:215], v[208:211], v[236:251]
    s_waitcnt lgkmcnt(4)
    v_mfma_f32_32x32x16_bf16 v[236:251], a[216:219], v[212:215], v[236:251]
    buffer_load_dwordx4 v15, s[12:15], s38 offen offset:1024 sc1 lds
    ds_read_b128 v[208:211], v116 offset:45056
    ds_read_b128 v[212:215], v116 offset:47104
    v_mfma_f32_32x32x16_bf16 v[236:251], a[220:223], v[216:219], v[236:251]
    s_waitcnt lgkmcnt(2)
    v_mfma_f32_32x32x16_bf16 v[236:251], a[224:227], v[200:203], v[236:251]
    s_waitcnt vmcnt(6)
    s_barrier
    ds_read_b128 v[216:219], v116 offset:49152
    v_add_f32 v220, v220, v228
    v_mfma_f32_32x32x16_bf16 v[236:251], a[228:231], v[204:207], v[236:251]
    v_add_f32 v221, v221, v229
    ds_read_b128 v[200:203], v116 offset:51200
    s_waitcnt lgkmcnt(2)
    v_mfma_f32_32x32x16_bf16 v[236:251], a[232:235], v[208:211], v[236:251]
    v_add_f32 v222, v222, v230
    v_add_f32 v223, v223, v231
    ds_read_b128 v[204:207], v116 offset:53248
    v_add_f32 v224, v224, v232
    v_add_f32 v225, v225, v233
    ds_read_b128 v[208:211], v116 offset:55296
    v_mfma_f32_32x32x16_bf16 v[236:251], a[236:239], v[212:215], v[236:251]
    s_waitcnt lgkmcnt(2)
    v_mfma_f32_32x32x16_bf16 v[236:251], a[240:243], v[216:219], v[236:251]
    v_add_f32 v226, v226, v234
    v_add_f32 v227, v227, v235
    ds_read_b128 v[212:215], v116 offset:57344
    v_fmac_f32_dpp v84, v100, v220 row_newbcast:12 row_mask:0xf bank_mask:0xf
    v_fmac_f32_dpp v85, v101, v221 row_newbcast:12 row_mask:0xf bank_mask:0xf
    ds_read_b128 v[216:219], v116 offset:59392
    v_mfma_f32_32x32x16_bf16 v[236:251], a[244:247], v[200:203], v[236:251]
    s_waitcnt lgkmcnt(2)
    v_mfma_f32_32x32x16_bf16 v[236:251], a[248:251], v[204:207], v[236:251]
    v_fmac_f32_dpp v86, v102, v222 row_newbcast:12 row_mask:0xf bank_mask:0xf
    v_fmac_f32_dpp v87, v103, v223 row_newbcast:12 row_mask:0xf bank_mask:0xf
    ds_read_b128 v[200:203], v116 offset:61440
    v_fmac_f32_dpp v88, v104, v224 row_newbcast:12 row_mask:0xf bank_mask:0xf
    v_fmac_f32_dpp v89, v105, v225 row_newbcast:12 row_mask:0xf bank_mask:0xf
    ds_read_b128 v[204:207], v116 offset:63488
    v_mfma_f32_32x32x16_bf16 v[236:251], a[252:255], v[208:211], v[236:251]
    s_waitcnt lgkmcnt(2)
    v_mfma_f32_32x32x16_bf16 v[236:251], v[36:39], v[212:215], v[236:251]
    v_fmac_f32_dpp v90, v106, v226 row_newbcast:12 row_mask:0xf bank_mask:0xf
    v_fmac_f32_dpp v91, v107, v227 row_newbcast:12 row_mask:0xf bank_mask:0xf
    s_waitcnt vmcnt(2)
    s_barrier
    v_mfma_f32_32x32x16_bf16 v[236:251], v[40:43], v[216:219], v[236:251]
    ds_read_b128 v[208:211], v117 offset:0
    v_cvt_pk_bf16_f32 v220, v84, v85
    v_cvt_pk_bf16_f32 v222, v88, v89
    ds_read_b128 v[212:215], v117 offset:2048
    s_waitcnt lgkmcnt(2)
    v_mfma_f32_32x32x16_bf16 v[236:251], v[44:47], v[200:203], v[236:251]
    v_cvt_pk_bf16_f32 v221, v86, v87
    v_cvt_pk_bf16_f32 v223, v90, v91
    ds_read_b128 v[216:219], v117 offset:4096
    v_permlane32_swap_b32 v220, v222
    ds_read_b128 v[200:203], v117 offset:6144
    v_mfma_f32_32x32x16_bf16 v[236:251], v[48:51], v[204:207], v[236:251]
    s_waitcnt lgkmcnt(2)
    v_mfma_f32_32x32x16_bf16 v[236:251], v[52:55], v[208:211], v[236:251]
    v_permlane32_swap_b32 v221, v223
    ds_read_b128 v[204:207], v117 offset:8192
    buffer_store_dwordx4 v[220:223], v6, s[52:55], s96 offen
    s_add_u32 s96, s96, 32768
    ds_read_b128 v[208:211], v117 offset:10240
    v_mfma_f32_32x32x16_bf16 v[236:251], v[56:59], v[212:215], v[236:251]
    s_waitcnt lgkmcnt(2)
    v_mfma_f32_32x32x16_bf16 v[236:251], v[60:63], v[216:219], v[236:251]
    ds_read_b128 v[212:215], v117 offset:12288
    ds_read_b128 v[216:219], v117 offset:14336
    v_mfma_f32_32x32x16_bf16 v[236:251], v[64:67], v[200:203], v[236:251]
    s_waitcnt lgkmcnt(2)
    v_mfma_f32_32x32x16_bf16 v[236:251], v[68:71], v[204:207], v[236:251]
    s_waitcnt vmcnt(1)
    s_barrier
    ds_read_b128 v[200:203], v117 offset:16384
    ds_read_b128 v[204:207], v117 offset:18432
    v_mfma_f32_32x32x16_bf16 v[236:251], v[72:75], v[208:211], v[236:251]
    s_waitcnt lgkmcnt(2)
    v_mfma_f32_32x32x16_bf16 v[236:251], v[76:79], v[212:215], v[236:251]
    ds_read_b128 v[208:211], v117 offset:20480
    v_mfma_f32_32x32x16_bf16 v[236:251], v[80:83], v[216:219], v[236:251]
    s_waitcnt lgkmcnt(1)
    v_mfma_f32_32x32x16_bf16 v[236:251], a[0:3], v[200:203], v[236:251]
    v_mfma_f32_32x32x16_bf16 v[236:251], a[4:7], v[204:207], v[236:251]
    s_waitcnt lgkmcnt(0)
    v_mfma_f32_32x32x16_bf16 v[236:251], a[8:11], v[208:211], v[236:251]
    s_nop 11
    ds_write_b128 v9, v[244:247] offset:0
    ds_write_b128 v9, v[248:251] offset:1024
    s_waitcnt lgkmcnt(0)
    s_barrier
    ds_read_b128 v[244:247], v10 offset:0
    ds_read_b128 v[248:251], v10 offset:1024
    s_waitcnt lgkmcnt(1)
    v_add_f32 v236, v236, v244
    v_add_f32 v237, v237, v245
    v_add_f32 v238, v238, v246
    v_add_f32 v239, v239, v247
    s_waitcnt lgkmcnt(0)
    v_add_f32 v240, v240, v248
    v_add_f32 v241, v241, v249
    v_add_f32 v242, v242, v250
    v_add_f32 v243, v243, v251
    v_fmac_f32_dpp v92, v100, v236 row_newbcast:12 row_mask:0xf bank_mask:0xf
    v_fmac_f32_dpp v93, v101, v237 row_newbcast:12 row_mask:0xf bank_mask:0xf
    v_fmac_f32_dpp v94, v102, v238 row_newbcast:12 row_mask:0xf bank_mask:0xf
    v_fmac_f32_dpp v95, v103, v239 row_newbcast:12 row_mask:0xf bank_mask:0xf
    v_fmac_f32_dpp v96, v104, v240 row_newbcast:12 row_mask:0xf bank_mask:0xf
    v_fmac_f32_dpp v97, v105, v241 row_newbcast:12 row_mask:0xf bank_mask:0xf
    v_fmac_f32_dpp v98, v106, v242 row_newbcast:12 row_mask:0xf bank_mask:0xf
    v_fmac_f32_dpp v99, v107, v243 row_newbcast:12 row_mask:0xf bank_mask:0xf
    v_cvt_pk_bf16_f32 v236, v92, v93
    v_cvt_pk_bf16_f32 v238, v96, v97
    v_cvt_pk_bf16_f32 v237, v94, v95
    v_cvt_pk_bf16_f32 v239, v98, v99
    v_permlane32_swap_b32 v236, v238
    s_nop 0
    v_permlane32_swap_b32 v237, v239
    buffer_store_dwordx4 v[236:239], v6, s[52:55], s96 offen
L_end:
    s_endpgm
retry_4:
    s_sub_u32 s7, s7, 1
    s_cbranch_scc0 retry_4_go
    s_mov_b32 s7, 0
    s_branch ready_5
retry_4_go:
    buffer_load_dwordx4 v[100:103], v119, s[12:15], s10 offen sc1
    s_mov_b32 exec_lo, 0xf000f
    s_mov_b32 exec_hi, exec_lo
    buffer_load_dwordx4 v[104:107], v119, s[12:15], s10 offen offset:256 sc1
    s_mov_b64 exec, -1
    s_waitcnt vmcnt(0)
    v_xor_b32 v101, v101, v112
    v_xor_b32 v103, v103, v112
    v_xor_b32 v105, v105, v112
    v_xor_b32 v107, v107, v112
    v_or_b32 v101, v101, v103
    s_mov_b32 exec_lo, 0xf000f
    s_mov_b32 exec_hi, exec_lo
    v_or3_b32 v101, v101, v105, v107
    s_mov_b64 exec, -1
    v_cmp_lt_u32 vcc, 15, v101
    s_nop 0
    s_cbranch_vccnz retry_4
    s_branch ready_5
retry_6:
    s_sub_u32 s7, s7, 1
    s_cbranch_scc0 retry_6_go
    s_mov_b32 s7, 0
    s_branch ready_7
retry_6_go:
    buffer_load_dwordx4 v[84:87], v128, s[12:15], s84 offen sc1
    buffer_load_dwordx4 v[88:91], v128, s[12:15], s85 offen sc1
    buffer_load_dwordx4 v[92:95], v128, s[12:15], s86 offen sc1
    buffer_load_dwordx4 v[96:99], v128, s[12:15], s87 offen sc1
    s_waitcnt vmcnt(0)
    v_xor_b32 v84, s72, v84
    v_xor_b32 v85, s73, v85
    v_xor_b32 v86, s74, v86
    v_xor_b32 v87, s75, v87
    v_xor_b32 v88, s72, v88
    v_xor_b32 v89, s73, v89
    v_xor_b32 v90, s74, v90
    v_xor_b32 v91, s75, v91
    v_xor_b32 v92, s72, v92
    v_xor_b32 v93, s73, v93
    v_xor_b32 v94, s74, v94
    v_xor_b32 v95, s75, v95
    v_xor_b32 v96, s72, v96
    v_xor_b32 v97, s73, v97
    v_xor_b32 v98, s74, v98
    v_xor_b32_e64 v99, s75, v99
    v_or3_b32 v28, v84, v85, v86
    v_or3_b32 v29, v87, v88, v89
    v_or3_b32 v30, v90, v91, v92
    v_or3_b32 v31, v93, v94, v95
    v_or3_b32 v32, v96, v97, v98
    v_or3_b32 v28, v28, v29, v30
    v_or3_b32 v31, v31, v32, v99
    v_or_b32 v28, v28, v31
    v_and_b32 v28, 0xff, v28
    v_cmp_ne_u32 vcc, 0, v28
    s_nop 0
    s_cbranch_vccnz retry_6
    s_branch ready_7
retry_8:
    s_sub_u32 s7, s7, 1
    s_cbranch_scc0 retry_8_go
    s_mov_b32 s7, 0
    s_branch ready_9
retry_8_go:
    s_mov_b32 exec_lo, 0xf00ff00f
    s_mov_b32 exec_hi, exec_lo
    buffer_load_dwordx4 v[100:103], v120, s[12:15], s97 offen sc1
    s_mov_b64 exec, -1
    s_waitcnt vmcnt(0)
    v_xor_b32 v100, s72, v100
    v_xor_b32 v101, s73, v101
    v_xor_b32 v102, s74, v102
    v_xor_b32 v103, s75, v103
    v_or3_b32 v122, v100, v101, v102
    v_or_b32 v122, v122, v103
    v_and_b32 v122, 0xff, v122
    s_mov_b32 exec_lo, 0xf00ff00f
    s_mov_b32 exec_hi, exec_lo
    v_cmp_ne_u32 vcc, 0, v122
    s_mov_b64 exec, -1
    s_cbranch_vccnz retry_8
    s_branch ready_9
retry_10:
    s_sub_u32 s7, s7, 1
    s_cbranch_scc0 retry_10_go
    s_mov_b32 s7, 0
    s_branch ready_11
retry_10_go:
    buffer_load_dwordx4 v[84:87], v128, s[12:15], s84 offen sc1
    buffer_load_dwordx4 v[88:91], v128, s[12:15], s85 offen sc1
    buffer_load_dwordx4 v[92:95], v128, s[12:15], s86 offen sc1
    buffer_load_dwordx4 v[96:99], v128, s[12:15], s87 offen sc1
    s_waitcnt vmcnt(0)
    v_xor_b32 v84, s72, v84
    v_xor_b32 v85, s73, v85
    v_xor_b32 v86, s74, v86
    v_xor_b32 v87, s75, v87
    v_xor_b32 v88, s72, v88
    v_xor_b32 v89, s73, v89
    v_xor_b32 v90, s74, v90
    v_xor_b32 v91, s75, v91
    v_xor_b32 v92, s72, v92
    v_xor_b32 v93, s73, v93
    v_xor_b32 v94, s74, v94
    v_xor_b32 v95, s75, v95
    v_xor_b32 v96, s72, v96
    v_xor_b32 v97, s73, v97
    v_xor_b32 v98, s74, v98
    v_xor_b32_e64 v99, s75, v99
    v_or3_b32 v150, v84, v85, v86
    v_or3_b32 v151, v87, v88, v89
    v_or3_b32 v152, v90, v91, v92
    v_or3_b32 v153, v93, v94, v95
    v_or3_b32 v154, v96, v97, v98
    v_or3_b32 v150, v150, v151, v152
    v_or3_b32 v153, v153, v154, v99
    v_or_b32 v150, v150, v153
    v_and_b32 v150, 0xff, v150
    v_cmp_ne_u32 vcc, 0, v150
    s_nop 0
    s_cbranch_vccnz retry_10
    s_branch ready_11
retry_12:
    s_sub_u32 s7, s7, 1
    s_cbranch_scc0 retry_12_go
    s_mov_b32 s7, 0
    s_branch ready_13
retry_12_go:
    buffer_load_dword v113, v15, s[12:15], s18 offen sc1
    s_waitcnt vmcnt(0)
    v_cmp_ne_u32 vcc, s6, v113
    s_nop 0
    s_cbranch_vccnz retry_12
    s_branch ready_13
retry_14:
    s_sub_u32 s7, s7, 1
    s_cbranch_scc0 retry_14_go
    s_mov_b32 s7, 0
    s_branch ready_15
retry_14_go:
    buffer_load_dword v14, v3, s[12:15], s22 offen sc1
    s_waitcnt vmcnt(0)
    v_cmp_ne_u32 vcc, s6, v14
    s_nop 0
    s_cbranch_vccnz retry_14
    s_branch ready_15
retry_16:
    s_sub_u32 s7, s7, 1
    s_cbranch_scc0 retry_16_go
    s_mov_b32 s7, 0
    s_branch ready_17
retry_16_go:
    buffer_load_dword v14, v3, s[12:15], s22 offen sc1
    s_waitcnt vmcnt(0)
    v_cmp_ne_u32 vcc, s6, v14
    s_nop 0
    s_cbranch_vccnz retry_16
    s_branch ready_17
retry_18:
    s_sub_u32 s7, s7, 1
    s_cbranch_scc0 retry_18_go
    s_mov_b32 s7, 0
    s_branch ready_19
retry_18_go:
    buffer_load_dword v14, v3, s[12:15], s22 offen sc1
    s_waitcnt vmcnt(0)
    v_cmp_ne_u32 vcc, s6, v14
    s_nop 0
    s_cbranch_vccnz retry_18
    s_branch ready_19
retry_20:
    s_sub_u32 s7, s7, 1
    s_cbranch_scc0 retry_20_go
    s_mov_b32 s7, 0
    s_branch ready_21
retry_20_go:
    buffer_load_dword v14, v3, s[12:15], s22 offen sc1
    s_waitcnt vmcnt(0)
    v_cmp_ne_u32 vcc, s6, v14
    s_nop 0
    s_cbranch_vccnz retry_20
    s_branch ready_21
retry_22:
    s_sub_u32 s7, s7, 1
    s_cbranch_scc0 retry_22_go
    s_mov_b32 s7, 0
    s_branch ready_23
retry_22_go:
    buffer_load_dword v14, v3, s[12:15], s22 offen sc1
    s_waitcnt vmcnt(0)
    v_cmp_ne_u32 vcc, s6, v14
    s_nop 0
    s_cbranch_vccnz retry_22
    s_branch ready_23
retry_24:
    s_sub_u32 s7, s7, 1
    s_cbranch_scc0 retry_24_go
    s_mov_b32 s7, 0
    s_branch ready_25
retry_24_go:
    buffer_load_dword v14, v3, s[12:15], s22 offen sc1
    s_waitcnt vmcnt(0)
    v_cmp_ne_u32 vcc, s6, v14
    s_nop 0
    s_cbranch_vccnz retry_24
    s_branch ready_25
retry_26:
    s_sub_u32 s7, s7, 1
    s_cbranch_scc0 retry_26_go
    s_mov_b32 s7, 0
    s_branch ready_27
retry_26_go:
    buffer_load_dword v14, v3, s[12:15], s22 offen sc1
    s_waitcnt vmcnt(0)
    v_cmp_ne_u32 vcc, s6, v14
    s_nop 0
    s_cbranch_vccnz retry_26
    s_branch ready_27
retry_28:
    s_sub_u32 s7, s7, 1
    s_cbranch_scc0 retry_28_go
    s_mov_b32 s7, 0
    s_branch ready_29
retry_28_go:
    buffer_load_dword v14, v3, s[12:15], s22 offen sc1
    s_waitcnt vmcnt(0)
    v_cmp_ne_u32 vcc, s6, v14
    s_nop 0
    s_cbranch_vccnz retry_28
    s_branch ready_29
L_fast_end:
L_slow:
    s_waitcnt lgkmcnt(2)
    v_mfma_f32_16x16x32_bf16 v[196:199], a[184:187], v[156:159], v[196:199]
    v_add_u32 v244, 49152, v244
    v_add_u32 v245, 49152, v245
    v_mfma_f32_16x16x32_bf16 v[176:179], v[156:159], a[188:191], v[176:179]
    buffer_load_dwordx4 a[212:215], v115, s[12:15], s81 offen sc1
    s_add_u32 s81, s81, 32768
    s_waitcnt lgkmcnt(1)
    v_mfma_f32_16x16x32_bf16 v[200:203], a[184:187], v[160:163], v[200:203]
    v_add_u32 v246, 49152, v246
    v_add_u32 v247, 49152, v247
    v_mfma_f32_16x16x32_bf16 v[180:183], v[160:163], a[188:191], v[180:183]
    ds_read_b128 v[148:151], v244 offset:16384
    ds_read_b128 v[152:155], v244 offset:20480
    v_mfma_f32_16x16x32_bf16 v[216:219], a[180:183], v[160:163], v[216:219]
    s_getpc_b64 s[40:41]
L_pf2_s:
    v_min_u32 v19, pf_last2, v0
    global_load_dword v18, v19, s[40:41]
    s_waitcnt lgkmcnt(2)
    v_mfma_f32_16x16x32_bf16 v[204:207], a[184:187], v[164:167], v[204:207]
    v_cvt_pk_bf16_f32 v136, v196, v197
    v_mfma_f32_16x16x32_bf16 v[184:187], v[164:167], a[188:191], v[184:187]
    v_mfma_f32_16x16x32_bf16 v[220:223], a[180:183], v[164:167], v[220:223]
    s_waitcnt lgkmcnt(1)
    v_mfma_f32_16x16x32_bf16 v[208:211], a[100:103], v[148:151], v[208:211]
    v_cvt_pk_bf16_f32 v137, v198, v199
    v_cvt_pk_bf16_f32 v138, v200, v201
    v_mfma_f32_16x16x32_bf16 v[188:191], v[148:151], a[104:107], v[188:191]
    ds_read_b128 v[168:171], v245 offset:16384
    v_cvt_pk_bf16_f32 v139, v202, v203
    v_mfma_f32_16x16x32_bf16 v[224:227], a[96:99], v[148:151], v[224:227]
    v_cvt_pk_bf16_f32 v140, v204, v205
    ds_read_b128 v[172:175], v245 offset:20480
    s_waitcnt lgkmcnt(2)
    v_mfma_f32_16x16x32_bf16 v[212:215], a[100:103], v[152:155], v[212:215]
    v_cvt_pk_bf16_f32 v141, v206, v207
    v_cvt_pk_bf16_f32 v20, v216, v217
    v_mfma_f32_16x16x32_bf16 v[192:195], v[152:155], a[104:107], v[192:195]
    buffer_load_dwordx4 a[216:219], v115, s[12:15], s81 offen sc1
    s_add_u32 s81, s81, 32768
    v_cvt_pk_bf16_f32 v21, v218, v219
    s_nop 1
    v_mfma_f32_16x16x16_bf16 v[196:199], v[136:137], v[20:21], v[236:239]
    v_cvt_pk_bf16_f32 v22, v220, v221
    v_mfma_f32_16x16x32_bf16 v[228:231], a[96:99], v[152:155], v[228:231]
    v_cvt_pk_bf16_f32 v23, v222, v223
    buffer_load_dwordx4 a[220:223], v115, s[12:15], s81 offen sc1
    s_add_u32 s81, s81, 32768
    v_mfma_f32_16x16x16_bf16 v[200:203], v[138:139], v[20:21], v[240:243]
    s_waitcnt lgkmcnt(1)
    v_mfma_f32_16x16x32_bf16 v[208:211], a[112:115], v[168:171], v[208:211]
    ds_read_b128 v[148:151], v246 offset:16384
    buffer_load_dwordx4 a[224:227], v115, s[12:15], s81 offen sc1
    s_add_u32 s81, s81, 32768
    v_mfma_f32_16x16x32_bf16 v[188:191], v[168:171], a[116:119], v[188:191]
    ds_read_b128 v[152:155], v246 offset:20480
    v_mfma_f32_16x16x16_bf16 v[204:207], v[138:139], v[22:23], v[236:239]
    buffer_load_dwordx4 a[228:231], v115, s[12:15], s81 offen sc1
    s_add_u32 s81, s81, 32768
    v_mfma_f32_16x16x32_bf16 v[224:227], a[108:111], v[168:171], v[224:227]
    v_cvt_pk_bf16_f32 v156, v176, v177
    v_cvt_pk_bf16_f32 v157, v178, v179
    v_mfma_f32_16x16x16_bf16 v[216:219], v[140:141], v[22:23], v[240:243]
    v_cvt_pk_bf16_f32 v158, v180, v181
    v_cvt_pk_bf16_f32 v159, v182, v183
    s_waitcnt lgkmcnt(2)
    v_mfma_f32_16x16x32_bf16 v[212:215], a[112:115], v[172:175], v[212:215]
    v_mfma_f32_16x16x32_bf16 v[192:195], v[172:175], a[116:119], v[192:195]
    v_mfma_f32_16x16x32_bf16 v[228:231], a[108:111], v[172:175], v[228:231]
    s_waitcnt lgkmcnt(1)
    v_mfma_f32_16x16x32_bf16 v[208:211], a[124:127], v[148:151], v[208:211]
    v_cvt_pk_bf16_f32 v160, v184, v185
    v_cvt_pk_bf16_f32 v161, v186, v187
    v_add_f32 v196, s91, v196
    v_mfma_f32_16x16x32_bf16 v[188:191], v[148:151], a[128:131], v[188:191]
    ds_read_b128 v[168:171], v247 offset:16384
    v_add_f32 v197, s91, v197
    v_add_f32 v198, s91, v198
    v_mfma_f32_16x16x32_bf16 v[224:227], a[120:123], v[148:151], v[224:227]
    ds_read_b128 v[172:175], v247 offset:20480
    buffer_load_dwordx4 a[232:235], v115, s[12:15], s81 offen sc1
    s_add_u32 s81, s81, 32768
    s_waitcnt lgkmcnt(2)
    v_mfma_f32_16x16x32_bf16 v[212:215], a[124:127], v[152:155], v[212:215]
    v_add_f32 v199, s91, v199
    v_max3_f32 v24, v196, v197, v200
    v_max3_f32 v25, v198, v199, v202
    v_mfma_f32_16x16x32_bf16 v[192:195], v[152:155], a[128:131], v[192:195]
    v_max_f32 v24, v24, v201
    v_max_f32 v25, v25, v203
    v_max_f32 v32, v24, v25
    v_mfma_f32_16x16x32_bf16 v[228:231], a[120:123], v[152:155], v[228:231]
    v_max3_f32 v26, v204, v205, v216
    v_max3_f32 v27, v206, v207, v218
    v_max_f32 v26, v26, v217
    v_max_f32 v27, v27, v219
    s_waitcnt lgkmcnt(1)
    v_mfma_f32_16x16x32_bf16 v[208:211], a[136:139], v[168:171], v[208:211]
    buffer_load_dwordx4 a[236:239], v115, s[12:15], s81 offen sc1
    s_add_u32 s81, s81, 32768
    v_max_f32 v33, v26, v27
    v_mfma_f32_16x16x32_bf16 v[188:191], v[168:171], a[140:143], v[188:191]
    s_nop 0
    v_permlane32_swap_b32 v32, v33
    ds_read_b128 v[148:151], v244 offset:24576
    v_max_f32 v32, v32, v33
    v_mfma_f32_16x16x32_bf16 v[224:227], a[132:135], v[168:171], v[224:227]
    v_mov_b32 v33, v32
    ds_read_b128 v[152:155], v244 offset:28672
    s_nop 0
    v_permlane16_swap_b32 v32, v33
    s_waitcnt lgkmcnt(2)
    v_mfma_f32_16x16x32_bf16 v[212:215], a[136:139], v[172:175], v[212:215]
    v_max_f32 v32, v32, v33
    v_mul_f32 v32, s88, v32
    v_mov_b32 v33, v32
    v_mfma_f32_16x16x32_bf16 v[192:195], v[172:175], a[140:143], v[192:195]
    buffer_load_dwordx4 a[240:243], v115, s[12:15], s81 offen sc1
    s_add_u32 s81, s81, 32768
    v_permlane32_swap_b32 v32, v33
    v_mfma_f32_16x16x32_bf16 v[228:231], a[132:135], v[172:175], v[228:231]
    v_fma_f32 v24, v24, s88, -v32
    v_fma_f32 v25, v25, s88, -v32
    v_fma_f32 v26, v26, s88, -v33
    s_waitcnt lgkmcnt(1)
    v_mfma_f32_16x16x32_bf16 v[208:211], a[148:151], v[148:151], v[208:211]
    v_fma_f32 v27, v27, s88, -v33
    v_exp_f32 v24, v24
    v_mfma_f32_16x16x32_bf16 v[188:191], v[148:151], a[152:155], v[188:191]
    ds_read_b128 v[168:171], v245 offset:24576
    v_exp_f32 v25, v25
    v_mfma_f32_16x16x32_bf16 v[224:227], a[144:147], v[148:151], v[224:227]
    ds_read_b128 v[172:175], v245 offset:28672
    buffer_load_dwordx4 a[244:247], v115, s[12:15], s81 offen sc1
    s_add_u32 s81, s81, 32768
    s_waitcnt lgkmcnt(2)
    v_mfma_f32_16x16x32_bf16 v[212:215], a[148:151], v[152:155], v[212:215]
    v_exp_f32 v26, v26
    v_exp_f32 v27, v27
    v_mfma_f32_16x16x32_bf16 v[192:195], v[152:155], a[152:155], v[192:195]
    v_cvt_pk_bf16_f32 v24, v24, v24
    v_cvt_pk_bf16_f32 v25, v25, v25
    v_cvt_pk_bf16_f32 v26, v26, v26
    v_mfma_f32_16x16x32_bf16 v[228:231], a[144:147], v[152:155], v[228:231]
    v_cvt_pk_bf16_f32 v27, v27, v27
    v_and_b32 v176, v24, v232
    v_and_b32 v178, v24, v234
    s_waitcnt lgkmcnt(1)
    v_mfma_f32_16x16x32_bf16 v[208:211], a[160:163], v[168:171], v[208:211]
    buffer_load_dwordx4 a[248:251], v115, s[12:15], s81 offen sc1
    s_add_u32 s81, s81, 32768
    v_mfma_f32_16x16x32_bf16 v[188:191], v[168:171], a[164:167], v[188:191]
    v_and_b32 v177, v25, v233
    v_and_b32 v179, v25, v235
    v_mfma_f32_16x16x32_bf16 v[224:227], a[156:159], v[168:171], v[224:227]
    ds_read_b128 v[148:151], v246 offset:24576
    v_and_b32 v180, v26, v232
    v_mfma_f32_16x16x32_bf16 v[200:203], v[248:251], v[176:179], 0
    v_and_b32 v182, v26, v234
    v_and_b32 v181, v27, v233
    s_waitcnt lgkmcnt(1)
    v_mfma_f32_16x16x32_bf16 v[212:215], a[160:163], v[172:175], v[212:215]
    ds_read_b128 v[152:155], v246 offset:28672
    v_and_b32 v183, v27, v235
    v_mfma_f32_16x16x32_bf16 v[192:195], v[172:175], a[164:167], v[192:195]
    buffer_load_dwordx4 a[252:255], v115, s[12:15], s81 offen sc1
    s_add_u32 s81, s81, 32768
    v_mfma_f32_16x16x32_bf16 v[216:219], v[248:251], v[180:183], 0
    v_mfma_f32_16x16x32_bf16 v[228:231], a[156:159], v[172:175], v[228:231]
    v_mfma_f32_16x16x32_bf16 v[196:199], v[156:159], v[176:179], 0
    s_waitcnt lgkmcnt(1)
    v_mfma_f32_16x16x32_bf16 v[208:211], a[172:175], v[148:151], v[208:211]
    ds_read_b128 v[168:171], v247 offset:24576
    buffer_load_dwordx4 v[36:39], v15, s[12:15], s92 offen sc1
    v_mfma_f32_16x16x32_bf16 v[188:191], v[148:151], a[176:179], v[188:191]
    ds_read_b128 v[172:175], v247 offset:28672
    v_rcp_f32 v32, v200
    v_mfma_f32_16x16x32_bf16 v[204:207], v[158:161], v[180:183], 0
    v_rcp_f32 v33, v216
    v_mfma_f32_16x16x32_bf16 v[224:227], a[168:171], v[148:151], v[224:227]
    v_mul_f32 v196, v196, v32
    s_waitcnt lgkmcnt(2)
    v_mfma_f32_16x16x32_bf16 v[212:215], a[172:175], v[152:155], v[212:215]
    buffer_load_dwordx4 v[40:43], v252, s[12:15], s92 offen sc1
    v_mul_f32 v197, v197, v32
    v_mfma_f32_16x16x32_bf16 v[192:195], v[152:155], a[176:179], v[192:195]
    v_mul_f32 v198, v198, v32
    v_mul_f32 v199, v199, v32
    v_mfma_f32_16x16x32_bf16 v[228:231], a[168:171], v[152:155], v[228:231]
    s_waitcnt lgkmcnt(1)
    v_mfma_f32_16x16x32_bf16 v[208:211], a[184:187], v[168:171], v[208:211]
    v_mul_f32 v204, v204, v33
    v_mul_f32 v205, v205, v33
    v_mul_f32 v206, v206, v33
    v_mul_f32 v207, v207, v33
    v_cvt_pk_bf16_f32 v28, v196, v197
    v_cvt_pk_bf16_f32 v30, v204, v205
    v_cvt_pk_bf16_f32 v29, v198, v199
    buffer_load_dwordx4 v[44:47], v253, s[12:15], s92 offen sc1
    s_add_u32 s92, s92, 90112
    v_cvt_pk_bf16_f32 v31, v206, v207
    v_permlane16_swap_b32 v28, v30
    s_nop 0
    v_permlane16_swap_b32 v29, v31
    buffer_store_dwordx4 v[28:31], v5, s[12:15], s89 offen sc1
    v_mfma_f32_16x16x32_bf16 v[188:191], v[168:171], a[188:191], v[188:191]
    s_add_u32 s89, s89, 32768
    v_cvt_pk_bf16_f32 v142, v208, v209
    v_cvt_pk_bf16_f32 v143, v210, v211
    v_mfma_f32_16x16x32_bf16 v[224:227], a[180:183], v[168:171], v[224:227]
    s_waitcnt lgkmcnt(0)
    v_mfma_f32_16x16x32_bf16 v[212:215], a[184:187], v[172:175], v[212:215]
    s_nop 7
    v_cvt_pk_bf16_f32 v144, v212, v213
    v_cvt_pk_bf16_f32 v145, v214, v215
    v_cvt_pk_bf16_f32 v20, v224, v225
    v_cvt_pk_bf16_f32 v21, v226, v227
    v_mfma_f32_16x16x32_bf16 v[192:195], v[172:175], a[188:191], v[192:195]
    v_mfma_f32_16x16x32_bf16 v[228:231], a[180:183], v[172:175], v[228:231]
    s_nop 7
    v_cvt_pk_bf16_f32 v22, v228, v229
    v_cvt_pk_bf16_f32 v23, v230, v231
    s_waitcnt vmcnt(21)
    v_xor_b32 v84, s72, v84
    v_xor_b32 v85, s73, v85
    v_xor_b32 v86, s74, v86
    v_xor_b32 v87, s75, v87
    s_waitcnt vmcnt(19)
    v_xor_b32 v88, s72, v88
    v_xor_b32 v89, s73, v89
    v_xor_b32 v90, s74, v90
    v_xor_b32 v91, s75, v91
    s_waitcnt vmcnt(18)
    v_xor_b32 v92, s72, v92
    v_xor_b32 v93, s73, v93
    v_xor_b32 v94, s74, v94
    v_xor_b32 v95, s75, v95
    s_waitcnt vmcnt(17)
    v_xor_b32 v96, s72, v96
    v_xor_b32 v97, s73, v97
    v_xor_b32 v98, s74, v98
    v_xor_b32 v99, s75, v99
    v_or3_b32 v150, v84, v85, v86
    v_or3_b32 v151, v87, v88, v89
    v_or3_b32 v152, v90, v91, v92
    v_or3_b32 v153, v93, v94, v95
    v_or3_b32 v154, v96, v97, v98
    v_or3_b32 v150, v150, v151, v152
    v_or3_b32 v153, v153, v154, v99
    v_or_b32 v150, v150, v153
    v_and_b32 v150, 0xff, v150
    v_cmp_ne_u32 vcc, 0, v150
    s_nop 0
    s_cbranch_vccnz retry_10_s
ready_11_s:
    v_mfma_f32_16x16x16_bf16 v[196:199], v[140:141], v[20:21], v[236:239]
    buffer_load_dwordx4 v[48:51], v15, s[12:15], s92 offen sc1
    v_cvt_pk_bf16_f32 v162, v188, v189
    v_mfma_f32_16x16x16_bf16 v[200:203], v[142:143], v[20:21], v[240:243]
    v_cvt_pk_bf16_f32 v163, v190, v191
    v_cvt_pk_bf16_f32 v164, v192, v193
    v_cvt_pk_bf16_f32 v165, v194, v195
    s_nop 4
    v_max3_f32 v24, v196, v197, v200
    v_max3_f32 v25, v198, v199, v202
    v_max_f32 v24, v24, v201
    v_max_f32 v25, v25, v203
    v_max_f32 v32, v24, v25
    v_mfma_f32_16x16x16_bf16 v[204:207], v[142:143], v[22:23], v[236:239]
    v_mfma_f32_16x16x16_bf16 v[216:219], v[144:145], v[22:23], v[240:243]
    s_nop 7
    v_max3_f32 v26, v204, v205, v216
    v_max3_f32 v27, v206, v207, v218
    v_max_f32 v26, v26, v217
    v_max_f32 v27, v27, v219
    v_max_f32 v33, v26, v27
    s_nop 1
    v_permlane32_swap_b32 v32, v33
    buffer_load_dwordx4 v[52:55], v252, s[12:15], s92 offen sc1
    v_max_f32 v32, v32, v33
    v_mov_b32 v33, v32
    s_nop 1
    v_permlane16_swap_b32 v32, v33
    v_max_f32 v32, v32, v33
    v_mul_f32 v32, s88, v32
    v_mov_b32 v33, v32
    s_nop 1
    v_permlane32_swap_b32 v32, v33
    v_add_f32 v84, v84, v88
    v_fma_f32 v24, v24, s88, -v32
    v_fma_f32 v25, v25, s88, -v32
    v_add_f32 v85, v85, v89
    v_fma_f32 v26, v26, s88, -v33
    v_add_f32 v86, v86, v90
    buffer_load_dwordx4 v[56:59], v253, s[12:15], s92 offen sc1
    s_add_u32 s92, s92, 90112
    v_fma_f32 v27, v27, s88, -v33
    v_exp_f32 v24, v24
    v_add_f32 v87, v87, v91
    v_add_f32 v92, v92, v96
    v_exp_f32 v25, v25
    v_add_f32 v93, v93, v97
    v_exp_f32 v26, v26
    v_add_f32 v94, v94, v98
    s_waitcnt vmcnt(3)
    s_mov_b64 exec, 1
    buffer_store_dword v2, v4, s[12:15], s17 offen sc1
    s_mov_b64 exec, -1
    s_add_u32 s17, s17, 128
    v_exp_f32 v27, v27
    v_add_f32 v95, v95, v99
    v_cvt_pk_bf16_f32 v24, v24, v24
    v_cvt_pk_bf16_f32 v25, v25, v25
    v_add_f32 v84, v84, v92
    v_cvt_pk_bf16_f32 v26, v26, v26
    v_cvt_pk_bf16_f32 v27, v27, v27
    v_add_f32 v85, v85, v93
    v_and_b32 v176, v24, v232
    v_and_b32 v178, v24, v234
    v_add_f32 v86, v86, v94
    v_and_b32 v177, v25, v233
    buffer_load_dwordx4 v[60:63], v15, s[12:15], s92 offen sc1
    v_add_f32 v87, v87, v95
    v_and_b32 v179, v25, v235
    s_nop 1
    v_mfma_f32_16x16x32_bf16 v[200:203], v[248:251], v[176:179], 0
    v_and_b32 v180, v26, v232
    v_cvt_pk_bf16_f32 v88, v84, v85
    v_and_b32 v182, v26, v234
    v_and_b32 v181, v27, v233
    v_cvt_pk_bf16_f32 v89, v86, v87
    v_and_b32 v183, v27, v235
    s_nop 1
    v_mfma_f32_16x16x32_bf16 v[216:219], v[248:251], v[180:183], 0
    v_mfma_f32_16x16x32_bf16 v[196:199], v[160:163], v[176:179], 0
    v_mfma_f32_16x16x32_bf16 v[204:207], v[162:165], v[180:183], 0
    v_lshlrev_b32 v84, 16, v88
    v_and_b32 v85, s16, v88
    v_lshlrev_b32 v86, 16, v89
    v_and_b32 v87, s16, v89
    buffer_load_dwordx4 v[64:67], v252, s[12:15], s92 offen sc1
    v_add_f32 v84, v129, v84
    v_add_f32 v85, v129, v85
    v_add_f32 v86, v129, v86
    v_add_f32 v87, v129, v87
    v_cvt_pk_bf16_f32 v88, v84, v85
    v_cvt_pk_bf16_f32 v89, v86, v87
    v_rcp_f32 v32, v200
    v_mul_u32_u24 v148, 1088, v130
    v_rcp_f32 v33, v216
    buffer_load_dwordx4 v[68:71], v253, s[12:15], s92 offen sc1
    s_add_u32 s92, s92, 90112
    v_lshl_add_u32 v148, v11, 4, v148
    v_mul_f32 v196, v196, v32
    v_mul_f32 v197, v197, v32
    v_and_b32 v149, 1, v12
    v_mul_f32 v198, v198, v32
    v_mul_f32 v199, v199, v32
    v_lshl_add_u32 v148, v149, 3, v148
    v_mul_f32 v204, v204, v33
    s_lshl_b32 s65, s3, 8
    v_mul_f32 v205, v205, v33
    v_mul_f32 v206, v206, v33
    s_add_u32 s65, s65, 155648
    v_mul_f32 v207, v207, v33
    v_cvt_pk_bf16_f32 v28, v196, v197
    buffer_load_dwordx4 v[72:75], v15, s[12:15], s92 offen sc1
    v_add_u32_e64 v148, s65, v148
    v_cvt_pk_bf16_f32 v30, v204, v205
    v_cvt_pk_bf16_f32 v29, v198, v199
    ds_write_b64 v148, v[88:89]
    v_cvt_pk_bf16_f32 v31, v206, v207
    v_and_b32 v149, 0x3ff, v0
    v_permlane16_swap_b32 v28, v30
    v_add_u32 v149, 157824, v149
    v_permlane16_swap_b32 v29, v31
    ds_write_b32 v149, v7
    buffer_store_dwordx4 v[28:31], v5, s[12:15], s89 offen sc1
    buffer_load_dword v14, v3, s[12:15], s22 offen sc1
    s_lshr_b32 s64, s8, 1
    s_lshl_b32 s64, s64, 11
    s_add_u32 s11, s10, s64
    s_and_b32 s64, s8, 1
    s_lshl_b32 s64, s64, 9
    s_add_u32 s11, s11, s64
    s_add_u32 s11, s11, 0x25000
    s_lshl_b32 s64, s4, 10
    s_add_u32 s18, s10, s64
    s_add_u32 s18, s18, 0x1000
    s_lshl_b32 s64, s3, 4
    s_lshl_b64 s[20:21], 0xffff, s64
    s_lshl_b32 s64, s3, 10
    s_add_u32 s64, s64, 69632
    v_add_u32 v112, s64, v15
    buffer_load_dwordx4 v[76:79], v252, s[12:15], s92 offen sc1
    v_add_u32 v113, 69632, v15
    s_and_b32 s64, s3, 1
    s_lshl_b32 s64, s64, 9
    v_add_u32 v116, s64, v5
    v_add_u32 v117, 0x10000, v116
    v_add_u32 v118, 0x20000, v116
    s_lshl_b32 s64, s3, 11
    s_add_u32 s64, s64, 49152
    v_add_u32 v9, s64, v15
    v_xor_b32 v10, 2048, v9
    s_waitcnt vmcnt(2)
    s_mov_b64 exec, 1
    buffer_store_dword v2, v4, s[12:15], s17 offen sc1
    s_mov_b64 exec, -1
    s_add_u32 s17, s17, 128
    s_waitcnt vmcnt(2)
    v_cmp_ne_u32 vcc, s6, v14
    s_nop 0
    s_cbranch_vccnz retry_14_s
ready_15_s:
    s_add_u32 s22, s22, 128
    s_lshl_b32 s39, s3, 12
    s_add_u32 s38, s10, s39
    s_add_u32 s38, s38, 0x3a800
    s_add_u32 m0, s39, 81920
    s_nop 0
    buffer_load_dwordx4 v15, s[12:15], s38 offen offset:0 sc1 lds
    buffer_load_dwordx4 v15, s[12:15], s38 offen offset:1024 sc1 lds
    buffer_load_dwordx4 v15, s[12:15], s38 offen offset:2048 sc1 lds
    buffer_load_dwordx4 v15, s[12:15], s38 offen offset:3072 sc1 lds
    s_add_u32 s38, s38, 16384
    s_waitcnt lgkmcnt(0)
    s_barrier
    s_add_u32 m0, s39, 98304
    s_nop 0
    buffer_load_dwordx4 v15, s[12:15], s38 offen offset:0 sc1 lds
    v_min_u32 v114, 2, v11
    v_mul_u32_u24 v114, 1088, v114
    v_lshl_add_u32 v114, v12, 4, v114
    v_add_u32 v114, 155648, v114
    v_xor_b32 v100, s72, v100
    v_xor_b32 v101, s73, v101
    v_xor_b32 v102, s74, v102
    v_xor_b32 v103, s75, v103
    v_or3_b32 v122, v100, v101, v102
    v_or_b32 v122, v122, v103
    v_and_b32 v122, 0xff, v122
    s_mov_b32 exec_lo, 0xf00ff00f
    s_mov_b32 exec_hi, exec_lo
    v_cmp_ne_u32 vcc, 0, v122
    s_mov_b64 exec, -1
    s_cbranch_vccnz retry_8_s
ready_9_s:
    buffer_load_dwordx4 v15, s[12:15], s38 offen offset:1024 sc1 lds
    v_xor_b32 v126, 16, v127
    ds_read_b64 v[86:87], v127 offset:0
    ds_read_b64 v[90:91], v126 offset:0
    ds_read_b64 v[94:95], v127 offset:4096
    ds_read_b64 v[98:99], v126 offset:4096
    buffer_load_dwordx4 v15, s[12:15], s38 offen offset:2048 sc1 lds
    v_add_f32_dpp v100, v100, v100 quad_perm:[1,0,3,2] row_mask:0xf bank_mask:0xf
    v_add_f32_dpp v101, v101, v101 quad_perm:[1,0,3,2] row_mask:0xf bank_mask:0xf
    v_add_f32_dpp v102, v102, v102 quad_perm:[1,0,3,2] row_mask:0xf bank_mask:0xf
    v_add_f32_dpp v103, v103, v103 quad_perm:[1,0,3,2] row_mask:0xf bank_mask:0xf
    v_add_f32_dpp v100, v100, v100 quad_perm:[2,3,0,1] row_mask:0xf bank_mask:0xf
    v_add_f32_dpp v101, v101, v101 quad_perm:[2,3,0,1] row_mask:0xf bank_mask:0xf
    v_add_f32_dpp v102, v102, v102 quad_perm:[2,3,0,1] row_mask:0xf bank_mask:0xf
    buffer_load_dwordx4 v15, s[12:15], s38 offen offset:3072 sc1 lds
    s_add_u32 s38, s38, 16384
    v_add_f32_dpp v103, v103, v103 quad_perm:[2,3,0,1] row_mask:0xf bank_mask:0xf
    v_cvt_pk_bf16_f32 v122, v100, v101
    v_cvt_pk_bf16_f32 v123, v102, v103
    s_mov_b32 exec_lo, 0xff00ff0
    s_mov_b32 exec_hi, exec_lo
    ds_read_b64 v[122:123], v121
    s_mov_b64 exec, -1
    s_waitcnt lgkmcnt(4)
    v_lshlrev_b32 v84, 16, v86
    v_and_b32 v85, s16, v86
    v_lshlrev_b32 v86, 16, v87
    v_and_b32 v87, s16, v87
    s_waitcnt lgkmcnt(3)
    v_lshlrev_b32 v88, 16, v90
    v_and_b32 v89, s16, v90
    v_lshlrev_b32 v90, 16, v91
    buffer_load_dword v14, v3, s[12:15], s22 offen sc1
    v_and_b32 v91, s16, v91
    s_waitcnt lgkmcnt(2)
    v_lshlrev_b32 v92, 16, v94
    v_and_b32 v93, s16, v94
    v_lshlrev_b32 v94, 16, v95
    v_and_b32 v95, s16, v95
    s_waitcnt lgkmcnt(1)
    v_lshlrev_b32 v96, 16, v98
    v_and_b32 v97, s16, v98
    v_lshlrev_b32 v98, 16, v99
    v_and_b32 v99, s16, v99
    v_lshlrev_b32 v108, 16, v110
    v_and_b32 v109, s16, v110
    v_lshlrev_b32 v110, 16, v111
    v_and_b32 v111, s16, v111
    s_waitcnt lgkmcnt(0)
    v_mov_b32 v124, v122
    v_mov_b32 v125, v123
    buffer_load_dwordx4 v[80:83], v253, s[12:15], s92 offen sc1
    s_add_u32 s92, s92, 90112
    v_permlane16_swap_b32 v122, v124
    v_permlane16_swap_b32 v123, v125
    v_lshlrev_b32 v100, 16, v122
    v_and_b32 v101, s16, v122
    v_lshlrev_b32 v102, 16, v123
    v_and_b32 v103, s16, v123
    v_lshlrev_b32 v104, 16, v124
    v_and_b32 v105, s16, v124
    v_lshlrev_b32 v106, 16, v125
    v_and_b32 v107, s16, v125
    s_waitcnt vmcnt(6)
    s_barrier
    s_nop 0
    buffer_load_dwordx4 a[0:3], v15, s[12:15], s92 offen sc1
    ds_read_b128 v[180:183], v117 offset:16384
    ds_read_b128 v[184:187], v117 offset:18432
    ds_read_b128 v[188:191], v117 offset:20480
    ds_read_b128 v[192:195], v117 offset:22528
    s_waitcnt lgkmcnt(2)
    v_mfma_f32_32x32x16_bf16 v[220:235], a[192:195], v[180:183], 0
    ds_read_b128 v[196:199], v117 offset:24576
    ds_read_b128 v[180:183], v117 offset:26624
    buffer_load_dwordx4 a[4:7], v252, s[12:15], s92 offen sc1
    v_mfma_f32_32x32x16_bf16 v[220:235], a[196:199], v[184:187], v[220:235]
    s_waitcnt lgkmcnt(2)
    v_mfma_f32_32x32x16_bf16 v[220:235], a[200:203], v[188:191], v[220:235]
    ds_read_b128 v[184:187], v117 offset:28672
    ds_read_b128 v[188:191], v117 offset:30720
    buffer_load_dwordx4 a[8:11], v253, s[12:15], s92 offen sc1
    s_add_u32 s92, s92, 90112
    v_mfma_f32_32x32x16_bf16 v[220:235], a[204:207], v[192:195], v[220:235]
    s_waitcnt lgkmcnt(2)
    v_mfma_f32_32x32x16_bf16 v[220:235], a[208:211], v[196:199], v[220:235]
    s_waitcnt vmcnt(4)
    v_cmp_ne_u32 vcc, s6, v14
    s_nop 0
    s_cbranch_vccnz retry_16_s
ready_17_s:
    buffer_load_dwordx4 a[12:15], v15, s[12:15], s92 offen sc1
    s_barrier
    v_mfma_f32_32x32x16_bf16 v[220:235], a[212:215], v[180:183], v[220:235]
    ds_read_b128 v[192:195], v117 offset:32768
    ds_read_b128 v[196:199], v117 offset:34816
    s_waitcnt lgkmcnt(2)
    v_mfma_f32_32x32x16_bf16 v[220:235], a[216:219], v[184:187], v[220:235]
    s_add_u32 s22, s22, 128
    s_lshl_b32 s39, s3, 12
    s_add_u32 s38, s10, s39
    s_add_u32 s38, s38, 0x42800
    s_add_u32 m0, s39, 114688
    s_nop 0
    buffer_load_dwordx4 v15, s[12:15], s38 offen offset:0 sc1 lds
    v_mfma_f32_32x32x16_bf16 v[220:235], a[220:223], v[188:191], v[220:235]
    ds_read_b128 v[180:183], v117 offset:36864
    ds_read_b128 v[120:123], v114 offset:512
    ds_read_b128 v[184:187], v117 offset:38912
    s_waitcnt lgkmcnt(3)
    v_mfma_f32_32x32x16_bf16 v[220:235], a[224:227], v[192:195], v[220:235]
    ds_read_b128 v[124:127], v114 offset:576
    ds_read_b128 v[188:191], v117 offset:40960
    buffer_load_dwordx4 v15, s[12:15], s38 offen offset:1024 sc1 lds
    ds_read_b128 v[128:131], v114 offset:640
    ds_read_b128 v[192:195], v117 offset:43008
    v_mfma_f32_32x32x16_bf16 v[220:235], a[228:231], v[196:199], v[220:235]
    s_waitcnt lgkmcnt(4)
    v_mfma_f32_32x32x16_bf16 v[220:235], a[232:235], v[180:183], v[220:235]
    buffer_load_dwordx4 v15, s[12:15], s38 offen offset:2048 sc1 lds
    ds_read_b128 v[132:135], v114 offset:704
    ds_read_b128 v[196:199], v117 offset:45056
    buffer_load_dwordx4 v15, s[12:15], s38 offen offset:3072 sc1 lds
    s_add_u32 s38, s38, 16384
    ds_read_b128 v[136:139], v114 offset:768
    v_mfma_f32_32x32x16_bf16 v[220:235], a[236:239], v[184:187], v[220:235]
    ds_read_b128 v[180:183], v117 offset:47104
    s_waitcnt lgkmcnt(4)
    v_mfma_f32_32x32x16_bf16 v[220:235], a[240:243], v[188:191], v[220:235]
    s_add_u32 m0, s39, 131072
    s_nop 0
    buffer_load_dwordx4 v15, s[12:15], s38 offen offset:0 sc1 lds
    ds_read_b128 v[140:143], v114 offset:832
    buffer_load_dwordx4 v15, s[12:15], s38 offen offset:1024 sc1 lds
    ds_read_b128 v[144:147], v114 offset:896
    v_mfma_f32_32x32x16_bf16 v[220:235], a[244:247], v[192:195], v[220:235]
    s_waitcnt lgkmcnt(2)
    v_mfma_f32_32x32x16_bf16 v[220:235], a[248:251], v[196:199], v[220:235]
    buffer_load_dwordx4 v15, s[12:15], s38 offen offset:2048 sc1 lds
    buffer_load_dwordx4 v15, s[12:15], s38 offen offset:3072 sc1 lds
    s_add_u32 s38, s38, 16384
    ds_read_b128 v[148:151], v114 offset:960
    s_lshr_b32 s64, s8, 1
    s_lshl_b32 s64, s64, 11
    s_add_u32 s76, s10, s64
    s_and_b32 s64, s8, 1
    v_mfma_f32_32x32x16_bf16 v[220:235], a[252:255], v[180:183], v[220:235]
    s_lshl_b32 s64, s64, 9
    s_add_u32 s76, s76, s64
    s_add_u32 s76, s76, 0x25000
    s_add_u32 s77, s76, 32768
    s_lshr_b32 s64, s9, 1
    buffer_load_dwordx4 a[16:19], v252, s[12:15], s92 offen sc1
    s_lshl_b32 s64, s64, 11
    s_add_u32 s78, s10, s64
    v_mfma_f32_16x16x32_bf16 v[176:179], v[120:123], v[120:123], 0
    s_and_b32 s64, s9, 1
    s_lshl_b32 s64, s64, 9
    s_add_u32 s78, s78, s64
    v_mfma_f32_16x16x32_bf16 v[176:179], v[124:127], v[124:127], v[176:179]
    s_add_u32 s78, s78, 0x25000
    s_cmp_lt_u32 s9, 86
    s_cselect_b32 s78, s78, 0x40000000
    v_mfma_f32_16x16x32_bf16 v[176:179], v[128:131], v[128:131], v[176:179]
    buffer_load_dwordx4 a[20:23], v253, s[12:15], s92 offen sc1
    s_add_u32 s92, s92, 90112
    v_mfma_f32_16x16x32_bf16 v[176:179], v[132:135], v[132:135], v[176:179]
    buffer_load_dwordx4 a[24:27], v15, s[12:15], s92 offen sc1
    ds_read_b128 v[120:123], v114 offset:0
    ds_read_b128 v[124:127], v114 offset:64
    v_mfma_f32_16x16x32_bf16 v[176:179], v[136:139], v[136:139], v[176:179]
    ds_read_b128 v[128:131], v114 offset:128
    ds_read_b128 v[132:135], v114 offset:192
    ds_read_b128 v[136:139], v114 offset:256
    s_waitcnt lgkmcnt(7)
    v_mfma_f32_16x16x32_bf16 v[176:179], v[140:143], v[140:143], v[176:179]
    ds_read_b128 v[140:143], v114 offset:320
    s_waitcnt lgkmcnt(7)
    v_mfma_f32_16x16x32_bf16 v[176:179], v[144:147], v[144:147], v[176:179]
    ds_read_b128 v[144:147], v114 offset:384
    s_waitcnt lgkmcnt(7)
    v_mfma_f32_16x16x32_bf16 v[176:179], v[148:151], v[148:151], v[176:179]
    ds_read_b128 v[148:151], v114 offset:448
    ds_write_b128 v9, v[228:231] offset:0
    s_waitcnt lgkmcnt(8)
    v_mfma_f32_16x16x32_bf16 v[176:179], v[120:123], v[120:123], v[176:179]
    s_waitcnt lgkmcnt(7)
    v_mfma_f32_16x16x32_bf16 v[176:179], v[124:127], v[124:127], v[176:179]
    ds_write_b128 v9, v[232:235] offset:1024
    s_waitcnt lgkmcnt(7)
    v_mfma_f32_16x16x32_bf16 v[176:179], v[128:131], v[128:131], v[176:179]
    s_waitcnt lgkmcnt(6)
    v_mfma_f32_16x16x32_bf16 v[176:179], v[132:135], v[132:135], v[176:179]
    s_waitcnt lgkmcnt(5)
    v_mfma_f32_16x16x32_bf16 v[176:179], v[136:139], v[136:139], v[176:179]
    buffer_load_dwordx4 a[28:31], v252, s[12:15], s92 offen sc1
    buffer_load_dwordx4 a[32:35], v253, s[12:15], s92 offen sc1
    s_add_u32 s92, s92, 90112
    s_waitcnt lgkmcnt(4)
    v_mfma_f32_16x16x32_bf16 v[176:179], v[140:143], v[140:143], v[176:179]
    s_waitcnt vmcnt(9)
    s_waitcnt lgkmcnt(0)
    s_barrier
    v_mfma_f32_16x16x32_bf16 v[176:179], v[144:147], v[144:147], v[176:179]
    buffer_load_dwordx4 a[36:39], v15, s[12:15], s92 offen sc1
    v_mfma_f32_16x16x32_bf16 v[176:179], v[148:151], v[148:151], v[176:179]
    ds_read_b128 v[228:231], v10 offset:0
    ds_read_b128 v[232:235], v10 offset:1024
    ds_read_b128 v[180:183], v117 offset:49152
    ds_read_b128 v[184:187], v117 offset:51200
    ds_read_b128 v[188:191], v117 offset:53248
    ds_read_b128 v[192:195], v117 offset:55296
    s_waitcnt lgkmcnt(2)
    v_mfma_f32_32x32x16_bf16 v[236:251], a[192:195], v[180:183], 0
    ds_read_b128 v[196:199], v117 offset:57344
    buffer_load_dwordx4 a[40:43], v252, s[12:15], s92 offen sc1
    v_add_f32 v220, v220, v228
    v_add_f32 v221, v221, v229
    v_add_f32 v222, v222, v230
    ds_read_b128 v[180:183], v117 offset:59392
    v_mfma_f32_32x32x16_bf16 v[236:251], a[196:199], v[184:187], v[236:251]
    s_waitcnt lgkmcnt(2)
    v_mfma_f32_32x32x16_bf16 v[236:251], a[200:203], v[188:191], v[236:251]
    v_add_f32 v223, v223, v231
    v_add_f32 v224, v224, v232
    v_add_f32 v225, v225, v233
    v_add_f32 v226, v226, v234
    v_add_f32 v227, v227, v235
    ds_read_b128 v[184:187], v117 offset:61440
    v_fmac_f32_dpp v84, v100, v220 row_newbcast:0 row_mask:0xf bank_mask:0xf
    v_mfma_f32_32x32x16_bf16 v[236:251], a[204:207], v[192:195], v[236:251]
    buffer_load_dwordx4 a[44:47], v253, s[12:15], s92 offen sc1
    s_add_u32 s92, s92, 90112
    v_fmac_f32_dpp v85, v101, v221 row_newbcast:0 row_mask:0xf bank_mask:0xf
    v_fmac_f32_dpp v86, v102, v222 row_newbcast:0 row_mask:0xf bank_mask:0xf
    v_fmac_f32_dpp v87, v103, v223 row_newbcast:0 row_mask:0xf bank_mask:0xf
    v_fmac_f32_dpp v88, v104, v224 row_newbcast:0 row_mask:0xf bank_mask:0xf
    ds_read_b128 v[188:191], v117 offset:63488
    s_waitcnt lgkmcnt(2)
    v_mfma_f32_32x32x16_bf16 v[236:251], a[208:211], v[196:199], v[236:251]
    v_fmac_f32_dpp v89, v105, v225 row_newbcast:0 row_mask:0xf bank_mask:0xf
    v_fmac_f32_dpp v90, v106, v226 row_newbcast:0 row_mask:0xf bank_mask:0xf
    v_fmac_f32_dpp v91, v107, v227 row_newbcast:0 row_mask:0xf bank_mask:0xf
    v_mul_f32_dpp v228, v100, v84 row_newbcast:8 row_mask:0xf bank_mask:0xf
    v_mul_f32_dpp v229, v101, v85 row_newbcast:8 row_mask:0xf bank_mask:0xf
    s_waitcnt vmcnt(8)
    s_barrier
    v_mfma_f32_32x32x16_bf16 v[236:251], a[212:215], v[180:183], v[236:251]
    buffer_load_dwordx4 a[48:51], v15, s[12:15], s92 offen sc1
    ds_read_b128 v[192:195], v118 offset:0
    v_mul_f32_dpp v230, v102, v86 row_newbcast:8 row_mask:0xf bank_mask:0xf
    v_mul_f32_dpp v231, v103, v87 row_newbcast:8 row_mask:0xf bank_mask:0xf
    v_mul_f32_dpp v232, v104, v88 row_newbcast:8 row_mask:0xf bank_mask:0xf
    v_mul_f32_dpp v233, v105, v89 row_newbcast:8 row_mask:0xf bank_mask:0xf
    ds_read_b128 v[196:199], v118 offset:2048
    s_waitcnt lgkmcnt(2)
    v_mfma_f32_32x32x16_bf16 v[236:251], a[216:219], v[184:187], v[236:251]
    v_mul_f32_dpp v234, v106, v90 row_newbcast:8 row_mask:0xf bank_mask:0xf
    v_mul_f32_dpp v235, v107, v91 row_newbcast:8 row_mask:0xf bank_mask:0xf
    v_cvt_pk_bf16_f32 v220, v228, v229
    v_cvt_pk_bf16_f32 v222, v232, v233
    buffer_load_dwordx4 a[52:55], v252, s[12:15], s92 offen sc1
    v_cvt_pk_bf16_f32 v221, v230, v231
    ds_read_b128 v[180:183], v118 offset:4096
    v_mfma_f32_32x32x16_bf16 v[236:251], a[220:223], v[188:191], v[236:251]
    v_cvt_pk_bf16_f32 v223, v234, v235
    v_permlane32_swap_b32 v220, v222
    s_nop 0
    v_permlane32_swap_b32 v221, v223
    buffer_store_dwordx4 v[220:223], v5, s[12:15], s11 offen sc1
    ds_read_b128 v[184:187], v118 offset:6144
    s_waitcnt lgkmcnt(2)
    v_mfma_f32_32x32x16_bf16 v[236:251], a[224:227], v[192:195], v[236:251]
    s_add_u32 s11, s11, 153600
    v_add_f32 v20, v84, v85
    v_mul_f32 v21, v84, v84
    v_add_f32 v22, v228, v229
    v_mul_f32 v23, v228, v228
    ds_read_b128 v[188:191], v118 offset:8192
    v_mfma_f32_32x32x16_bf16 v[236:251], a[228:231], v[196:199], v[236:251]
    v_mul_f32_dpp v24, v100, v228 row_newbcast:8 row_mask:0xf bank_mask:0xf
    v_mul_f32_dpp v25, v100, v228 row_newbcast:4 row_mask:0xf bank_mask:0xf
    v_fmac_f32 v21, v85, v85
    v_fmac_f32 v23, v229, v229
    v_fmac_f32_dpp v24, v101, v229 row_newbcast:8 row_mask:0xf bank_mask:0xf
    ds_read_b128 v[192:195], v118 offset:10240
    s_waitcnt lgkmcnt(2)
    v_mfma_f32_32x32x16_bf16 v[236:251], a[232:235], v[180:183], v[236:251]
    v_fmac_f32_dpp v25, v101, v229 row_newbcast:4 row_mask:0xf bank_mask:0xf
    v_add_f32 v20, v20, v86
    v_add_f32 v22, v22, v230
    v_fmac_f32 v21, v86, v86
    buffer_load_dwordx4 a[56:59], v253, s[12:15], s92 offen sc1
    s_add_u32 s92, s92, 90112
    v_fmac_f32 v23, v230, v230
    v_mfma_f32_32x32x16_bf16 v[236:251], a[236:239], v[184:187], v[236:251]
    ds_read_b128 v[196:199], v118 offset:12288
    v_fmac_f32_dpp v24, v102, v230 row_newbcast:8 row_mask:0xf bank_mask:0xf
    v_fmac_f32_dpp v25, v102, v230 row_newbcast:4 row_mask:0xf bank_mask:0xf
    v_add_f32 v20, v20, v87
    v_add_f32 v22, v22, v231
    v_fmac_f32 v21, v87, v87
    ds_read_b128 v[180:183], v118 offset:14336
    s_waitcnt lgkmcnt(2)
    v_mfma_f32_32x32x16_bf16 v[236:251], a[240:243], v[188:191], v[236:251]
    v_fmac_f32 v23, v231, v231
    v_fmac_f32_dpp v24, v103, v231 row_newbcast:8 row_mask:0xf bank_mask:0xf
    v_fmac_f32_dpp v25, v103, v231 row_newbcast:4 row_mask:0xf bank_mask:0xf
    v_add_f32 v20, v20, v88
    v_add_f32 v22, v22, v232
    buffer_load_dwordx4 a[60:63], v15, s[12:15], s92 offen sc1
    v_mfma_f32_32x32x16_bf16 v[236:251], a[244:247], v[192:195], v[236:251]
    v_fmac_f32 v21, v88, v88
    v_fmac_f32 v23, v232, v232
    v_fmac_f32_dpp v24, v104, v232 row_newbcast:8 row_mask:0xf bank_mask:0xf
    v_fmac_f32_dpp v25, v104, v232 row_newbcast:4 row_mask:0xf bank_mask:0xf
    v_add_f32 v20, v20, v89
    s_waitcnt lgkmcnt(0)
    v_mfma_f32_32x32x16_bf16 v[236:251], a[248:251], v[196:199], v[236:251]
    v_add_f32 v22, v22, v233
    v_fmac_f32 v21, v89, v89
    v_fmac_f32 v23, v233, v233
    v_fmac_f32_dpp v24, v105, v233 row_newbcast:8 row_mask:0xf bank_mask:0xf
    v_fmac_f32_dpp v25, v105, v233 row_newbcast:4 row_mask:0xf bank_mask:0xf
    v_add_f32 v20, v20, v90
    v_add_f32 v22, v22, v234
    v_fmac_f32 v21, v90, v90
    v_fmac_f32 v23, v234, v234
    buffer_load_dwordx4 a[64:67], v252, s[12:15], s92 offen sc1
    v_fmac_f32_dpp v24, v106, v234 row_newbcast:8 row_mask:0xf bank_mask:0xf
    v_fmac_f32_dpp v25, v106, v234 row_newbcast:4 row_mask:0xf bank_mask:0xf
    v_add_f32 v20, v20, v91
    v_add_f32 v22, v22, v235
    v_fmac_f32 v21, v91, v91
    v_fmac_f32 v23, v235, v235
    v_fmac_f32_dpp v24, v107, v235 row_newbcast:8 row_mask:0xf bank_mask:0xf
    v_fmac_f32_dpp v25, v107, v235 row_newbcast:4 row_mask:0xf bank_mask:0xf
    v_permlane32_swap_b32 v20, v21
    v_permlane32_swap_b32 v22, v23
    v_permlane32_swap_b32 v24, v25
    v_mfma_f32_32x32x16_bf16 v[236:251], a[252:255], v[180:183], v[236:251]
    v_add_f32 v20, v20, v21
    v_add_f32 v21, v22, v23
    v_add_f32 v22, v24, v25
    ds_write_b96 v112, v[20:22] offset:0
    s_nop 7
    ds_write_b128 v9, v[244:247] offset:8192
    buffer_load_dwordx4 a[68:71], v253, s[12:15], s92 offen sc1
    s_add_u32 s92, s92, 90112
    ds_write_b128 v9, v[248:251] offset:9216
    s_waitcnt vmcnt(4)
    s_mov_b64 exec, 1
    buffer_store_dword v2, v4, s[12:15], s17 offen sc1
    s_mov_b64 exec, -1
    s_add_u32 s17, s17, 128
    s_waitcnt lgkmcnt(0)
    s_barrier
    s_nop 0
    ds_read_b128 v[244:247], v10 offset:8192
    ds_read_b128 v[248:251], v10 offset:9216
    ds_read_b128 v[20:23], v113 offset:0
    ds_read_b128 v[24:27], v113 offset:1024
    ds_read_b128 v[28:31], v113 offset:2048
    ds_read_b128 v[32:35], v113 offset:3072
    s_getpc_b64 s[40:41]
L_pf3_s:
    v_min_u32 v19, pf_last3, v0
    global_load_dword v18, v19, s[40:41]
    s_waitcnt lgkmcnt(5)
    v_add_f32 v236, v236, v244
    v_mfma_f32_16x16x32_bf16 v[164:167], v[36:39], v[120:123], 0
    v_add_f32 v237, v237, v245
    v_add_f32 v238, v238, v246
    v_add_f32 v239, v239, v247
    s_waitcnt lgkmcnt(4)
    v_add_f32 v240, v240, v248
    v_add_f32 v241, v241, v249
    v_add_f32 v242, v242, v250
    v_add_f32 v243, v243, v251
    v_mfma_f32_16x16x32_bf16 v[168:171], v[40:43], v[120:123], 0
    v_fmac_f32_dpp v92, v100, v236 row_newbcast:0 row_mask:0xf bank_mask:0xf
    buffer_load_dwordx4 a[72:75], v15, s[12:15], s92 offen sc1
    v_fmac_f32_dpp v93, v101, v237 row_newbcast:0 row_mask:0xf bank_mask:0xf
    v_fmac_f32_dpp v94, v102, v238 row_newbcast:0 row_mask:0xf bank_mask:0xf
    v_fmac_f32_dpp v95, v103, v239 row_newbcast:0 row_mask:0xf bank_mask:0xf
    v_fmac_f32_dpp v96, v104, v240 row_newbcast:0 row_mask:0xf bank_mask:0xf
    v_fmac_f32_dpp v97, v105, v241 row_newbcast:0 row_mask:0xf bank_mask:0xf
    v_fmac_f32_dpp v98, v106, v242 row_newbcast:0 row_mask:0xf bank_mask:0xf
    v_mfma_f32_16x16x32_bf16 v[172:175], v[44:47], v[120:123], 0
    v_fmac_f32_dpp v99, v107, v243 row_newbcast:0 row_mask:0xf bank_mask:0xf
    v_mul_f32_dpp v244, v100, v92 row_newbcast:8 row_mask:0xf bank_mask:0xf
    v_mul_f32_dpp v245, v101, v93 row_newbcast:8 row_mask:0xf bank_mask:0xf
    v_mul_f32_dpp v246, v102, v94 row_newbcast:8 row_mask:0xf bank_mask:0xf
    v_mul_f32_dpp v247, v103, v95 row_newbcast:8 row_mask:0xf bank_mask:0xf
    buffer_load_dwordx4 a[76:79], v252, s[12:15], s92 offen sc1
    v_mul_f32_dpp v248, v104, v96 row_newbcast:8 row_mask:0xf bank_mask:0xf
    v_mul_f32_dpp v249, v105, v97 row_newbcast:8 row_mask:0xf bank_mask:0xf
    v_mfma_f32_16x16x32_bf16 v[164:167], v[48:51], v[124:127], v[164:167]
    v_mul_f32_dpp v250, v106, v98 row_newbcast:8 row_mask:0xf bank_mask:0xf
    v_mul_f32_dpp v251, v107, v99 row_newbcast:8 row_mask:0xf bank_mask:0xf
    v_cvt_pk_bf16_f32 v236, v244, v245
    v_cvt_pk_bf16_f32 v238, v248, v249
    v_cvt_pk_bf16_f32 v237, v246, v247
    v_cvt_pk_bf16_f32 v239, v250, v251
    v_permlane32_swap_b32 v236, v238
    v_mfma_f32_16x16x32_bf16 v[168:171], v[52:55], v[124:127], v[168:171]
    v_permlane32_swap_b32 v237, v239
    buffer_load_dwordx4 a[80:83], v253, s[12:15], s92 offen sc1
    s_add_u32 s92, s92, 90112
    buffer_store_dwordx4 v[236:239], v5, s[12:15], s11 offen sc1
    s_waitcnt lgkmcnt(2)
    v_add_f32 v20, v20, v24
    v_add_f32 v21, v21, v25
    v_add_f32 v22, v22, v26
    v_mfma_f32_16x16x32_bf16 v[172:175], v[56:59], v[124:127], v[172:175]
    s_waitcnt lgkmcnt(0)
    v_add_f32 v28, v28, v32
    v_add_f32 v29, v29, v33
    v_add_f32 v30, v30, v34
    v_add_f32 v20, v20, v28
    v_add_f32 v21, v21, v29
    v_add_f32 v22, v22, v30
    s_mov_b64 exec, s[20:21]
    buffer_store_dwordx4 v[20:23], v15, s[12:15], s18 offen sc1
    s_mov_b64 exec, -1
    v_mfma_f32_16x16x32_bf16 v[164:167], v[60:63], v[128:131], v[164:167]
    s_add_u32 s18, s18, 8192
    buffer_load_dword v14, v3, s[12:15], s22 offen sc1
    v_add_f32 v20, v92, v93
    v_mul_f32 v21, v92, v92
    v_add_f32 v22, v244, v245
    v_mul_f32 v23, v244, v244
    v_mul_f32_dpp v24, v100, v244 row_newbcast:8 row_mask:0xf bank_mask:0xf
    v_mfma_f32_16x16x32_bf16 v[168:171], v[64:67], v[128:131], v[168:171]
    v_mul_f32_dpp v25, v100, v244 row_newbcast:4 row_mask:0xf bank_mask:0xf
    v_fmac_f32 v21, v93, v93
    v_fmac_f32 v23, v245, v245
    v_fmac_f32_dpp v24, v101, v245 row_newbcast:8 row_mask:0xf bank_mask:0xf
    buffer_load_dwordx4 a[84:87], v15, s[12:15], s92 offen sc1
    v_fmac_f32_dpp v25, v101, v245 row_newbcast:4 row_mask:0xf bank_mask:0xf
    v_add_f32 v20, v20, v94
    v_add_f32 v22, v22, v246
    v_mfma_f32_16x16x32_bf16 v[172:175], v[68:71], v[128:131], v[172:175]
    v_fmac_f32 v21, v94, v94
    v_fmac_f32 v23, v246, v246
    v_fmac_f32_dpp v24, v102, v246 row_newbcast:8 row_mask:0xf bank_mask:0xf
    v_fmac_f32_dpp v25, v102, v246 row_newbcast:4 row_mask:0xf bank_mask:0xf
    v_add_f32 v20, v20, v95
    v_add_f32 v22, v22, v247
    v_fmac_f32 v21, v95, v95
    v_fmac_f32 v23, v247, v247
    v_mfma_f32_16x16x32_bf16 v[164:167], v[72:75], v[132:135], v[164:167]
    buffer_load_dwordx4 a[88:91], v252, s[12:15], s92 offen sc1
    v_fmac_f32_dpp v24, v103, v247 row_newbcast:8 row_mask:0xf bank_mask:0xf
    v_fmac_f32_dpp v25, v103, v247 row_newbcast:4 row_mask:0xf bank_mask:0xf
    v_add_f32 v20, v20, v96
    v_add_f32 v22, v22, v248
    v_fmac_f32 v21, v96, v96
    v_fmac_f32 v23, v248, v248
    v_fmac_f32_dpp v24, v104, v248 row_newbcast:8 row_mask:0xf bank_mask:0xf
    v_mfma_f32_16x16x32_bf16 v[168:171], v[76:79], v[132:135], v[168:171]
    v_fmac_f32_dpp v25, v104, v248 row_newbcast:4 row_mask:0xf bank_mask:0xf
    v_add_f32 v20, v20, v97
    v_add_f32 v22, v22, v249
    v_fmac_f32 v21, v97, v97
    buffer_load_dwordx4 a[92:95], v253, s[12:15], s92 offen sc1
    s_add_u32 s92, s92, 90112
    v_fmac_f32 v23, v249, v249
    v_fmac_f32_dpp v24, v105, v249 row_newbcast:8 row_mask:0xf bank_mask:0xf
    v_mfma_f32_16x16x32_bf16 v[172:175], v[80:83], v[132:135], v[172:175]
    v_fmac_f32_dpp v25, v105, v249 row_newbcast:4 row_mask:0xf bank_mask:0xf
    v_add_f32 v20, v20, v98
    v_add_f32 v22, v22, v250
    v_fmac_f32 v21, v98, v98
    v_fmac_f32 v23, v250, v250
    v_fmac_f32_dpp v24, v106, v250 row_newbcast:8 row_mask:0xf bank_mask:0xf
    buffer_load_dwordx4 a[96:99], v15, s[12:15], s92 offen sc1
    v_fmac_f32_dpp v25, v106, v250 row_newbcast:4 row_mask:0xf bank_mask:0xf
    v_mfma_f32_16x16x32_bf16 v[164:167], a[0:3], v[136:139], v[164:167]
    v_add_f32 v20, v20, v99
    v_add_f32 v22, v22, v251
    v_fmac_f32 v21, v99, v99
    v_fmac_f32 v23, v251, v251
    v_fmac_f32_dpp v24, v107, v251 row_newbcast:8 row_mask:0xf bank_mask:0xf
    v_fmac_f32_dpp v25, v107, v251 row_newbcast:4 row_mask:0xf bank_mask:0xf
    v_permlane32_swap_b32 v20, v21
    v_mfma_f32_16x16x32_bf16 v[168:171], a[4:7], v[136:139], v[168:171]
    v_permlane32_swap_b32 v22, v23
    buffer_load_dwordx4 a[100:103], v252, s[12:15], s92 offen sc1
    v_permlane32_swap_b32 v24, v25
    v_add_f32 v20, v20, v21
    v_add_f32 v21, v22, v23
    v_add_f32 v22, v24, v25
    v_mfma_f32_16x16x32_bf16 v[172:175], a[8:11], v[136:139], v[172:175]
    ds_write_b96 v112, v[20:22] offset:4096
    s_waitcnt vmcnt(5)
    v_cmp_ne_u32 vcc, s6, v14
    s_nop 0
    s_cbranch_vccnz retry_18_s
ready_19_s:
    buffer_load_dwordx4 a[104:107], v253, s[12:15], s92 offen sc1
    s_add_u32 s92, s92, 90112
    s_add_u32 s22, s22, 128
    s_mov_b64 exec, 1
    buffer_store_dword v2, v4, s[12:15], s17 offen sc1
    s_mov_b64 exec, -1
    s_add_u32 s17, s17, 128
    v_mfma_f32_16x16x32_bf16 v[164:167], a[12:15], v[140:143], v[164:167]
    s_lshl_b32 s39, s3, 12
    s_add_u32 s38, s10, s39
    s_add_u32 s38, s38, 0x25000
    s_add_u32 m0, s39, 0
    s_nop 0
    buffer_load_dwordx4 v15, s[12:15], s38 offen offset:0 sc1 lds
    v_mfma_f32_16x16x32_bf16 v[168:171], a[16:19], v[140:143], v[168:171]
    buffer_load_dwordx4 v15, s[12:15], s38 offen offset:1024 sc1 lds
    buffer_load_dwordx4 v15, s[12:15], s38 offen offset:2048 sc1 lds
    buffer_load_dwordx4 v15, s[12:15], s38 offen offset:3072 sc1 lds
    s_add_u32 s38, s38, 16384
    s_add_u32 m0, s39, 16384
    s_nop 0
    buffer_load_dwordx4 v15, s[12:15], s38 offen offset:0 sc1 lds
    buffer_load_dwordx4 v15, s[12:15], s38 offen offset:1024 sc1 lds
    buffer_load_dwordx4 v15, s[12:15], s38 offen offset:2048 sc1 lds
    v_mfma_f32_16x16x32_bf16 v[172:175], a[20:23], v[140:143], v[172:175]
    buffer_load_dwordx4 v15, s[12:15], s38 offen offset:3072 sc1 lds
    s_add_u32 s38, s38, 16384
    v_mov_b32_dpp v24, v108 row_newbcast:3 row_mask:0xf bank_mask:0xf
    v_mov_b32_dpp v25, v109 row_newbcast:3 row_mask:0xf bank_mask:0xf
    v_mov_b32_dpp v26, v110 row_newbcast:3 row_mask:0xf bank_mask:0xf
    v_mov_b32_dpp v27, v111 row_newbcast:3 row_mask:0xf bank_mask:0xf
    v_mov_b32 v28, v24
    v_mov_b32 v29, v25
    v_mfma_f32_16x16x32_bf16 v[164:167], a[24:27], v[144:147], v[164:167]
    v_mov_b32 v30, v26
    v_mov_b32 v31, v27
    v_permlane16_swap_b32 v24, v28
    v_permlane16_swap_b32 v25, v29
    v_permlane16_swap_b32 v26, v30
    v_mfma_f32_16x16x32_bf16 v[168:171], a[28:31], v[144:147], v[168:171]
    v_permlane16_swap_b32 v27, v31
    s_nop 0
    v_fmac_f32_dpp v84, v100, v24 row_newbcast:12 row_mask:0xf bank_mask:0xf
    v_fmac_f32_dpp v85, v101, v25 row_newbcast:12 row_mask:0xf bank_mask:0xf
    v_fmac_f32_dpp v86, v102, v26 row_newbcast:12 row_mask:0xf bank_mask:0xf
    v_fmac_f32_dpp v87, v103, v27 row_newbcast:12 row_mask:0xf bank_mask:0xf
    v_fmac_f32_dpp v88, v104, v28 row_newbcast:12 row_mask:0xf bank_mask:0xf
    v_fmac_f32_dpp v89, v105, v29 row_newbcast:12 row_mask:0xf bank_mask:0xf
    v_mfma_f32_16x16x32_bf16 v[172:175], a[32:35], v[144:147], v[172:175]
    v_fmac_f32_dpp v90, v106, v30 row_newbcast:12 row_mask:0xf bank_mask:0xf
    v_fmac_f32_dpp v91, v107, v31 row_newbcast:12 row_mask:0xf bank_mask:0xf
    v_fmac_f32_dpp v92, v100, v24 row_newbcast:12 row_mask:0xf bank_mask:0xf
    v_fmac_f32_dpp v93, v101, v25 row_newbcast:12 row_mask:0xf bank_mask:0xf
    v_fmac_f32_dpp v94, v102, v26 row_newbcast:12 row_mask:0xf bank_mask:0xf
    v_fmac_f32_dpp v95, v103, v27 row_newbcast:12 row_mask:0xf bank_mask:0xf
    v_fmac_f32_dpp v96, v104, v28 row_newbcast:12 row_mask:0xf bank_mask:0xf
    v_fmac_f32_dpp v97, v105, v29 row_newbcast:12 row_mask:0xf bank_mask:0xf
    v_mfma_f32_16x16x32_bf16 v[164:167], a[36:39], v[148:151], v[164:167]
    v_fmac_f32_dpp v98, v106, v30 row_newbcast:12 row_mask:0xf bank_mask:0xf
    v_fmac_f32_dpp v99, v107, v31 row_newbcast:12 row_mask:0xf bank_mask:0xf
    v_add_u32 v9, 106496, v9
    v_add_u32 v10, 106496, v10
    v_mul_f32 v176, 0x3b000000, v176
    v_mul_f32 v177, 0x3b000000, v177
    s_nop 0
    v_readlane_b32 s84, v177, 2
    v_readlane_b32 s85, v177, 1
    v_mfma_f32_16x16x32_bf16 v[168:171], a[40:43], v[148:151], v[168:171]
    v_readlane_b32 s86, v176, 1
    v_readlane_b32 s87, v176, 2
    v_readlane_b32 s88, v176, 0
    s_mov_b32 s42, 0xbdd2d3e8
    s_mov_b32 s43, 0xc0135761
    s_waitcnt vmcnt(4)
    s_waitcnt lgkmcnt(0)
    s_barrier
    v_mfma_f32_16x16x32_bf16 v[172:175], a[44:47], v[148:151], v[172:175]
    buffer_load_dwordx4 a[108:111], v15, s[12:15], s92 offen sc1
    ds_read_b128 v[20:23], v113 offset:4096
    ds_read_b128 v[24:27], v113 offset:5120
    ds_read_b128 v[180:183], v15 offset:0
    ds_read_b128 v[184:187], v15 offset:1024
    ds_read_b128 v[188:191], v15 offset:2048
    ds_read_b128 v[192:195], v15 offset:3072
    s_waitcnt lgkmcnt(2)
    v_mfma_f32_16x16x32_bf16 v[220:223], v[36:39], v[180:183], 0
    ds_read_b128 v[196:199], v15 offset:4096
    ds_read_b128 v[200:203], v15 offset:5120
    v_mfma_f32_16x16x32_bf16 v[224:227], v[36:39], v[184:187], 0
    buffer_load_dwordx4 a[112:115], v252, s[12:15], s92 offen sc1
    ds_read_b128 v[28:31], v113 offset:6144
    v_mfma_f32_16x16x32_bf16 v[228:231], v[40:43], v[180:183], 0
    ds_read_b128 v[32:35], v113 offset:7168
    buffer_load_dword v14, v3, s[12:15], s22 offen sc1
    v_mfma_f32_16x16x32_bf16 v[232:235], v[40:43], v[184:187], 0
    v_add_f32 v20, v20, v24
    v_mfma_f32_16x16x32_bf16 v[236:239], v[44:47], v[180:183], 0
    v_mfma_f32_16x16x32_bf16 v[240:243], v[44:47], v[184:187], 0
    s_waitcnt lgkmcnt(4)
    v_mfma_f32_16x16x32_bf16 v[220:223], v[48:51], v[188:191], v[220:223]
    v_add_f32 v21, v21, v25
    ds_read_b128 v[180:183], v15 offset:6144
    v_mfma_f32_16x16x32_bf16 v[224:227], v[48:51], v[192:195], v[224:227]
    v_add_f32 v22, v22, v26
    ds_read_b128 v[184:187], v15 offset:7168
    v_mfma_f32_16x16x32_bf16 v[228:231], v[52:55], v[188:191], v[228:231]
    buffer_load_dwordx4 a[116:119], v253, s[12:15], s92 offen sc1
    s_add_u32 s92, s92, 90112
    v_mfma_f32_16x16x32_bf16 v[232:235], v[52:55], v[192:195], v[232:235]
    s_waitcnt lgkmcnt(2)
    v_add_f32 v28, v28, v32
    v_add_f32 v29, v29, v33
    v_mfma_f32_16x16x32_bf16 v[236:239], v[56:59], v[188:191], v[236:239]
    v_add_f32 v30, v30, v34
    v_add_f32 v20, v20, v28
    v_mfma_f32_16x16x32_bf16 v[240:243], v[56:59], v[192:195], v[240:243]
    v_add_f32 v21, v21, v29
    v_add_f32 v22, v22, v30
    v_mfma_f32_16x16x32_bf16 v[220:223], v[60:63], v[196:199], v[220:223]
    s_mov_b64 exec, s[20:21]
    buffer_store_dwordx4 v[20:23], v15, s[12:15], s18 offen sc1
    s_mov_b64 exec, -1
    v_mfma_f32_16x16x32_bf16 v[224:227], v[60:63], v[200:203], v[224:227]
    ds_read_b128 v[188:191], v15 offset:8192
    v_mfma_f32_16x16x32_bf16 v[228:231], v[64:67], v[196:199], v[228:231]
    ds_read_b128 v[192:195], v15 offset:9216
    buffer_load_dwordx4 a[120:123], v15, s[12:15], s92 offen sc1
    v_mfma_f32_16x16x32_bf16 v[232:235], v[64:67], v[200:203], v[232:235]
    v_mov_b32_dpp v120, v108 row_newbcast:0 row_mask:0xf bank_mask:0xf
    v_mfma_f32_16x16x32_bf16 v[236:239], v[68:71], v[196:199], v[236:239]
    v_mfma_f32_16x16x32_bf16 v[240:243], v[68:71], v[200:203], v[240:243]
    s_waitcnt lgkmcnt(2)
    v_mfma_f32_16x16x32_bf16 v[220:223], v[72:75], v[180:183], v[220:223]
    v_mov_b32_dpp v121, v109 row_newbcast:0 row_mask:0xf bank_mask:0xf
    ds_read_b128 v[196:199], v15 offset:10240
    v_mfma_f32_16x16x32_bf16 v[224:227], v[72:75], v[184:187], v[224:227]
    v_mov_b32_dpp v122, v110 row_newbcast:0 row_mask:0xf bank_mask:0xf
    ds_read_b128 v[200:203], v15 offset:11264
    v_mfma_f32_16x16x32_bf16 v[228:231], v[76:79], v[180:183], v[228:231]
    buffer_load_dwordx4 a[124:127], v252, s[12:15], s92 offen sc1
    v_mov_b32_dpp v123, v111 row_newbcast:0 row_mask:0xf bank_mask:0xf
    v_mfma_f32_16x16x32_bf16 v[232:235], v[76:79], v[184:187], v[232:235]
    v_mov_b32_dpp v124, v108 row_newbcast:1 row_mask:0xf bank_mask:0xf
    v_mov_b32_dpp v125, v109 row_newbcast:1 row_mask:0xf bank_mask:0xf
    v_mfma_f32_16x16x32_bf16 v[236:239], v[80:83], v[180:183], v[236:239]
    v_mov_b32_dpp v126, v110 row_newbcast:1 row_mask:0xf bank_mask:0xf
    v_mfma_f32_16x16x32_bf16 v[240:243], v[80:83], v[184:187], v[240:243]
    s_waitcnt lgkmcnt(2)
    v_mfma_f32_16x16x32_bf16 v[220:223], a[0:3], v[188:191], v[220:223]
    buffer_load_dwordx4 a[128:131], v253, s[12:15], s92 offen sc1
    s_add_u32 s92, s92, 90112
    v_mfma_f32_16x16x32_bf16 v[224:227], a[0:3], v[192:195], v[224:227]
    v_mov_b32_dpp v127, v111 row_newbcast:1 row_mask:0xf bank_mask:0xf
    ds_read_b128 v[180:183], v15 offset:12288
    v_mfma_f32_16x16x32_bf16 v[228:231], a[4:7], v[188:191], v[228:231]
    v_mov_b32_dpp v128, v108 row_newbcast:2 row_mask:0xf bank_mask:0xf
    ds_read_b128 v[184:187], v15 offset:13312
    v_mfma_f32_16x16x32_bf16 v[232:235], a[4:7], v[192:195], v[232:235]
    v_mov_b32_dpp v129, v109 row_newbcast:2 row_mask:0xf bank_mask:0xf
    v_mov_b32_dpp v130, v110 row_newbcast:2 row_mask:0xf bank_mask:0xf
    v_mfma_f32_16x16x32_bf16 v[236:239], a[8:11], v[188:191], v[236:239]
    buffer_load_dwordx4 a[132:135], v15, s[12:15], s92 offen sc1
    v_mov_b32_dpp v131, v111 row_newbcast:2 row_mask:0xf bank_mask:0xf
    v_mfma_f32_16x16x32_bf16 v[240:243], a[8:11], v[192:195], v[240:243]
    s_waitcnt lgkmcnt(2)
    v_mfma_f32_16x16x32_bf16 v[220:223], a[12:15], v[196:199], v[220:223]
    ds_read_b128 v[188:191], v15 offset:14336
    ds_read_b128 v[192:195], v15 offset:15360
    v_mfma_f32_16x16x32_bf16 v[224:227], a[12:15], v[200:203], v[224:227]
    buffer_load_dwordx4 a[136:139], v252, s[12:15], s92 offen sc1
    v_mfma_f32_16x16x32_bf16 v[228:231], a[16:19], v[196:199], v[228:231]
    v_mfma_f32_16x16x32_bf16 v[232:235], a[16:19], v[200:203], v[232:235]
    v_mfma_f32_16x16x32_bf16 v[236:239], a[20:23], v[196:199], v[236:239]
    v_mfma_f32_16x16x32_bf16 v[240:243], a[20:23], v[200:203], v[240:243]
    s_waitcnt lgkmcnt(2)
    v_mfma_f32_16x16x32_bf16 v[220:223], a[24:27], v[180:183], v[220:223]
    buffer_load_dwordx4 a[140:143], v253, s[12:15], s92 offen sc1
    s_add_u32 s92, s92, 90112
    v_mfma_f32_16x16x32_bf16 v[224:227], a[24:27], v[184:187], v[224:227]
    s_waitcnt vmcnt(11)
    s_barrier
    v_mfma_f32_16x16x32_bf16 v[228:231], a[28:31], v[180:183], v[228:231]
    s_waitcnt vmcnt(6)
    s_mov_b64 exec, 1
    buffer_store_dword v2, v4, s[12:15], s17 offen sc1
    s_mov_b64 exec, -1
    s_add_u32 s17, s17, 128
    v_mfma_f32_16x16x32_bf16 v[232:235], a[28:31], v[184:187], v[232:235]
    v_mfma_f32_16x16x32_bf16 v[236:239], a[32:35], v[180:183], v[236:239]
    ds_read_b128 v[152:155], v114 offset:512
    v_mfma_f32_16x16x32_bf16 v[240:243], a[32:35], v[184:187], v[240:243]
    ds_read_b128 v[196:199], v15 offset:16384
    ds_read_b128 v[200:203], v15 offset:17408
    s_waitcnt lgkmcnt(3)
    v_mfma_f32_16x16x32_bf16 v[220:223], a[36:39], v[188:191], v[220:223]
    ds_read_b128 v[244:247], v114 offset:576
    v_cmp_ne_u32 vcc, s6, v14
    s_nop 0
    s_cbranch_vccnz retry_20_s
ready_21_s:
    v_mfma_f32_16x16x32_bf16 v[224:227], a[36:39], v[192:195], v[224:227]
    buffer_load_dwordx4 a[144:147], v115, s[12:15], s95 offen sc1
    s_add_u32 s95, s95, 32768
    v_mfma_f32_16x16x32_bf16 v[228:231], a[40:43], v[188:191], v[228:231]
    ds_read_b128 v[180:183], v15 offset:18432
    ds_read_b128 v[184:187], v15 offset:19456
    v_mfma_f32_16x16x32_bf16 v[232:235], a[40:43], v[192:195], v[232:235]
    s_add_u32 s22, s22, 128
    s_lshl_b32 s39, s3, 11
    s_add_u32 s38, s10, s39
    s_add_u32 s38, s38, 0x1000
    s_add_u32 m0, s39, 81920
    s_nop 0
    buffer_load_dwordx4 v15, s[12:15], s38 offen offset:0 sc1 lds
    v_mfma_f32_16x16x32_bf16 v[236:239], a[44:47], v[188:191], v[236:239]
    v_mfma_f32_16x16x32_bf16 v[240:243], a[44:47], v[192:195], v[240:243]
    s_waitcnt lgkmcnt(3)
    v_mfma_f32_16x16x32_bf16 v[220:223], a[48:51], v[196:199], v[220:223]
    buffer_load_dwordx4 v15, s[12:15], s38 offen offset:1024 sc1 lds
    ds_read_b128 v[248:251], v114 offset:640
    v_mfma_f32_16x16x32_bf16 v[224:227], a[48:51], v[200:203], v[224:227]
    ds_read_b128 v[188:191], v15 offset:20480
    ds_read_b128 v[192:195], v15 offset:21504
    v_mfma_f32_16x16x32_bf16 v[164:167], a[48:51], v[152:155], v[164:167]
    buffer_load_dwordx4 a[148:151], v115, s[12:15], s95 offen sc1
    s_add_u32 s95, s95, 32768
    v_mfma_f32_16x16x32_bf16 v[228:231], a[52:55], v[196:199], v[228:231]
    v_mfma_f32_16x16x32_bf16 v[232:235], a[52:55], v[200:203], v[232:235]
    v_mfma_f32_16x16x32_bf16 v[168:171], a[52:55], v[152:155], v[168:171]
    v_mfma_f32_16x16x32_bf16 v[236:239], a[56:59], v[196:199], v[236:239]
    v_mfma_f32_16x16x32_bf16 v[240:243], a[56:59], v[200:203], v[240:243]
    v_mfma_f32_16x16x32_bf16 v[172:175], a[56:59], v[152:155], v[172:175]
    s_waitcnt lgkmcnt(3)
    v_mfma_f32_16x16x32_bf16 v[220:223], a[60:63], v[180:183], v[220:223]
    ds_read_b128 v[152:155], v114 offset:704
    buffer_load_dwordx4 a[152:155], v115, s[12:15], s95 offen sc1
    s_add_u32 s95, s95, 32768
    v_mfma_f32_16x16x32_bf16 v[224:227], a[60:63], v[184:187], v[224:227]
    ds_read_b128 v[196:199], v15 offset:22528
    v_mfma_f32_16x16x32_bf16 v[164:167], a[60:63], v[244:247], v[164:167]
    ds_read_b128 v[200:203], v15 offset:23552
    buffer_load_dwordx4 a[156:159], v115, s[12:15], s95 offen sc1
    s_add_u32 s95, s95, 32768
    v_mfma_f32_16x16x32_bf16 v[228:231], a[64:67], v[180:183], v[228:231]
    v_mfma_f32_16x16x32_bf16 v[232:235], a[64:67], v[184:187], v[232:235]
    v_mfma_f32_16x16x32_bf16 v[168:171], a[64:67], v[244:247], v[168:171]
    v_mfma_f32_16x16x32_bf16 v[236:239], a[68:71], v[180:183], v[236:239]
    v_mfma_f32_16x16x32_bf16 v[240:243], a[68:71], v[184:187], v[240:243]
    v_mfma_f32_16x16x32_bf16 v[172:175], a[68:71], v[244:247], v[172:175]
    s_waitcnt lgkmcnt(3)
    v_mfma_f32_16x16x32_bf16 v[220:223], a[72:75], v[188:191], v[220:223]
    ds_read_b128 v[244:247], v114 offset:768
    ds_read_b128 v[180:183], v15 offset:24576
    v_mfma_f32_16x16x32_bf16 v[224:227], a[72:75], v[192:195], v[224:227]
    buffer_load_dwordx4 a[160:163], v115, s[12:15], s95 offen sc1
    s_add_u32 s95, s95, 32768
    v_mfma_f32_16x16x32_bf16 v[164:167], a[72:75], v[248:251], v[164:167]
    ds_read_b128 v[184:187], v15 offset:25600
    s_waitcnt vmcnt(4)
    s_barrier
    v_mfma_f32_16x16x32_bf16 v[228:231], a[76:79], v[188:191], v[228:231]
    v_mfma_f32_16x16x32_bf16 v[232:235], a[76:79], v[192:195], v[232:235]
    buffer_load_dwordx4 a[164:167], v115, s[12:15], s95 offen sc1
    s_add_u32 s95, s95, 32768
    v_mfma_f32_16x16x32_bf16 v[168:171], a[76:79], v[248:251], v[168:171]
    ds_read_b128 v[20:23], v16 offset:16384
    ds_read_b128 v[24:27], v16 offset:17408
    v_mfma_f32_16x16x32_bf16 v[236:239], a[80:83], v[188:191], v[236:239]
    ds_read_b128 v[28:31], v16 offset:18432
    ds_read_b128 v[32:35], v16 offset:19456
    v_mfma_f32_16x16x32_bf16 v[240:243], a[80:83], v[192:195], v[240:243]
    buffer_load_dwordx4 a[168:171], v115, s[12:15], s95 offen sc1
    s_add_u32 s95, s95, 32768
    v_mfma_f32_16x16x32_bf16 v[172:175], a[80:83], v[248:251], v[172:175]
    ds_read_b128 v[204:207], v16 offset:20480
    ds_read_b128 v[208:211], v16 offset:21504
    s_waitcnt lgkmcnt(9)
    v_mfma_f32_16x16x32_bf16 v[220:223], a[84:87], v[196:199], v[220:223]
    ds_read_b128 v[212:215], v16 offset:22528
    ds_read_b128 v[248:251], v114 offset:832
    v_mfma_f32_16x16x32_bf16 v[224:227], a[84:87], v[200:203], v[224:227]
    ds_read_b128 v[216:219], v16 offset:23552
    ds_read_b128 v[188:191], v15 offset:26624
    v_mfma_f32_16x16x32_bf16 v[164:167], a[84:87], v[152:155], v[164:167]
    buffer_load_dword v14, v3, s[12:15], s22 offen sc1
    ds_read_b128 v[192:195], v15 offset:27648
    v_mfma_f32_16x16x32_bf16 v[228:231], a[88:91], v[196:199], v[228:231]
    buffer_load_dwordx4 a[172:175], v115, s[12:15], s95 offen sc1
    s_add_u32 s95, s95, 32768
    v_mfma_f32_16x16x32_bf16 v[232:235], a[88:91], v[200:203], v[232:235]
    s_waitcnt lgkmcnt(6)
    v_add_f32 v20, v20, v204
    v_add_f32 v21, v21, v205
    v_mfma_f32_16x16x32_bf16 v[168:171], a[88:91], v[152:155], v[168:171]
    v_add_f32 v22, v22, v206
    v_mfma_f32_16x16x32_bf16 v[236:239], a[92:95], v[196:199], v[236:239]
    v_mfma_f32_16x16x32_bf16 v[240:243], a[92:95], v[200:203], v[240:243]
    v_mfma_f32_16x16x32_bf16 v[172:175], a[92:95], v[152:155], v[172:175]
    v_mfma_f32_16x16x32_bf16 v[220:223], a[96:99], v[180:183], v[220:223]
    s_waitcnt lgkmcnt(5)
    v_add_f32 v24, v24, v208
    ds_read_b128 v[152:155], v114 offset:896
    v_mfma_f32_16x16x32_bf16 v[224:227], a[96:99], v[184:187], v[224:227]
    v_add_f32 v25, v25, v209
    v_add_f32 v26, v26, v210
    ds_read_b128 v[196:199], v15 offset:28672
    v_mfma_f32_16x16x32_bf16 v[164:167], a[96:99], v[244:247], v[164:167]
    s_waitcnt lgkmcnt(6)
    v_add_f32 v28, v28, v212
    buffer_load_dwordx4 a[176:179], v115, s[12:15], s95 offen sc1
    s_add_u32 s95, s95, 32768
    v_mfma_f32_16x16x32_bf16 v[228:231], a[100:103], v[180:183], v[228:231]
    ds_read_b128 v[200:203], v15 offset:29696
    v_add_f32 v29, v29, v213
    v_mfma_f32_16x16x32_bf16 v[232:235], a[100:103], v[184:187], v[232:235]
    v_add_f32 v30, v30, v214
    s_waitcnt lgkmcnt(5)
    v_add_f32 v32, v32, v216
    v_mfma_f32_16x16x32_bf16 v[168:171], a[100:103], v[244:247], v[168:171]
    v_add_f32 v33, v33, v217
    v_add_f32 v34, v34, v218
    v_add_f32 v20, v20, v28
    v_mfma_f32_16x16x32_bf16 v[236:239], a[104:107], v[180:183], v[236:239]
    v_add_f32 v21, v21, v29
    buffer_load_dwordx4 a[180:183], v115, s[12:15], s95 offen sc1
    s_add_u32 s95, s95, 32768
    v_mfma_f32_16x16x32_bf16 v[240:243], a[104:107], v[184:187], v[240:243]
    v_add_f32 v22, v22, v30
    v_add_f32 v24, v24, v32
    v_mfma_f32_16x16x32_bf16 v[172:175], a[104:107], v[244:247], v[172:175]
    v_add_f32 v25, v25, v33
    v_add_f32 v26, v26, v34
    s_waitcnt lgkmcnt(3)
    v_mfma_f32_16x16x32_bf16 v[220:223], a[108:111], v[188:191], v[220:223]
    v_add_f32 v20, v20, v24
    ds_read_b128 v[244:247], v114 offset:960
    v_mfma_f32_16x16x32_bf16 v[224:227], a[108:111], v[192:195], v[224:227]
    v_add_f32 v21, v21, v25
    ds_read_b128 v[180:183], v15 offset:30720
    buffer_load_dwordx4 a[184:187], v115, s[12:15], s95 offen sc1
    s_add_u32 s95, s95, 32768
    v_mfma_f32_16x16x32_bf16 v[164:167], a[108:111], v[248:251], v[164:167]
    v_add_f32 v22, v22, v26
    v_mfma_f32_16x16x32_bf16 v[228:231], a[112:115], v[188:191], v[228:231]
    ds_read_b128 v[184:187], v15 offset:31744
    v_mul_f32 v20, 0x3b000000, v20
    v_mul_f32 v21, 0x3b000000, v21
    v_mfma_f32_16x16x32_bf16 v[232:235], a[112:115], v[192:195], v[232:235]
    v_mul_f32 v22, 0x3b000000, v22
    v_mov_b32 v24, v20
    v_mfma_f32_16x16x32_bf16 v[168:171], a[112:115], v[248:251], v[168:171]
    v_mov_b32 v25, v21
    v_mov_b32 v26, v22
    buffer_load_dwordx4 a[188:191], v115, s[12:15], s95 offen sc1
    s_add_u32 s95, s95, 32768
    v_mfma_f32_16x16x32_bf16 v[236:239], a[116:119], v[188:191], v[236:239]
    v_permlane32_swap_b32 v20, v24
    v_mfma_f32_16x16x32_bf16 v[240:243], a[116:119], v[192:195], v[240:243]
    v_permlane32_swap_b32 v21, v25
    v_mfma_f32_16x16x32_bf16 v[172:175], a[116:119], v[248:251], v[172:175]
    v_permlane32_swap_b32 v22, v26
    s_waitcnt lgkmcnt(3)
    v_mfma_f32_16x16x32_bf16 v[220:223], a[120:123], v[196:199], v[220:223]
    v_fma_f32 v24, -v20, v20, v24
    v_max_f32 v24, 0, v24
    v_mfma_f32_16x16x32_bf16 v[224:227], a[120:123], v[200:203], v[224:227]
    buffer_load_dwordx4 a[192:195], v115, s[12:15], s95 offen sc1
    s_add_u32 s95, s95, 32768
    v_mfma_f32_16x16x32_bf16 v[164:167], a[120:123], v[152:155], v[164:167]
    v_add_f32 v24, 0x3727c5ac, v24
    v_rsq_f32 v28, v24
    v_mfma_f32_16x16x32_bf16 v[228:231], a[124:127], v[196:199], v[228:231]
    v_fma_f32 v21, -v20, s84, v21
    v_mul_f32 v31, s85, v20
    v_mfma_f32_16x16x32_bf16 v[232:235], a[124:127], v[200:203], v[232:235]
    v_fma_f32 v29, v28, v21, s87
    v_fma_f32 v31, v22, -2.0, v31
    v_mfma_f32_16x16x32_bf16 v[168:171], a[124:127], v[152:155], v[168:171]
    v_fma_f32 v25, v20, v31, v25
    v_fma_f32 v26, -v20, s86, v26
    v_mfma_f32_16x16x32_bf16 v[236:239], a[128:131], v[196:199], v[236:239]
    buffer_load_dwordx4 a[196:199], v115, s[12:15], s95 offen sc1
    s_add_u32 s95, s95, 32768
    v_mfma_f32_16x16x32_bf16 v[240:243], a[128:131], v[200:203], v[240:243]
    v_add_f32 v26, v26, v26
    v_fma_f32 v30, v28, v25, v26
    v_mfma_f32_16x16x32_bf16 v[172:175], a[128:131], v[152:155], v[172:175]
    v_fma_f32 v30, v28, v30, s88
    v_fma_f32 v30, -v29, v29, v30
    v_max_f32 v30, 0, v30
    v_add_f32 v30, 0x3727c5ac, v30
    s_waitcnt lgkmcnt(0)
    v_mfma_f32_16x16x32_bf16 v[220:223], a[132:135], v[180:183], v[220:223]
    v_rsq_f32 v158, v30
    buffer_load_dwordx4 a[200:203], v115, s[12:15], s95 offen sc1
    s_add_u32 s95, s95, 32768
    v_mul_f32 v156, v28, v158
    v_mul_f32 v162, -v29, v158
    v_mul_f32 v160, -v20, v156
    v_mov_b32 v157, v156
    v_mfma_f32_16x16x32_bf16 v[224:227], a[132:135], v[184:187], v[224:227]
    v_mov_b32 v159, v158
    v_mov_b32 v161, v160
    v_mov_b32 v163, v162
    v_permlane16_swap_b32 v156, v157
    buffer_load_dwordx4 a[204:207], v115, s[12:15], s95 offen sc1
    s_add_u32 s95, s95, 32768
    s_waitcnt vmcnt(9)
    v_cmp_ne_u32 vcc, s6, v14
    s_nop 0
    s_cbranch_vccnz retry_22_s
ready_23_s:
    v_mfma_f32_16x16x32_bf16 v[164:167], a[132:135], v[244:247], v[164:167]
    v_permlane16_swap_b32 v158, v159
    s_add_u32 s22, s22, 128
    s_lshl_b32 s39, s3, 11
    s_add_u32 s38, s10, s39
    s_add_u32 s38, s38, 0x3000
    s_add_u32 m0, s39, 139264
    s_nop 0
    buffer_load_dwordx4 v15, s[12:15], s38 offen offset:0 sc1 lds
    v_permlane16_swap_b32 v160, v161
    v_mfma_f32_16x16x32_bf16 v[228:231], a[136:139], v[180:183], v[228:231]
    buffer_load_dwordx4 v15, s[12:15], s38 offen offset:1024 sc1 lds
    s_lshl_b32 s39, s3, 12
    s_add_u32 s38, s10, s39
    s_add_u32 s38, s38, 0x4a800
    s_add_u32 m0, s39, 32768
    s_nop 0
    buffer_load_dwordx4 v15, s[12:15], s38 offen offset:0 sc1 lds
    v_permlane16_swap_b32 v162, v163
    v_mfma_f32_16x16x32_bf16 v[232:235], a[136:139], v[184:187], v[232:235]
    v_mov_b32_dpp v132, v164 row_newbcast:0 row_mask:0xf bank_mask:0xf
    v_mov_b32_dpp v133, v165 row_newbcast:0 row_mask:0xf bank_mask:0xf
    v_mov_b32_dpp v134, v166 row_newbcast:0 row_mask:0xf bank_mask:0xf
    v_mov_b32_dpp v135, v167 row_newbcast:0 row_mask:0xf bank_mask:0xf
    v_mfma_f32_16x16x32_bf16 v[168:171], a[136:139], v[244:247], v[168:171]
    s_nop 7
    v_mov_b32_dpp v136, v168 row_newbcast:0 row_mask:0xf bank_mask:0xf
    v_mov_b32_dpp v137, v169 row_newbcast:0 row_mask:0xf bank_mask:0xf
    v_mov_b32_dpp v138, v170 row_newbcast:0 row_mask:0xf bank_mask:0xf
    v_mov_b32_dpp v139, v171 row_newbcast:0 row_mask:0xf bank_mask:0xf
    v_mfma_f32_16x16x32_bf16 v[236:239], a[140:143], v[180:183], v[236:239]
    v_mfma_f32_16x16x32_bf16 v[240:243], a[140:143], v[184:187], v[240:243]
    v_mfma_f32_16x16x32_bf16 v[172:175], a[140:143], v[244:247], v[172:175]
    s_nop 7
    s_nop 0
    v_mov_b32_dpp v140, v172 row_newbcast:0 row_mask:0xf bank_mask:0xf
    v_mov_b32_dpp v141, v173 row_newbcast:0 row_mask:0xf bank_mask:0xf
    v_mov_b32_dpp v142, v174 row_newbcast:0 row_mask:0xf bank_mask:0xf
    v_mov_b32_dpp v143, v175 row_newbcast:0 row_mask:0xf bank_mask:0xf
    v_mov_b32_dpp v144, v164 row_newbcast:1 row_mask:0xf bank_mask:0xf
    v_mov_b32_dpp v145, v165 row_newbcast:1 row_mask:0xf bank_mask:0xf
    v_mov_b32_dpp v146, v166 row_newbcast:1 row_mask:0xf bank_mask:0xf
    v_mov_b32_dpp v147, v167 row_newbcast:1 row_mask:0xf bank_mask:0xf
    buffer_load_dwordx4 a[208:211], v115, s[12:15], s95 offen sc1
    s_add_u32 s95, s95, 32768
    v_mov_b32_dpp v148, v168 row_newbcast:1 row_mask:0xf bank_mask:0xf
    v_mov_b32_dpp v149, v169 row_newbcast:1 row_mask:0xf bank_mask:0xf
    v_mov_b32_dpp v150, v170 row_newbcast:1 row_mask:0xf bank_mask:0xf
    v_mov_b32_dpp v151, v171 row_newbcast:1 row_mask:0xf bank_mask:0xf
    v_mov_b32_dpp v152, v172 row_newbcast:1 row_mask:0xf bank_mask:0xf
    v_mov_b32_dpp v153, v173 row_newbcast:1 row_mask:0xf bank_mask:0xf
    v_mov_b32_dpp v154, v174 row_newbcast:1 row_mask:0xf bank_mask:0xf
    v_mov_b32_dpp v155, v175 row_newbcast:1 row_mask:0xf bank_mask:0xf
    v_mov_b32_dpp v164, v164 row_newbcast:2 row_mask:0xf bank_mask:0xf
    v_mov_b32_dpp v165, v165 row_newbcast:2 row_mask:0xf bank_mask:0xf
    v_mov_b32_dpp v166, v166 row_newbcast:2 row_mask:0xf bank_mask:0xf
    v_mov_b32_dpp v167, v167 row_newbcast:2 row_mask:0xf bank_mask:0xf
    v_mov_b32_dpp v168, v168 row_newbcast:2 row_mask:0xf bank_mask:0xf
    v_mov_b32_dpp v169, v169 row_newbcast:2 row_mask:0xf bank_mask:0xf
    v_mov_b32_dpp v170, v170 row_newbcast:2 row_mask:0xf bank_mask:0xf
    v_mov_b32_dpp v171, v171 row_newbcast:2 row_mask:0xf bank_mask:0xf
    v_mov_b32_dpp v172, v172 row_newbcast:2 row_mask:0xf bank_mask:0xf
    buffer_load_dwordx4 a[212:215], v115, s[12:15], s95 offen sc1
    s_add_u32 s95, s95, 32768
    v_mov_b32_dpp v173, v173 row_newbcast:2 row_mask:0xf bank_mask:0xf
    v_mov_b32_dpp v174, v174 row_newbcast:2 row_mask:0xf bank_mask:0xf
    v_mov_b32_dpp v175, v175 row_newbcast:2 row_mask:0xf bank_mask:0xf
    s_getpc_b64 s[40:41]
L_pf4_s:
    s_nop 0
    v_min_u32 v19, pf_last4, v0
    global_load_dword v18, v19, s[40:41]
    buffer_load_dwordx4 v15, s[12:15], s38 offen offset:1024 sc1 lds
    v_pk_fma_f32 v[220:221], v[220:221], v[156:157], v[120:121] op_sel:[0,0,0] op_sel_hi:[1,0,1]
    v_pk_fma_f32 v[222:223], v[222:223], v[156:157], v[122:123] op_sel:[0,0,0] op_sel_hi:[1,0,1]
    v_pk_fma_f32 v[224:225], v[224:225], v[156:157], v[120:121] op_sel:[0,1,0] op_sel_hi:[1,1,1]
    v_pk_fma_f32 v[226:227], v[226:227], v[156:157], v[122:123] op_sel:[0,1,0] op_sel_hi:[1,1,1]
    v_pk_fma_f32 v[220:221], v[132:133], v[158:159], v[220:221] op_sel:[0,0,0] op_sel_hi:[1,0,1]
    v_pk_fma_f32 v[222:223], v[134:135], v[158:159], v[222:223] op_sel:[0,0,0] op_sel_hi:[1,0,1]
    v_pk_fma_f32 v[224:225], v[132:133], v[158:159], v[224:225] op_sel:[0,1,0] op_sel_hi:[1,1,1]
    v_pk_fma_f32 v[226:227], v[134:135], v[158:159], v[226:227] op_sel:[0,1,0] op_sel_hi:[1,1,1]
    v_pk_fma_f32 v[220:221], v[144:145], v[160:161], v[220:221] op_sel:[0,0,0] op_sel_hi:[1,0,1]
    v_pk_fma_f32 v[222:223], v[146:147], v[160:161], v[222:223] op_sel:[0,0,0] op_sel_hi:[1,0,1]
    buffer_load_dwordx4 v15, s[12:15], s38 offen offset:2048 sc1 lds
    v_pk_fma_f32 v[224:225], v[144:145], v[160:161], v[224:225] op_sel:[0,1,0] op_sel_hi:[1,1,1]
    v_pk_fma_f32 v[226:227], v[146:147], v[160:161], v[226:227] op_sel:[0,1,0] op_sel_hi:[1,1,1]
    v_pk_fma_f32 v[220:221], v[164:165], v[162:163], v[220:221] op_sel:[0,0,0] op_sel_hi:[1,0,1]
    v_pk_fma_f32 v[222:223], v[166:167], v[162:163], v[222:223] op_sel:[0,0,0] op_sel_hi:[1,0,1]
    v_pk_fma_f32 v[224:225], v[164:165], v[162:163], v[224:225] op_sel:[0,1,0] op_sel_hi:[1,1,1]
    v_pk_fma_f32 v[226:227], v[166:167], v[162:163], v[226:227] op_sel:[0,1,0] op_sel_hi:[1,1,1]
    v_pk_mul_f32 v[20:21], v[220:221], v[220:221]
    v_pk_mul_f32 v[22:23], v[222:223], v[222:223]
    v_pk_mul_f32 v[24:25], v[224:225], v[224:225]
    buffer_load_dwordx4 v15, s[12:15], s38 offen offset:3072 sc1 lds
    s_add_u32 s38, s38, 16384
    v_pk_mul_f32 v[26:27], v[226:227], v[226:227]
    v_pk_fma_f32 v[20:21], v[20:21], s[42:43], s[42:43] op_sel:[0,0,1] op_sel_hi:[1,0,1]
    v_pk_fma_f32 v[22:23], v[22:23], s[42:43], s[42:43] op_sel:[0,0,1] op_sel_hi:[1,0,1]
    v_pk_fma_f32 v[24:25], v[24:25], s[42:43], s[42:43] op_sel:[0,0,1] op_sel_hi:[1,0,1]
    v_pk_fma_f32 v[26:27], v[26:27], s[42:43], s[42:43] op_sel:[0,0,1] op_sel_hi:[1,0,1]
    v_pk_mul_f32 v[20:21], v[20:21], v[220:221]
    v_pk_mul_f32 v[22:23], v[22:23], v[222:223]
    v_pk_mul_f32 v[24:25], v[24:25], v[224:225]
    v_pk_mul_f32 v[26:27], v[26:27], v[226:227]
    v_exp_f32 v20, v20
    v_exp_f32 v21, v21
    v_exp_f32 v22, v22
    v_exp_f32 v23, v23
    v_exp_f32 v24, v24
    s_add_u32 m0, s39, 49152
    s_nop 0
    buffer_load_dwordx4 v15, s[12:15], s38 offen offset:0 sc1 lds
    v_exp_f32 v25, v25
    v_exp_f32 v26, v26
    v_exp_f32 v27, v27
    v_pk_add_f32 v[20:21], v[20:21], 1.0 op_sel_hi:[1,0]
    v_pk_add_f32 v[22:23], v[22:23], 1.0 op_sel_hi:[1,0]
    v_pk_add_f32 v[24:25], v[24:25], 1.0 op_sel_hi:[1,0]
    v_pk_add_f32 v[26:27], v[26:27], 1.0 op_sel_hi:[1,0]
    v_rcp_f32 v20, v20
    v_rcp_f32 v21, v21
    v_rcp_f32 v22, v22
    v_rcp_f32 v23, v23
    v_rcp_f32 v24, v24
    buffer_load_dwordx4 v15, s[12:15], s38 offen offset:1024 sc1 lds
    v_rcp_f32 v25, v25
    v_rcp_f32 v26, v26
    v_rcp_f32_e64 v27, v27
    v_pk_mul_f32 v[20:21], v[20:21], v[220:221]
    v_pk_mul_f32 v[22:23], v[22:23], v[222:223]
    buffer_load_dwordx4 v15, s[12:15], s38 offen offset:2048 sc1 lds
    v_pk_mul_f32 v[24:25], v[24:25], v[224:225]
    v_pk_mul_f32 v[26:27], v[26:27], v[226:227]
    v_cvt_pk_bf16_f32 v204, v20, v21
    v_cvt_pk_bf16_f32 v206, v24, v25
    v_cvt_pk_bf16_f32 v205, v22, v23
    v_cvt_pk_bf16_f32 v207, v26, v27
    v_permlane16_swap_b32 v204, v206
    s_nop 0
    v_permlane16_swap_b32 v205, v207
    s_nop 0
    buffer_load_dwordx4 v15, s[12:15], s38 offen offset:3072 sc1 lds
    s_add_u32 s38, s38, 16384
    buffer_store_dwordx4 v[204:207], v5, s[12:15], s76 offen sc1
    s_add_u32 s76, s76, 88064
    v_pk_fma_f32 v[228:229], v[228:229], v[156:157], v[124:125] op_sel:[0,0,0] op_sel_hi:[1,0,1]
    v_pk_fma_f32 v[230:231], v[230:231], v[156:157], v[126:127] op_sel:[0,0,0] op_sel_hi:[1,0,1]
    v_pk_fma_f32 v[232:233], v[232:233], v[156:157], v[124:125] op_sel:[0,1,0] op_sel_hi:[1,1,1]
    v_pk_fma_f32 v[234:235], v[234:235], v[156:157], v[126:127] op_sel:[0,1,0] op_sel_hi:[1,1,1]
    v_pk_fma_f32 v[228:229], v[136:137], v[158:159], v[228:229] op_sel:[0,0,0] op_sel_hi:[1,0,1]
    v_pk_fma_f32 v[230:231], v[138:139], v[158:159], v[230:231] op_sel:[0,0,0] op_sel_hi:[1,0,1]
    v_pk_fma_f32 v[232:233], v[136:137], v[158:159], v[232:233] op_sel:[0,1,0] op_sel_hi:[1,1,1]
    v_pk_fma_f32 v[234:235], v[138:139], v[158:159], v[234:235] op_sel:[0,1,0] op_sel_hi:[1,1,1]
    v_pk_fma_f32 v[228:229], v[148:149], v[160:161], v[228:229] op_sel:[0,0,0] op_sel_hi:[1,0,1]
    v_pk_fma_f32 v[230:231], v[150:151], v[160:161], v[230:231] op_sel:[0,0,0] op_sel_hi:[1,0,1]
    v_pk_fma_f32 v[232:233], v[148:149], v[160:161], v[232:233] op_sel:[0,1,0] op_sel_hi:[1,1,1]
    v_pk_fma_f32 v[234:235], v[150:151], v[160:161], v[234:235] op_sel:[0,1,0] op_sel_hi:[1,1,1]
    v_pk_fma_f32 v[228:229], v[168:169], v[162:163], v[228:229] op_sel:[0,0,0] op_sel_hi:[1,0,1]
    v_pk_fma_f32 v[230:231], v[170:171], v[162:163], v[230:231] op_sel:[0,0,0] op_sel_hi:[1,0,1]
    v_pk_fma_f32 v[232:233], v[168:169], v[162:163], v[232:233] op_sel:[0,1,0] op_sel_hi:[1,1,1]
    v_pk_fma_f32 v[234:235], v[170:171], v[162:163], v[234:235] op_sel:[0,1,0] op_sel_hi:[1,1,1]
    v_pk_mul_f32 v[28:29], v[228:229], v[228:229]
    v_pk_mul_f32 v[30:31], v[230:231], v[230:231]
    v_pk_mul_f32 v[32:33], v[232:233], v[232:233]
    v_pk_mul_f32 v[34:35], v[234:235], v[234:235]
    v_pk_fma_f32 v[28:29], v[28:29], s[42:43], s[42:43] op_sel:[0,0,1] op_sel_hi:[1,0,1]
    v_pk_fma_f32 v[30:31], v[30:31], s[42:43], s[42:43] op_sel:[0,0,1] op_sel_hi:[1,0,1]
    v_pk_fma_f32 v[32:33], v[32:33], s[42:43], s[42:43] op_sel:[0,0,1] op_sel_hi:[1,0,1]
    v_pk_fma_f32 v[34:35], v[34:35], s[42:43], s[42:43] op_sel:[0,0,1] op_sel_hi:[1,0,1]
    v_pk_mul_f32 v[28:29], v[28:29], v[228:229]
    v_pk_mul_f32 v[30:31], v[30:31], v[230:231]
    v_pk_mul_f32 v[32:33], v[32:33], v[232:233]
    v_pk_mul_f32 v[34:35], v[34:35], v[234:235]
    v_exp_f32 v28, v28
    v_exp_f32 v29, v29
    v_exp_f32 v30, v30
    v_exp_f32 v31, v31
    v_exp_f32 v32, v32
    v_exp_f32 v33, v33
    buffer_load_dwordx4 a[216:219], v115, s[12:15], s95 offen sc1
    s_add_u32 s95, s95, 32768
    v_exp_f32 v34, v34
    v_exp_f32 v35, v35
    v_pk_add_f32 v[28:29], v[28:29], 1.0 op_sel_hi:[1,0]
    v_pk_add_f32 v[30:31], v[30:31], 1.0 op_sel_hi:[1,0]
    v_pk_add_f32 v[32:33], v[32:33], 1.0 op_sel_hi:[1,0]
    v_pk_add_f32 v[34:35], v[34:35], 1.0 op_sel_hi:[1,0]
    v_rcp_f32 v28, v28
    v_rcp_f32 v29, v29
    v_rcp_f32 v30, v30
    v_rcp_f32 v31, v31
    v_rcp_f32 v32, v32
    v_rcp_f32 v33, v33
    buffer_load_dwordx4 a[220:223], v115, s[12:15], s95 offen sc1
    s_add_u32 s95, s95, 32768
    v_rcp_f32 v34, v34
    v_rcp_f32 v35, v35
    v_pk_mul_f32 v[28:29], v[28:29], v[228:229]
    v_pk_mul_f32 v[30:31], v[30:31], v[230:231]
    v_pk_mul_f32 v[32:33], v[32:33], v[232:233]
    v_pk_mul_f32 v[34:35], v[34:35], v[234:235]
    v_cvt_pk_bf16_f32 v208, v28, v29
    v_cvt_pk_bf16_f32 v210, v32, v33
    v_cvt_pk_bf16_f32 v209, v30, v31
    v_cvt_pk_bf16_f32 v211, v34, v35
    v_permlane16_swap_b32 v208, v210
    s_nop 0
    v_permlane16_swap_b32 v209, v211
    s_nop 0
    buffer_store_dwordx4 v[208:211], v5, s[12:15], s77 offen sc1
    s_add_u32 s77, s77, 88064
    v_pk_fma_f32 v[236:237], v[236:237], v[156:157], v[128:129] op_sel:[0,0,0] op_sel_hi:[1,0,1]
    v_pk_fma_f32 v[238:239], v[238:239], v[156:157], v[130:131] op_sel:[0,0,0] op_sel_hi:[1,0,1]
    v_pk_fma_f32 v[240:241], v[240:241], v[156:157], v[128:129] op_sel:[0,1,0] op_sel_hi:[1,1,1]
    v_pk_fma_f32 v[242:243], v[242:243], v[156:157], v[130:131] op_sel:[0,1,0] op_sel_hi:[1,1,1]
    v_pk_fma_f32 v[236:237], v[140:141], v[158:159], v[236:237] op_sel:[0,0,0] op_sel_hi:[1,0,1]
    v_pk_fma_f32 v[238:239], v[142:143], v[158:159], v[238:239] op_sel:[0,0,0] op_sel_hi:[1,0,1]
    v_pk_fma_f32 v[240:241], v[140:141], v[158:159], v[240:241] op_sel:[0,1,0] op_sel_hi:[1,1,1]
    v_pk_fma_f32 v[242:243], v[142:143], v[158:159], v[242:243] op_sel:[0,1,0] op_sel_hi:[1,1,1]
    v_pk_fma_f32 v[236:237], v[152:153], v[160:161], v[236:237] op_sel:[0,0,0] op_sel_hi:[1,0,1]
    v_pk_fma_f32 v[238:239], v[154:155], v[160:161], v[238:239] op_sel:[0,0,0] op_sel_hi:[1,0,1]
    v_pk_fma_f32 v[240:241], v[152:153], v[160:161], v[240:241] op_sel:[0,1,0] op_sel_hi:[1,1,1]
    v_pk_fma_f32 v[242:243], v[154:155], v[160:161], v[242:243] op_sel:[0,1,0] op_sel_hi:[1,1,1]
    v_pk_fma_f32 v[236:237], v[172:173], v[162:163], v[236:237] op_sel:[0,0,0] op_sel_hi:[1,0,1]
    v_pk_fma_f32 v[238:239], v[174:175], v[162:163], v[238:239] op_sel:[0,0,0] op_sel_hi:[1,0,1]
    v_pk_fma_f32 v[240:241], v[172:173], v[162:163], v[240:241] op_sel:[0,1,0] op_sel_hi:[1,1,1]
    v_pk_fma_f32 v[242:243], v[174:175], v[162:163], v[242:243] op_sel:[0,1,0] op_sel_hi:[1,1,1]
    v_pk_mul_f32 v[20:21], v[236:237], v[236:237]
    v_pk_mul_f32 v[22:23], v[238:239], v[238:239]
    buffer_load_dwordx4 a[224:227], v115, s[12:15], s95 offen sc1
    s_add_u32 s95, s95, 32768
    v_pk_mul_f32 v[24:25], v[240:241], v[240:241]
    v_pk_mul_f32 v[26:27], v[242:243], v[242:243]
    v_pk_fma_f32 v[20:21], v[20:21], s[42:43], s[42:43] op_sel:[0,0,1] op_sel_hi:[1,0,1]
    v_pk_fma_f32 v[22:23], v[22:23], s[42:43], s[42:43] op_sel:[0,0,1] op_sel_hi:[1,0,1]
    v_pk_fma_f32 v[24:25], v[24:25], s[42:43], s[42:43] op_sel:[0,0,1] op_sel_hi:[1,0,1]
    v_pk_fma_f32 v[26:27], v[26:27], s[42:43], s[42:43] op_sel:[0,0,1] op_sel_hi:[1,0,1]
    v_pk_mul_f32 v[20:21], v[20:21], v[236:237]
    v_pk_mul_f32 v[22:23], v[22:23], v[238:239]
    v_pk_mul_f32 v[24:25], v[24:25], v[240:241]
    v_pk_mul_f32 v[26:27], v[26:27], v[242:243]
    v_exp_f32 v20, v20
    v_exp_f32 v21, v21
    s_waitcnt vmcnt(9)
    s_barrier
    buffer_load_dwordx4 a[228:231], v115, s[12:15], s95 offen sc1
    s_add_u32 s95, s95, 32768
    v_exp_f32 v22, v22
    v_exp_f32 v23, v23
    v_exp_f32 v24, v24
    v_exp_f32 v25, v25
    v_exp_f32 v26, v26
    v_exp_f32 v27, v27
    ds_read_b128 v[180:183], v15 offset:32768
    v_pk_add_f32 v[20:21], v[20:21], 1.0 op_sel_hi:[1,0]
    v_pk_add_f32 v[22:23], v[22:23], 1.0 op_sel_hi:[1,0]
    ds_read_b128 v[184:187], v15 offset:33792
    v_pk_add_f32 v[24:25], v[24:25], 1.0 op_sel_hi:[1,0]
    buffer_load_dwordx4 a[232:235], v115, s[12:15], s95 offen sc1
    s_add_u32 s95, s95, 32768
    v_pk_add_f32 v[26:27], v[26:27], 1.0 op_sel_hi:[1,0]
    v_rcp_f32 v20, v20
    ds_read_b128 v[188:191], v15 offset:34816
    v_rcp_f32 v21, v21
    ds_read_b128 v[192:195], v15 offset:35840
    v_rcp_f32 v22, v22
    v_rcp_f32 v23, v23
    v_rcp_f32 v24, v24
    v_rcp_f32 v25, v25
    v_rcp_f32 v26, v26
    buffer_load_dwordx4 a[236:239], v115, s[12:15], s95 offen sc1
    s_add_u32 s95, s95, 32768
    v_rcp_f32 v27, v27
    v_pk_mul_f32 v[20:21], v[20:21], v[236:237]
    v_pk_mul_f32 v[22:23], v[22:23], v[238:239]
    v_pk_mul_f32 v[24:25], v[24:25], v[240:241]
    v_pk_mul_f32 v[26:27], v[26:27], v[242:243]
    v_cvt_pk_bf16_f32 v212, v20, v21
    v_cvt_pk_bf16_f32 v214, v24, v25
    v_cvt_pk_bf16_f32 v213, v22, v23
    v_cvt_pk_bf16_f32 v215, v26, v27
    v_permlane16_swap_b32 v212, v214
    s_nop 0
    v_permlane16_swap_b32 v213, v215
    buffer_store_dwordx4 v[212:215], v5, s[12:15], s78 offen sc1
    s_add_u32 s78, s78, 88064
    s_waitcnt lgkmcnt(2)
    v_mfma_f32_16x16x32_bf16 v[220:223], v[36:39], v[180:183], 0
    ds_read_b128 v[196:199], v15 offset:36864
    ds_read_b128 v[20:23], v17 offset:8192
    v_mfma_f32_16x16x32_bf16 v[224:227], v[36:39], v[184:187], 0
    ds_read_b128 v[200:203], v15 offset:37888
    ds_read_b128 v[24:27], v17 offset:9216
    v_mfma_f32_16x16x32_bf16 v[228:231], v[40:43], v[180:183], 0
    ds_read_b128 v[28:31], v17 offset:10240
    buffer_load_dwordx4 a[240:243], v115, s[12:15], s95 offen sc1
    s_add_u32 s95, s95, 32768
    v_mfma_f32_16x16x32_bf16 v[232:235], v[40:43], v[184:187], 0
    ds_read_b128 v[32:35], v17 offset:11264
    v_mfma_f32_16x16x32_bf16 v[236:239], v[44:47], v[180:183], 0
    ds_read_b128 v[204:207], v17 offset:12288
    v_mfma_f32_16x16x32_bf16 v[240:243], v[44:47], v[184:187], 0
    s_waitcnt lgkmcnt(7)
    v_mfma_f32_16x16x32_bf16 v[220:223], v[48:51], v[188:191], v[220:223]
    ds_read_b128 v[208:211], v17 offset:13312
    ds_read_b128 v[180:183], v15 offset:38912
    v_mfma_f32_16x16x32_bf16 v[224:227], v[48:51], v[192:195], v[224:227]
    ds_read_b128 v[212:215], v17 offset:14336
    ds_read_b128 v[184:187], v15 offset:39936
    v_mfma_f32_16x16x32_bf16 v[228:231], v[52:55], v[188:191], v[228:231]
    ds_read_b128 v[216:219], v17 offset:15360
    buffer_load_dwordx4 a[244:247], v115, s[12:15], s95 offen sc1
    s_add_u32 s95, s95, 32768
    v_mfma_f32_16x16x32_bf16 v[232:235], v[52:55], v[192:195], v[232:235]
    v_mfma_f32_16x16x32_bf16 v[236:239], v[56:59], v[188:191], v[236:239]
    v_mfma_f32_16x16x32_bf16 v[240:243], v[56:59], v[192:195], v[240:243]
    s_waitcnt lgkmcnt(9)
    v_mfma_f32_16x16x32_bf16 v[220:223], v[60:63], v[196:199], v[220:223]
    ds_read_b128 v[188:191], v15 offset:40960
    ds_read_b128 v[192:195], v15 offset:41984
    v_mfma_f32_16x16x32_bf16 v[224:227], v[60:63], v[200:203], v[224:227]
    buffer_load_dwordx4 a[248:251], v115, s[12:15], s95 offen sc1
    s_add_u32 s95, s95, 32768
    v_mfma_f32_16x16x32_bf16 v[228:231], v[64:67], v[196:199], v[228:231]
    s_waitcnt lgkmcnt(7)
    v_add_f32 v20, v20, v204
    v_add_f32 v21, v21, v205
    v_mfma_f32_16x16x32_bf16 v[232:235], v[64:67], v[200:203], v[232:235]
    v_add_f32 v22, v22, v206
    s_waitcnt lgkmcnt(6)
    v_add_f32 v24, v24, v208
    v_mfma_f32_16x16x32_bf16 v[236:239], v[68:71], v[196:199], v[236:239]
    v_mfma_f32_16x16x32_bf16 v[240:243], v[68:71], v[200:203], v[240:243]
    s_waitcnt lgkmcnt(3)
    v_mfma_f32_16x16x32_bf16 v[220:223], v[72:75], v[180:183], v[220:223]
    v_add_f32 v25, v25, v209
    ds_read_b128 v[196:199], v15 offset:43008
    v_mfma_f32_16x16x32_bf16 v[224:227], v[72:75], v[184:187], v[224:227]
    buffer_load_dwordx4 a[252:255], v115, s[12:15], s95 offen sc1
    s_add_u32 s95, s95, 32768
    v_mfma_f32_16x16x32_bf16 v[228:231], v[76:79], v[180:183], v[228:231]
    v_add_f32 v26, v26, v210
    ds_read_b128 v[200:203], v15 offset:44032
    v_mfma_f32_16x16x32_bf16 v[232:235], v[76:79], v[184:187], v[232:235]
    v_add_f32 v28, v28, v212
    v_add_f32 v29, v29, v213
    v_mfma_f32_16x16x32_bf16 v[236:239], v[80:83], v[180:183], v[236:239]
    v_add_f32 v30, v30, v214
    buffer_load_dwordx4 v[36:39], v115, s[12:15], s95 offen sc1
    s_add_u32 s95, s95, 32768
    v_mfma_f32_16x16x32_bf16 v[240:243], v[80:83], v[184:187], v[240:243]
    s_waitcnt lgkmcnt(2)
    v_mfma_f32_16x16x32_bf16 v[220:223], a[0:3], v[188:191], v[220:223]
    v_add_f32 v32, v32, v216
    ds_read_b128 v[180:183], v15 offset:45056
    v_mfma_f32_16x16x32_bf16 v[224:227], a[0:3], v[192:195], v[224:227]
    v_add_f32 v33, v33, v217
    ds_read_b128 v[184:187], v15 offset:46080
    v_mfma_f32_16x16x32_bf16 v[228:231], a[4:7], v[188:191], v[228:231]
    v_add_f32 v34, v34, v218
    v_add_f32 v20, v20, v28
    v_mfma_f32_16x16x32_bf16 v[232:235], a[4:7], v[192:195], v[232:235]
    buffer_load_dwordx4 v[40:43], v115, s[12:15], s95 offen sc1
    s_add_u32 s95, s95, 32768
    v_mfma_f32_16x16x32_bf16 v[236:239], a[8:11], v[188:191], v[236:239]
    v_add_f32 v21, v21, v29
    v_add_f32 v22, v22, v30
    v_mfma_f32_16x16x32_bf16 v[240:243], a[8:11], v[192:195], v[240:243]
    s_waitcnt lgkmcnt(2)
    v_mfma_f32_16x16x32_bf16 v[220:223], a[12:15], v[196:199], v[220:223]
    v_add_f32 v24, v24, v32
    ds_read_b128 v[188:191], v15 offset:47104
    v_mfma_f32_16x16x32_bf16 v[224:227], a[12:15], v[200:203], v[224:227]
    v_add_f32 v25, v25, v33
    ds_read_b128 v[192:195], v15 offset:48128
    v_mfma_f32_16x16x32_bf16 v[228:231], a[16:19], v[196:199], v[228:231]
    v_add_f32 v26, v26, v34
    buffer_load_dwordx4 v[44:47], v115, s[12:15], s95 offen sc1
    s_add_u32 s95, s95, 32768
    v_mfma_f32_16x16x32_bf16 v[232:235], a[16:19], v[200:203], v[232:235]
    v_add_f32 v20, v20, v24
    v_mfma_f32_16x16x32_bf16 v[236:239], a[20:23], v[196:199], v[236:239]
    v_add_f32 v21, v21, v25
    v_add_f32 v22, v22, v26
    v_mfma_f32_16x16x32_bf16 v[240:243], a[20:23], v[200:203], v[240:243]
    s_waitcnt lgkmcnt(2)
    v_mfma_f32_16x16x32_bf16 v[220:223], a[24:27], v[180:183], v[220:223]
    v_mul_f32 v20, 0x3b000000, v20
    s_waitcnt vmcnt(16)
    s_barrier
    v_mfma_f32_16x16x32_bf16 v[224:227], a[24:27], v[184:187], v[224:227]
    v_mfma_f32_16x16x32_bf16 v[228:231], a[28:31], v[180:183], v[228:231]
    buffer_load_dwordx4 v[48:51], v115, s[12:15], s95 offen sc1
    s_add_u32 s95, s95, 32768
    v_mfma_f32_16x16x32_bf16 v[232:235], a[28:31], v[184:187], v[232:235]
    v_mul_f32 v21, 0x3b000000, v21
    v_mul_f32 v22, 0x3b000000, v22
    v_mfma_f32_16x16x32_bf16 v[236:239], a[32:35], v[180:183], v[236:239]
    ds_read_b128 v[196:199], v15 offset:49152
    v_mov_b32 v24, v20
    v_mfma_f32_16x16x32_bf16 v[240:243], a[32:35], v[184:187], v[240:243]
    ds_read_b128 v[200:203], v15 offset:50176
    v_mov_b32 v25, v21
    s_waitcnt lgkmcnt(2)
    v_mfma_f32_16x16x32_bf16 v[220:223], a[36:39], v[188:191], v[220:223]
    buffer_load_dwordx4 v[52:55], v115, s[12:15], s95 offen sc1
    s_add_u32 s95, s95, 32768
    v_mfma_f32_16x16x32_bf16 v[224:227], a[36:39], v[192:195], v[224:227]
    v_mov_b32 v26, v22
    ds_read_b128 v[180:183], v15 offset:51200
    s_waitcnt vmcnt(9)
    s_mov_b64 exec, 1
    buffer_store_dword v2, v4, s[12:15], s17 offen sc1
    s_mov_b64 exec, -1
    s_add_u32 s17, s17, 128
    v_mfma_f32_16x16x32_bf16 v[228:231], a[40:43], v[188:191], v[228:231]
    v_mfma_f32_16x16x32_bf16 v[232:235], a[40:43], v[192:195], v[232:235]
    ds_read_b128 v[184:187], v15 offset:52224
    v_permlane32_swap_b32 v20, v24
    v_mfma_f32_16x16x32_bf16 v[236:239], a[44:47], v[188:191], v[236:239]
    v_permlane32_swap_b32 v21, v25
    v_mfma_f32_16x16x32_bf16 v[240:243], a[44:47], v[192:195], v[240:243]
    buffer_load_dwordx4 v[56:59], v115, s[12:15], s95 offen sc1
    s_add_u32 s95, s95, 32768
    s_waitcnt lgkmcnt(2)
    v_mfma_f32_16x16x32_bf16 v[220:223], a[48:51], v[196:199], v[220:223]
    v_permlane32_swap_b32 v22, v26
    v_mfma_f32_16x16x32_bf16 v[224:227], a[48:51], v[200:203], v[224:227]
    ds_read_b128 v[188:191], v15 offset:53248
    ds_read_b128 v[192:195], v15 offset:54272
    v_mfma_f32_16x16x32_bf16 v[228:231], a[52:55], v[196:199], v[228:231]
    v_fma_f32 v24, -v20, v20, v24
    v_max_f32 v24, 0, v24
    v_mfma_f32_16x16x32_bf16 v[232:235], a[52:55], v[200:203], v[232:235]
    buffer_load_dwordx4 v[60:63], v115, s[12:15], s95 offen sc1
    s_add_u32 s95, s95, 32768
    v_mfma_f32_16x16x32_bf16 v[236:239], a[56:59], v[196:199], v[236:239]
    v_add_f32 v24, 0x3727c5ac, v24
    v_rsq_f32 v28, v24
    v_mfma_f32_16x16x32_bf16 v[240:243], a[56:59], v[200:203], v[240:243]
    s_waitcnt lgkmcnt(2)
    v_mfma_f32_16x16x32_bf16 v[220:223], a[60:63], v[180:183], v[220:223]
    ds_read_b128 v[196:199], v15 offset:55296
    v_fma_f32 v21, -v20, s84, v21
    v_mfma_f32_16x16x32_bf16 v[224:227], a[60:63], v[184:187], v[224:227]
    ds_read_b128 v[200:203], v15 offset:56320
    v_mul_f32 v31, s85, v20
    v_mfma_f32_16x16x32_bf16 v[228:231], a[64:67], v[180:183], v[228:231]
    buffer_load_dwordx4 v[64:67], v115, s[12:15], s95 offen sc1
    s_add_u32 s95, s95, 32768
    v_mfma_f32_16x16x32_bf16 v[232:235], a[64:67], v[184:187], v[232:235]
    v_fma_f32 v29, v28, v21, s87
    v_fma_f32 v31, v22, -2.0, v31
    v_mfma_f32_16x16x32_bf16 v[236:239], a[68:71], v[180:183], v[236:239]
    v_fma_f32 v25, v20, v31, v25
    v_mfma_f32_16x16x32_bf16 v[240:243], a[68:71], v[184:187], v[240:243]
    s_waitcnt lgkmcnt(2)
    v_mfma_f32_16x16x32_bf16 v[220:223], a[72:75], v[188:191], v[220:223]
    v_fma_f32 v26, -v20, s86, v26
    ds_read_b128 v[180:183], v15 offset:57344
    v_mfma_f32_16x16x32_bf16 v[224:227], a[72:75], v[192:195], v[224:227]
    v_add_f32 v26, v26, v26
    ds_read_b128 v[184:187], v15 offset:58368
    v_mfma_f32_16x16x32_bf16 v[228:231], a[76:79], v[188:191], v[228:231]
    buffer_load_dwordx4 v[68:71], v115, s[12:15], s95 offen sc1
    s_add_u32 s95, s95, 32768
    v_mfma_f32_16x16x32_bf16 v[232:235], a[76:79], v[192:195], v[232:235]
    v_fma_f32 v30, v28, v25, v26
    v_fma_f32 v30, v28, v30, s88
    v_mfma_f32_16x16x32_bf16 v[236:239], a[80:83], v[188:191], v[236:239]
    v_fma_f32 v30, -v29, v29, v30
    v_max_f32 v30, 0, v30
    v_mfma_f32_16x16x32_bf16 v[240:243], a[80:83], v[192:195], v[240:243]
    s_waitcnt lgkmcnt(2)
    v_mfma_f32_16x16x32_bf16 v[220:223], a[84:87], v[196:199], v[220:223]
    buffer_load_dwordx4 v[72:75], v115, s[12:15], s95 offen sc1
    s_add_u32 s95, s95, 32768
    v_mfma_f32_16x16x32_bf16 v[224:227], a[84:87], v[200:203], v[224:227]
    ds_read_b128 v[188:191], v15 offset:59392
    v_add_f32 v30, 0x3727c5ac, v30
    v_mfma_f32_16x16x32_bf16 v[228:231], a[88:91], v[196:199], v[228:231]
    ds_read_b128 v[192:195], v15 offset:60416
    v_rsq_f32 v158, v30
    v_mfma_f32_16x16x32_bf16 v[232:235], a[88:91], v[200:203], v[232:235]
    v_mul_f32 v156, v28, v158
    v_mfma_f32_16x16x32_bf16 v[236:239], a[92:95], v[196:199], v[236:239]
    buffer_load_dwordx4 v[76:79], v115, s[12:15], s95 offen sc1
    s_add_u32 s95, s95, 32768
    v_mfma_f32_16x16x32_bf16 v[240:243], a[92:95], v[200:203], v[240:243]
    v_mul_f32 v162, -v29, v158
    s_waitcnt lgkmcnt(2)
    v_mfma_f32_16x16x32_bf16 v[220:223], a[96:99], v[180:183], v[220:223]
    v_mul_f32 v160, -v20, v156
    ds_read_b128 v[196:199], v15 offset:61440
    v_mfma_f32_16x16x32_bf16 v[224:227], a[96:99], v[184:187], v[224:227]
    v_mov_b32 v157, v156
    ds_read_b128 v[200:203], v15 offset:62464
    v_mfma_f32_16x16x32_bf16 v[228:231], a[100:103], v[180:183], v[228:231]
    v_mov_b32 v159, v158
    v_mov_b32 v161, v160
    v_mfma_f32_16x16x32_bf16 v[232:235], a[100:103], v[184:187], v[232:235]
    buffer_load_dwordx4 v[80:83], v115, s[12:15], s95 offen sc1
    s_add_u32 s95, s95, 32768
    v_mfma_f32_16x16x32_bf16 v[236:239], a[104:107], v[180:183], v[236:239]
    v_mov_b32 v163, v162
    v_permlane16_swap_b32 v156, v157
    v_mfma_f32_16x16x32_bf16 v[240:243], a[104:107], v[184:187], v[240:243]
    s_waitcnt lgkmcnt(2)
    v_mfma_f32_16x16x32_bf16 v[220:223], a[108:111], v[188:191], v[220:223]
    ds_read_b128 v[180:183], v15 offset:63488
    v_permlane16_swap_b32 v158, v159
    v_mfma_f32_16x16x32_bf16 v[224:227], a[108:111], v[192:195], v[224:227]
    ds_read_b128 v[184:187], v15 offset:64512
    v_mfma_f32_16x16x32_bf16 v[228:231], a[112:115], v[188:191], v[228:231]
    buffer_load_dwordx4 a[0:3], v115, s[12:15], s95 offen sc1
    s_add_u32 s95, s95, 32768
    v_mfma_f32_16x16x32_bf16 v[232:235], a[112:115], v[192:195], v[232:235]
    v_permlane16_swap_b32 v160, v161
    v_mfma_f32_16x16x32_bf16 v[236:239], a[116:119], v[188:191], v[236:239]
    v_mfma_f32_16x16x32_bf16 v[240:243], a[116:119], v[192:195], v[240:243]
    s_waitcnt lgkmcnt(2)
    v_mfma_f32_16x16x32_bf16 v[220:223], a[120:123], v[196:199], v[220:223]
    v_permlane16_swap_b32 v162, v163
    v_mfma_f32_16x16x32_bf16 v[224:227], a[120:123], v[200:203], v[224:227]
    buffer_load_dword v14, v3, s[12:15], s22 offen sc1
    v_mfma_f32_16x16x32_bf16 v[228:231], a[124:127], v[196:199], v[228:231]
    v_mfma_f32_16x16x32_bf16 v[232:235], a[124:127], v[200:203], v[232:235]
    v_mfma_f32_16x16x32_bf16 v[236:239], a[128:131], v[196:199], v[236:239]
    v_mfma_f32_16x16x32_bf16 v[240:243], a[128:131], v[200:203], v[240:243]
    s_waitcnt lgkmcnt(0)
    v_mfma_f32_16x16x32_bf16 v[220:223], a[132:135], v[180:183], v[220:223]
    buffer_load_dwordx4 a[4:7], v115, s[12:15], s95 offen sc1
    s_add_u32 s95, s95, 32768
    v_mfma_f32_16x16x32_bf16 v[224:227], a[132:135], v[184:187], v[224:227]
    v_mfma_f32_16x16x32_bf16 v[228:231], a[136:139], v[180:183], v[228:231]
    v_mfma_f32_16x16x32_bf16 v[232:235], a[136:139], v[184:187], v[232:235]
    v_mfma_f32_16x16x32_bf16 v[236:239], a[140:143], v[180:183], v[236:239]
    v_mfma_f32_16x16x32_bf16 v[240:243], a[140:143], v[184:187], v[240:243]
    s_nop 0
    v_pk_fma_f32 v[220:221], v[220:221], v[156:157], v[120:121] op_sel:[0,0,0] op_sel_hi:[1,0,1]
    v_pk_fma_f32 v[222:223], v[222:223], v[156:157], v[122:123] op_sel:[0,0,0] op_sel_hi:[1,0,1]
    s_nop 0
    v_pk_fma_f32 v[224:225], v[224:225], v[156:157], v[120:121] op_sel:[0,1,0] op_sel_hi:[1,1,1]
    buffer_load_dwordx4 a[8:11], v115, s[12:15], s95 offen sc1
    s_add_u32 s95, s95, 32768
    v_pk_fma_f32 v[226:227], v[226:227], v[156:157], v[122:123] op_sel:[0,1,0] op_sel_hi:[1,1,1]
    v_pk_fma_f32 v[220:221], v[132:133], v[158:159], v[220:221] op_sel:[0,0,0] op_sel_hi:[1,0,1]
    v_pk_fma_f32 v[222:223], v[134:135], v[158:159], v[222:223] op_sel:[0,0,0] op_sel_hi:[1,0,1]
    v_pk_fma_f32 v[224:225], v[132:133], v[158:159], v[224:225] op_sel:[0,1,0] op_sel_hi:[1,1,1]
    v_pk_fma_f32 v[226:227], v[134:135], v[158:159], v[226:227] op_sel:[0,1,0] op_sel_hi:[1,1,1]
    v_pk_fma_f32 v[220:221], v[144:145], v[160:161], v[220:221] op_sel:[0,0,0] op_sel_hi:[1,0,1]
    v_pk_fma_f32 v[222:223], v[146:147], v[160:161], v[222:223] op_sel:[0,0,0] op_sel_hi:[1,0,1]
    v_pk_fma_f32 v[224:225], v[144:145], v[160:161], v[224:225] op_sel:[0,1,0] op_sel_hi:[1,1,1]
    v_pk_fma_f32 v[226:227], v[146:147], v[160:161], v[226:227] op_sel:[0,1,0] op_sel_hi:[1,1,1]
    v_pk_fma_f32 v[220:221], v[164:165], v[162:163], v[220:221] op_sel:[0,0,0] op_sel_hi:[1,0,1]
    v_pk_fma_f32 v[222:223], v[166:167], v[162:163], v[222:223] op_sel:[0,0,0] op_sel_hi:[1,0,1]
    v_pk_fma_f32 v[224:225], v[164:165], v[162:163], v[224:225] op_sel:[0,1,0] op_sel_hi:[1,1,1]
    v_pk_fma_f32 v[226:227], v[166:167], v[162:163], v[226:227] op_sel:[0,1,0] op_sel_hi:[1,1,1]
    v_pk_mul_f32 v[20:21], v[220:221], v[220:221]
    v_pk_mul_f32 v[22:23], v[222:223], v[222:223]
    v_pk_mul_f32 v[24:25], v[224:225], v[224:225]
    v_pk_mul_f32 v[26:27], v[226:227], v[226:227]
    v_pk_fma_f32 v[20:21], v[20:21], s[42:43], s[42:43] op_sel:[0,0,1] op_sel_hi:[1,0,1]
    v_pk_fma_f32 v[22:23], v[22:23], s[42:43], s[42:43] op_sel:[0,0,1] op_sel_hi:[1,0,1]
    v_pk_fma_f32 v[24:25], v[24:25], s[42:43], s[42:43] op_sel:[0,0,1] op_sel_hi:[1,0,1]
    v_pk_fma_f32 v[26:27], v[26:27], s[42:43], s[42:43] op_sel:[0,0,1] op_sel_hi:[1,0,1]
    v_pk_mul_f32 v[20:21], v[20:21], v[220:221]
    v_pk_mul_f32 v[22:23], v[22:23], v[222:223]
    v_pk_mul_f32 v[24:25], v[24:25], v[224:225]
    v_pk_mul_f32 v[26:27], v[26:27], v[226:227]
    v_exp_f32 v20, v20
    v_exp_f32 v21, v21
    v_exp_f32 v22, v22
    v_exp_f32 v23, v23
    v_exp_f32 v24, v24
    v_exp_f32 v25, v25
    v_exp_f32 v26, v26
    v_exp_f32 v27, v27
    v_pk_add_f32 v[20:21], v[20:21], 1.0 op_sel_hi:[1,0]
    v_pk_add_f32 v[22:23], v[22:23], 1.0 op_sel_hi:[1,0]
    v_pk_add_f32 v[24:25], v[24:25], 1.0 op_sel_hi:[1,0]
    s_waitcnt vmcnt(2)
    v_cmp_ne_u32 vcc, s6, v14
    s_nop 0
    s_cbranch_vccnz retry_24_s
ready_25_s:
    v_pk_add_f32 v[26:27], v[26:27], 1.0 op_sel_hi:[1,0]
    v_rcp_f32 v20, v20
    v_rcp_f32 v21, v21
    v_rcp_f32 v22, v22
    v_rcp_f32 v23, v23
    v_rcp_f32 v24, v24
    v_rcp_f32 v25, v25
    s_add_u32 s22, s22, 128
    v_rcp_f32 v26, v26
    v_rcp_f32 v27, v27
    v_pk_mul_f32 v[20:21], v[20:21], v[220:221]
    v_pk_mul_f32 v[22:23], v[22:23], v[222:223]
    v_pk_mul_f32 v[24:25], v[24:25], v[224:225]
    s_lshl_b32 s39, s3, 12
    s_add_u32 s38, s10, s39
    s_add_u32 s38, s38, 0x25000
    s_add_u32 m0, s39, 65536
    s_nop 0
    s_nop 0
    buffer_load_dwordx4 v15, s[12:15], s38 offen offset:0 sc1 lds
    v_pk_mul_f32 v[26:27], v[26:27], v[226:227]
    v_cvt_pk_bf16_f32 v204, v20, v21
    v_cvt_pk_bf16_f32 v206, v24, v25
    v_cvt_pk_bf16_f32 v205, v22, v23
    v_cvt_pk_bf16_f32 v207, v26, v27
    v_permlane16_swap_b32 v204, v206
    s_nop 0
    v_permlane16_swap_b32 v205, v207
    s_nop 0
    buffer_store_dwordx4 v[204:207], v5, s[12:15], s76 offen sc1
    v_pk_fma_f32 v[228:229], v[228:229], v[156:157], v[124:125] op_sel:[0,0,0] op_sel_hi:[1,0,1]
    v_pk_fma_f32 v[230:231], v[230:231], v[156:157], v[126:127] op_sel:[0,0,0] op_sel_hi:[1,0,1]
    v_pk_fma_f32 v[232:233], v[232:233], v[156:157], v[124:125] op_sel:[0,1,0] op_sel_hi:[1,1,1]
    v_pk_fma_f32 v[234:235], v[234:235], v[156:157], v[126:127] op_sel:[0,1,0] op_sel_hi:[1,1,1]
    v_pk_fma_f32 v[228:229], v[136:137], v[158:159], v[228:229] op_sel:[0,0,0] op_sel_hi:[1,0,1]
    v_pk_fma_f32 v[230:231], v[138:139], v[158:159], v[230:231] op_sel:[0,0,0] op_sel_hi:[1,0,1]
    v_pk_fma_f32 v[232:233], v[136:137], v[158:159], v[232:233] op_sel:[0,1,0] op_sel_hi:[1,1,1]
    v_pk_fma_f32 v[234:235], v[138:139], v[158:159], v[234:235] op_sel:[0,1,0] op_sel_hi:[1,1,1]
    v_pk_fma_f32 v[228:229], v[148:149], v[160:161], v[228:229] op_sel:[0,0,0] op_sel_hi:[1,0,1]
    v_pk_fma_f32 v[230:231], v[150:151], v[160:161], v[230:231] op_sel:[0,0,0] op_sel_hi:[1,0,1]
    v_pk_fma_f32 v[232:233], v[148:149], v[160:161], v[232:233] op_sel:[0,1,0] op_sel_hi:[1,1,1]
    v_pk_fma_f32 v[234:235], v[150:151], v[160:161], v[234:235] op_sel:[0,1,0] op_sel_hi:[1,1,1]
    v_pk_fma_f32 v[228:229], v[168:169], v[162:163], v[228:229] op_sel:[0,0,0] op_sel_hi:[1,0,1]
    v_pk_fma_f32 v[230:231], v[170:171], v[162:163], v[230:231] op_sel:[0,0,0] op_sel_hi:[1,0,1]
    v_pk_fma_f32 v[232:233], v[168:169], v[162:163], v[232:233] op_sel:[0,1,0] op_sel_hi:[1,1,1]
    v_pk_fma_f32 v[234:235], v[170:171], v[162:163], v[234:235] op_sel:[0,1,0] op_sel_hi:[1,1,1]
    v_pk_mul_f32 v[28:29], v[228:229], v[228:229]
    v_pk_mul_f32 v[30:31], v[230:231], v[230:231]
    v_pk_mul_f32 v[32:33], v[232:233], v[232:233]
    v_pk_mul_f32 v[34:35], v[234:235], v[234:235]
    v_pk_fma_f32 v[28:29], v[28:29], s[42:43], s[42:43] op_sel:[0,0,1] op_sel_hi:[1,0,1]
    v_pk_fma_f32 v[30:31], v[30:31], s[42:43], s[42:43] op_sel:[0,0,1] op_sel_hi:[1,0,1]
    v_pk_fma_f32 v[32:33], v[32:33], s[42:43], s[42:43] op_sel:[0,0,1] op_sel_hi:[1,0,1]
    v_pk_fma_f32 v[34:35], v[34:35], s[42:43], s[42:43] op_sel:[0,0,1] op_sel_hi:[1,0,1]
    buffer_load_dwordx4 v15, s[12:15], s38 offen offset:1024 sc1 lds
    v_pk_mul_f32 v[28:29], v[28:29], v[228:229]
    v_pk_mul_f32 v[30:31], v[30:31], v[230:231]
    v_pk_mul_f32 v[32:33], v[32:33], v[232:233]
    v_pk_mul_f32 v[34:35], v[34:35], v[234:235]
    v_exp_f32 v28, v28
    v_exp_f32 v29, v29
    buffer_load_dwordx4 v15, s[12:15], s38 offen offset:2048 sc1 lds
    v_exp_f32 v30, v30
    v_exp_f32 v31, v31
    v_exp_f32 v32, v32
    buffer_load_dwordx4 v15, s[12:15], s38 offen offset:3072 sc1 lds
    s_add_u32 s38, s38, 16384
    v_exp_f32 v33, v33
    v_exp_f32 v34, v34
    v_exp_f32 v35, v35
    v_pk_add_f32 v[28:29], v[28:29], 1.0 op_sel_hi:[1,0]
    v_pk_add_f32 v[30:31], v[30:31], 1.0 op_sel_hi:[1,0]
    v_pk_add_f32 v[32:33], v[32:33], 1.0 op_sel_hi:[1,0]
    v_pk_add_f32 v[34:35], v[34:35], 1.0 op_sel_hi:[1,0]
    v_rcp_f32 v28, v28
    v_rcp_f32 v29, v29
    s_add_u32 m0, s39, 81920
    s_nop 0
    buffer_load_dwordx4 v15, s[12:15], s38 offen offset:0 sc1 lds
    v_rcp_f32 v30, v30
    v_rcp_f32 v31, v31
    v_rcp_f32 v32, v32
    v_rcp_f32 v33, v33
    v_rcp_f32 v34, v34
    v_rcp_f32_e64 v35, v35
    v_pk_mul_f32 v[28:29], v[28:29], v[228:229]
    v_pk_mul_f32 v[30:31], v[30:31], v[230:231]
    buffer_load_dwordx4 v15, s[12:15], s38 offen offset:1024 sc1 lds
    v_pk_mul_f32 v[32:33], v[32:33], v[232:233]
    v_pk_mul_f32 v[34:35], v[34:35], v[234:235]
    v_cvt_pk_bf16_f32 v208, v28, v29
    v_cvt_pk_bf16_f32 v210, v32, v33
    v_cvt_pk_bf16_f32 v209, v30, v31
    v_cvt_pk_bf16_f32 v211, v34, v35
    buffer_load_dwordx4 v15, s[12:15], s38 offen offset:2048 sc1 lds
    v_permlane16_swap_b32 v208, v210
    v_permlane16_swap_b32 v209, v211
    buffer_store_dwordx4 v[208:211], v5, s[12:15], s77 offen sc1
    v_pk_fma_f32 v[236:237], v[236:237], v[156:157], v[128:129] op_sel:[0,0,0] op_sel_hi:[1,0,1]
    v_pk_fma_f32 v[238:239], v[238:239], v[156:157], v[130:131] op_sel:[0,0,0] op_sel_hi:[1,0,1]
    buffer_load_dwordx4 v15, s[12:15], s38 offen offset:3072 sc1 lds
    s_add_u32 s38, s38, 16384
    v_pk_fma_f32 v[240:241], v[240:241], v[156:157], v[128:129] op_sel:[0,1,0] op_sel_hi:[1,1,1]
    v_pk_fma_f32 v[242:243], v[242:243], v[156:157], v[130:131] op_sel:[0,1,0] op_sel_hi:[1,1,1]
    v_pk_fma_f32 v[236:237], v[140:141], v[158:159], v[236:237] op_sel:[0,0,0] op_sel_hi:[1,0,1]
    v_pk_fma_f32 v[238:239], v[142:143], v[158:159], v[238:239] op_sel:[0,0,0] op_sel_hi:[1,0,1]
    v_pk_fma_f32 v[240:241], v[140:141], v[158:159], v[240:241] op_sel:[0,1,0] op_sel_hi:[1,1,1]
    v_pk_fma_f32 v[242:243], v[142:143], v[158:159], v[242:243] op_sel:[0,1,0] op_sel_hi:[1,1,1]
    v_pk_fma_f32 v[236:237], v[152:153], v[160:161], v[236:237] op_sel:[0,0,0] op_sel_hi:[1,0,1]
    v_pk_fma_f32 v[238:239], v[154:155], v[160:161], v[238:239] op_sel:[0,0,0] op_sel_hi:[1,0,1]
    v_pk_fma_f32 v[240:241], v[152:153], v[160:161], v[240:241] op_sel:[0,1,0] op_sel_hi:[1,1,1]
    v_pk_fma_f32 v[242:243], v[154:155], v[160:161], v[242:243] op_sel:[0,1,0] op_sel_hi:[1,1,1]
    v_pk_fma_f32 v[236:237], v[172:173], v[162:163], v[236:237] op_sel:[0,0,0] op_sel_hi:[1,0,1]
    v_pk_fma_f32 v[238:239], v[174:175], v[162:163], v[238:239] op_sel:[0,0,0] op_sel_hi:[1,0,1]
    v_pk_fma_f32 v[240:241], v[172:173], v[162:163], v[240:241] op_sel:[0,1,0] op_sel_hi:[1,1,1]
    v_pk_fma_f32 v[242:243], v[174:175], v[162:163], v[242:243] op_sel:[0,1,0] op_sel_hi:[1,1,1]
    s_add_u32 m0, s39, 98304
    s_nop 0
    s_nop 0
    buffer_load_dwordx4 v15, s[12:15], s38 offen offset:0 sc1 lds
    v_pk_mul_f32 v[20:21], v[236:237], v[236:237]
    v_pk_mul_f32 v[22:23], v[238:239], v[238:239]
    v_pk_mul_f32 v[24:25], v[240:241], v[240:241]
    v_pk_mul_f32 v[26:27], v[242:243], v[242:243]
    v_pk_fma_f32 v[20:21], v[20:21], s[42:43], s[42:43] op_sel:[0,0,1] op_sel_hi:[1,0,1]
    v_pk_fma_f32 v[22:23], v[22:23], s[42:43], s[42:43] op_sel:[0,0,1] op_sel_hi:[1,0,1]
    v_pk_fma_f32 v[24:25], v[24:25], s[42:43], s[42:43] op_sel:[0,0,1] op_sel_hi:[1,0,1]
    v_pk_fma_f32 v[26:27], v[26:27], s[42:43], s[42:43] op_sel:[0,0,1] op_sel_hi:[1,0,1]
    v_pk_mul_f32 v[20:21], v[20:21], v[236:237]
    v_pk_mul_f32 v[22:23], v[22:23], v[238:239]
    v_pk_mul_f32 v[24:25], v[24:25], v[240:241]
    v_pk_mul_f32 v[26:27], v[26:27], v[242:243]
    v_exp_f32 v20, v20
    buffer_load_dwordx4 v15, s[12:15], s38 offen offset:1024 sc1 lds
    v_exp_f32 v21, v21
    s_waitcnt vmcnt(7)
    s_barrier
    v_exp_f32 v22, v22
    v_exp_f32 v23, v23
    buffer_load_dwordx4 v15, s[12:15], s38 offen offset:2048 sc1 lds
    v_exp_f32 v24, v24
    v_exp_f32 v25, v25
    v_exp_f32 v26, v26
    ds_read_b128 v[180:183], v117 offset:0
    v_exp_f32 v27, v27
    buffer_load_dwordx4 v15, s[12:15], s38 offen offset:3072 sc1 lds
    s_add_u32 s38, s38, 16384
    v_pk_add_f32 v[20:21], v[20:21], 1.0 op_sel_hi:[1,0]
    ds_read_b128 v[184:187], v117 offset:2048
    v_pk_add_f32 v[22:23], v[22:23], 1.0 op_sel_hi:[1,0]
    v_pk_add_f32 v[24:25], v[24:25], 1.0 op_sel_hi:[1,0]
    v_pk_add_f32 v[26:27], v[26:27], 1.0 op_sel_hi:[1,0]
    ds_read_b128 v[188:191], v117 offset:4096
    v_rcp_f32 v20, v20
    v_rcp_f32 v21, v21
    ds_read_b128 v[192:195], v117 offset:6144
    v_rcp_f32 v22, v22
    v_rcp_f32 v23, v23
    v_rcp_f32 v24, v24
    s_add_u32 m0, s39, 114688
    s_nop 0
    buffer_load_dwordx4 v15, s[12:15], s38 offen offset:0 sc1 lds
    v_rcp_f32 v25, v25
    v_rcp_f32 v26, v26
    v_rcp_f32_e64 v27, v27
    v_pk_mul_f32 v[20:21], v[20:21], v[236:237]
    v_pk_mul_f32 v[22:23], v[22:23], v[238:239]
    v_pk_mul_f32 v[24:25], v[24:25], v[240:241]
    v_pk_mul_f32 v[26:27], v[26:27], v[242:243]
    v_cvt_pk_bf16_f32 v212, v20, v21
    v_cvt_pk_bf16_f32 v214, v24, v25
    v_cvt_pk_bf16_f32 v213, v22, v23
    buffer_load_dwordx4 v15, s[12:15], s38 offen offset:1024 sc1 lds
    v_cvt_pk_bf16_f32 v215, v26, v27
    v_permlane16_swap_b32 v212, v214
    s_nop 0
    v_permlane16_swap_b32 v213, v215
    buffer_store_dwordx4 v[212:215], v5, s[12:15], s78 offen sc1
    s_waitcnt vmcnt(8)
    s_mov_b64 exec, 1
    buffer_store_dword v2, v4, s[12:15], s17 offen sc1
    s_mov_b64 exec, -1
    s_add_u32 s17, s17, 128
    buffer_load_dwordx4 v15, s[12:15], s38 offen offset:2048 sc1 lds
    s_waitcnt lgkmcnt(2)
    v_mfma_f32_32x32x16_bf16 v[220:235], a[144:147], v[180:183], 0
    buffer_load_dwordx4 v15, s[12:15], s38 offen offset:3072 sc1 lds
    s_add_u32 s38, s38, 16384
    ds_read_b128 v[196:199], v117 offset:8192
    ds_read_b128 v[180:183], v117 offset:10240
    v_mfma_f32_32x32x16_bf16 v[220:235], a[148:151], v[184:187], v[220:235]
    s_waitcnt lgkmcnt(2)
    v_mfma_f32_32x32x16_bf16 v[220:235], a[152:155], v[188:191], v[220:235]
    s_add_u32 m0, s39, 131072
    s_nop 0
    buffer_load_dwordx4 v15, s[12:15], s38 offen offset:0 sc1 lds
    ds_read_b128 v[184:187], v117 offset:12288
    buffer_load_dwordx4 v15, s[12:15], s38 offen offset:1024 sc1 lds
    ds_read_b128 v[188:191], v117 offset:14336
    v_mfma_f32_32x32x16_bf16 v[220:235], a[156:159], v[192:195], v[220:235]
    s_waitcnt lgkmcnt(2)
    v_mfma_f32_32x32x16_bf16 v[220:235], a[160:163], v[196:199], v[220:235]
    buffer_load_dwordx4 v15, s[12:15], s38 offen offset:2048 sc1 lds
    buffer_load_dwordx4 v15, s[12:15], s38 offen offset:3072 sc1 lds
    s_add_u32 s38, s38, 16384
    s_waitcnt vmcnt(14)
    s_barrier
    v_mfma_f32_32x32x16_bf16 v[220:235], a[164:167], v[180:183], v[220:235]
    ds_read_b128 v[192:195], v117 offset:16384
    ds_read_b128 v[196:199], v117 offset:18432
    s_waitcnt lgkmcnt(2)
    v_mfma_f32_32x32x16_bf16 v[220:235], a[168:171], v[184:187], v[220:235]
    s_sub_u32 s38, s38, s39
    s_min_u32 s39, s3, 2
    s_lshl_b32 s39, s39, 11
    s_add_u32 s38, s38, s39
    s_add_u32 m0, s39, 147456
    s_nop 0
    buffer_load_dwordx4 v15, s[12:15], s38 offen offset:0 sc1 lds
    v_mfma_f32_32x32x16_bf16 v[220:235], a[172:175], v[188:191], v[220:235]
    ds_read_b128 v[180:183], v117 offset:20480
    ds_read_b128 v[184:187], v117 offset:22528
    s_waitcnt lgkmcnt(2)
    v_mfma_f32_32x32x16_bf16 v[220:235], a[176:179], v[192:195], v[220:235]
    ds_read_b128 v[188:191], v117 offset:24576
    ds_read_b128 v[192:195], v117 offset:26624
    v_mfma_f32_32x32x16_bf16 v[220:235], a[180:183], v[196:199], v[220:235]
    s_waitcnt lgkmcnt(2)
    v_mfma_f32_32x32x16_bf16 v[220:235], a[184:187], v[180:183], v[220:235]
    buffer_load_dwordx4 v15, s[12:15], s38 offen offset:1024 sc1 lds
    s_waitcnt vmcnt(9)
    s_mov_b64 exec, 1
    buffer_store_dword v2, v4, s[12:15], s17 offen sc1
    s_mov_b64 exec, -1
    s_add_u32 s17, s17, 128
    v_mfma_f32_32x32x16_bf16 v[220:235], a[188:191], v[184:187], v[220:235]
    ds_read_b128 v[196:199], v117 offset:28672
    ds_read_b128 v[180:183], v117 offset:30720
    s_waitcnt lgkmcnt(2)
    v_mfma_f32_32x32x16_bf16 v[220:235], a[192:195], v[188:191], v[220:235]
    buffer_load_dword v14, v3, s[12:15], s22 offen sc1
    s_barrier
    ds_read_b128 v[184:187], v117 offset:32768
    v_mfma_f32_32x32x16_bf16 v[220:235], a[196:199], v[192:195], v[220:235]
    ds_read_b128 v[188:191], v117 offset:34816
    s_waitcnt lgkmcnt(2)
    v_mfma_f32_32x32x16_bf16 v[220:235], a[200:203], v[196:199], v[220:235]
    ds_read_b128 v[192:195], v117 offset:36864
    ds_read_b128 v[196:199], v117 offset:38912
    v_mfma_f32_32x32x16_bf16 v[220:235], a[204:207], v[180:183], v[220:235]
    s_waitcnt lgkmcnt(2)
    v_mfma_f32_32x32x16_bf16 v[220:235], a[208:211], v[184:187], v[220:235]
    ds_read_b128 v[180:183], v117 offset:40960
    ds_read_b128 v[184:187], v117 offset:43008
    v_mfma_f32_32x32x16_bf16 v[220:235], a[212:215], v[188:191], v[220:235]
    s_waitcnt lgkmcnt(2)
    v_mfma_f32_32x32x16_bf16 v[220:235], a[216:219], v[192:195], v[220:235]
    ds_read_b128 v[188:191], v117 offset:45056
    ds_read_b128 v[192:195], v117 offset:47104
    v_mfma_f32_32x32x16_bf16 v[220:235], a[220:223], v[196:199], v[220:235]
    s_waitcnt lgkmcnt(2)
    v_mfma_f32_32x32x16_bf16 v[220:235], a[224:227], v[180:183], v[220:235]
    s_waitcnt vmcnt(8)
    s_barrier
    ds_read_b128 v[196:199], v117 offset:49152
    ds_read_b128 v[180:183], v117 offset:51200
    v_mfma_f32_32x32x16_bf16 v[220:235], a[228:231], v[184:187], v[220:235]
    s_waitcnt lgkmcnt(2)
    v_mfma_f32_32x32x16_bf16 v[220:235], a[232:235], v[188:191], v[220:235]
    ds_read_b128 v[184:187], v117 offset:53248
    ds_read_b128 v[188:191], v117 offset:55296
    v_mfma_f32_32x32x16_bf16 v[220:235], a[236:239], v[192:195], v[220:235]
    s_waitcnt lgkmcnt(2)
    v_mfma_f32_32x32x16_bf16 v[220:235], a[240:243], v[196:199], v[220:235]
    ds_read_b128 v[192:195], v117 offset:57344
    s_waitcnt vmcnt(0)
    v_cmp_ne_u32 vcc, s6, v14
    s_nop 0
    s_cbranch_vccnz retry_26_s
ready_27_s:
    ds_read_b128 v[196:199], v117 offset:59392
    v_mfma_f32_32x32x16_bf16 v[220:235], a[244:247], v[180:183], v[220:235]
    s_waitcnt lgkmcnt(2)
    v_mfma_f32_32x32x16_bf16 v[220:235], a[248:251], v[184:187], v[220:235]
    ds_read_b128 v[180:183], v117 offset:61440
    s_add_u32 s22, s22, 128
    s_lshl_b32 s39, s3, 12
    s_add_u32 s38, s10, s39
    s_add_u32 s38, s38, 0x3a800
    s_add_u32 m0, s39, 0
    s_nop 0
    buffer_load_dwordx4 v15, s[12:15], s38 offen offset:0 sc1 lds
    v_mfma_f32_32x32x16_bf16 v[220:235], a[252:255], v[188:191], v[220:235]
    ds_read_b128 v[184:187], v117 offset:63488
    s_waitcnt lgkmcnt(2)
    v_mfma_f32_32x32x16_bf16 v[220:235], v[36:39], v[192:195], v[220:235]
    s_barrier
    ds_read_b128 v[188:191], v118 offset:0
    ds_read_b128 v[192:195], v118 offset:2048
    v_mfma_f32_32x32x16_bf16 v[220:235], v[40:43], v[196:199], v[220:235]
    s_waitcnt lgkmcnt(2)
    v_mfma_f32_32x32x16_bf16 v[220:235], v[44:47], v[180:183], v[220:235]
    ds_read_b128 v[196:199], v118 offset:4096
    buffer_load_dwordx4 v15, s[12:15], s38 offen offset:1024 sc1 lds
    ds_read_b128 v[180:183], v118 offset:6144
    v_mfma_f32_32x32x16_bf16 v[220:235], v[48:51], v[184:187], v[220:235]
    s_waitcnt lgkmcnt(2)
    v_mfma_f32_32x32x16_bf16 v[220:235], v[52:55], v[188:191], v[220:235]
    buffer_load_dwordx4 v15, s[12:15], s38 offen offset:2048 sc1 lds
    ds_read_b128 v[184:187], v118 offset:8192
    buffer_load_dwordx4 v15, s[12:15], s38 offen offset:3072 sc1 lds
    s_add_u32 s38, s38, 16384
    ds_read_b128 v[188:191], v118 offset:10240
    v_mfma_f32_32x32x16_bf16 v[220:235], v[56:59], v[192:195], v[220:235]
    s_waitcnt lgkmcnt(2)
    v_mfma_f32_32x32x16_bf16 v[220:235], v[60:63], v[196:199], v[220:235]
    s_add_u32 m0, s39, 16384
    s_nop 0
    buffer_load_dwordx4 v15, s[12:15], s38 offen offset:0 sc1 lds
    ds_read_b128 v[192:195], v118 offset:12288
    buffer_load_dwordx4 v15, s[12:15], s38 offen offset:1024 sc1 lds
    ds_read_b128 v[196:199], v118 offset:14336
    v_mfma_f32_32x32x16_bf16 v[220:235], v[64:67], v[180:183], v[220:235]
    s_waitcnt lgkmcnt(2)
    v_mfma_f32_32x32x16_bf16 v[220:235], v[68:71], v[184:187], v[220:235]
    buffer_load_dwordx4 v15, s[12:15], s38 offen offset:2048 sc1 lds
    s_barrier
    ds_read_b128 v[180:183], v118 offset:16384
    v_mfma_f32_32x32x16_bf16 v[220:235], v[72:75], v[188:191], v[220:235]
    buffer_load_dwordx4 v15, s[12:15], s38 offen offset:3072 sc1 lds
    s_add_u32 s38, s38, 16384
    ds_read_b128 v[184:187], v118 offset:18432
    s_waitcnt lgkmcnt(2)
    v_mfma_f32_32x32x16_bf16 v[220:235], v[76:79], v[192:195], v[220:235]
    buffer_load_dword v14, v3, s[12:15], s22 offen sc1
    ds_read_b128 v[188:191], v118 offset:20480
    v_mfma_f32_32x32x16_bf16 v[220:235], v[80:83], v[196:199], v[220:235]
    s_waitcnt lgkmcnt(1)
    v_mfma_f32_32x32x16_bf16 v[220:235], a[0:3], v[180:183], v[220:235]
    s_waitcnt vmcnt(5)
    s_barrier
    ds_read_b128 v[200:203], v116 offset:0
    ds_read_b128 v[204:207], v116 offset:2048
    v_mfma_f32_32x32x16_bf16 v[220:235], a[4:7], v[184:187], v[220:235]
    ds_read_b128 v[208:211], v116 offset:4096
    ds_read_b128 v[212:215], v116 offset:6144
    s_waitcnt lgkmcnt(4)
    v_mfma_f32_32x32x16_bf16 v[220:235], a[8:11], v[188:191], v[220:235]
    s_add_u32 m0, s39, 32768
    s_nop 0
    buffer_load_dwordx4 v15, s[12:15], s38 offen offset:0 sc1 lds
    s_waitcnt lgkmcnt(2)
    v_mfma_f32_32x32x16_bf16 v[236:251], a[144:147], v[200:203], 0
    ds_read_b128 v[216:219], v116 offset:8192
    buffer_load_dwordx4 v15, s[12:15], s38 offen offset:1024 sc1 lds
    ds_read_b128 v[200:203], v116 offset:10240
    v_mfma_f32_32x32x16_bf16 v[236:251], a[148:151], v[204:207], v[236:251]
    s_waitcnt lgkmcnt(2)
    v_mfma_f32_32x32x16_bf16 v[236:251], a[152:155], v[208:211], v[236:251]
    buffer_load_dwordx4 v15, s[12:15], s38 offen offset:2048 sc1 lds
    ds_write_b128 v9, v[228:231] offset:0
    v_mfma_f32_32x32x16_bf16 v[236:251], a[156:159], v[212:215], v[236:251]
    ds_read_b128 v[204:207], v116 offset:12288
    buffer_load_dwordx4 v15, s[12:15], s38 offen offset:3072 sc1 lds
    s_add_u32 s38, s38, 16384
    ds_read_b128 v[208:211], v116 offset:14336
    s_waitcnt lgkmcnt(3)
    v_mfma_f32_32x32x16_bf16 v[236:251], a[160:163], v[216:219], v[236:251]
    s_add_u32 m0, s39, 49152
    s_nop 0
    buffer_load_dwordx4 v15, s[12:15], s38 offen offset:0 sc1 lds
    s_waitcnt vmcnt(6)
    s_barrier
    ds_read_b128 v[212:215], v116 offset:16384
    buffer_load_dwordx4 v15, s[12:15], s38 offen offset:1024 sc1 lds
    v_mfma_f32_32x32x16_bf16 v[236:251], a[164:167], v[200:203], v[236:251]
    ds_write_b128 v9, v[232:235] offset:1024
    ds_read_b128 v[216:219], v116 offset:18432
    s_waitcnt lgkmcnt(3)
    v_mfma_f32_32x32x16_bf16 v[236:251], a[168:171], v[204:207], v[236:251]
    buffer_load_dwordx4 v15, s[12:15], s38 offen offset:2048 sc1 lds
    buffer_load_dwordx4 v15, s[12:15], s38 offen offset:3072 sc1 lds
    s_add_u32 s38, s38, 16384
    ds_read_b128 v[200:203], v116 offset:20480
    ds_read_b128 v[204:207], v116 offset:22528
    v_mfma_f32_32x32x16_bf16 v[236:251], a[172:175], v[208:211], v[236:251]
    s_waitcnt lgkmcnt(2)
    v_mfma_f32_32x32x16_bf16 v[236:251], a[176:179], v[212:215], v[236:251]
    s_waitcnt vmcnt(8)
    v_cmp_ne_u32 vcc, s6, v14
    s_nop 0
    s_cbranch_vccnz retry_28_s
ready_29_s:
    ds_read_b128 v[208:211], v116 offset:24576
    s_add_u32 s22, s22, 128
    ds_read_b128 v[212:215], v116 offset:26624
    v_mfma_f32_32x32x16_bf16 v[236:251], a[180:183], v[216:219], v[236:251]
    s_waitcnt lgkmcnt(2)
    v_mfma_f32_32x32x16_bf16 v[236:251], a[184:187], v[200:203], v[236:251]
    s_add_u32 m0, s39, 65536
    s_nop 0
    buffer_load_dwordx4 v15, s[12:15], s38 offen offset:0 sc1 lds
    ds_read_b128 v[216:219], v116 offset:28672
    buffer_load_dwordx4 v15, s[12:15], s38 offen offset:1024 sc1 lds
    ds_read_b128 v[200:203], v116 offset:30720
    v_mfma_f32_32x32x16_bf16 v[236:251], a[188:191], v[204:207], v[236:251]
    s_waitcnt lgkmcnt(2)
    v_mfma_f32_32x32x16_bf16 v[236:251], a[192:195], v[208:211], v[236:251]
    buffer_load_dwordx4 v15, s[12:15], s38 offen offset:2048 sc1 lds
    s_waitcnt vmcnt(7)
    s_barrier
    ds_read_b128 v[204:207], v116 offset:32768
    v_mfma_f32_32x32x16_bf16 v[236:251], a[196:199], v[212:215], v[236:251]
    buffer_load_dwordx4 v15, s[12:15], s38 offen offset:3072 sc1 lds
    s_add_u32 s38, s38, 16384
    ds_read_b128 v[208:211], v116 offset:34816
    s_waitcnt lgkmcnt(2)
    v_mfma_f32_32x32x16_bf16 v[236:251], a[200:203], v[216:219], v[236:251]
    s_sub_u32 s38, s38, s39
    s_min_u32 s39, s3, 2
    s_lshl_b32 s39, s39, 11
    s_add_u32 s38, s38, s39
    s_add_u32 m0, s39, 81920
    s_nop 0
    buffer_load_dwordx4 v15, s[12:15], s38 offen offset:0 sc1 lds
    v_mfma_f32_32x32x16_bf16 v[236:251], a[204:207], v[200:203], v[236:251]
    ds_read_b128 v[212:215], v116 offset:36864
    ds_read_b128 v[216:219], v116 offset:38912
    s_waitcnt lgkmcnt(2)
    v_mfma_f32_32x32x16_bf16 v[236:251], a[208:211], v[204:207], v[236:251]
    ds_read_b128 v[228:231], v10 offset:0
    ds_read_b128 v[200:203], v116 offset:40960
    ds_read_b128 v[232:235], v10 offset:1024
    ds_read_b128 v[204:207], v116 offset:43008
    v_mfma_f32_32x32x16_bf16 v[236:251], a[212:215], v[208:211], v[236:251]
    s_waitcnt lgkmcnt(4)
    v_mfma_f32_32x32x16_bf16 v[236:251], a[216:219], v[212:215], v[236:251]
    buffer_load_dwordx4 v15, s[12:15], s38 offen offset:1024 sc1 lds
    ds_read_b128 v[208:211], v116 offset:45056
    ds_read_b128 v[212:215], v116 offset:47104
    v_mfma_f32_32x32x16_bf16 v[236:251], a[220:223], v[216:219], v[236:251]
    s_waitcnt lgkmcnt(2)
    v_mfma_f32_32x32x16_bf16 v[236:251], a[224:227], v[200:203], v[236:251]
    s_waitcnt vmcnt(6)
    s_barrier
    ds_read_b128 v[216:219], v116 offset:49152
    v_add_f32 v220, v220, v228
    v_mfma_f32_32x32x16_bf16 v[236:251], a[228:231], v[204:207], v[236:251]
    v_add_f32 v221, v221, v229
    ds_read_b128 v[200:203], v116 offset:51200
    s_waitcnt lgkmcnt(2)
    v_mfma_f32_32x32x16_bf16 v[236:251], a[232:235], v[208:211], v[236:251]
    v_add_f32 v222, v222, v230
    v_add_f32 v223, v223, v231
    ds_read_b128 v[204:207], v116 offset:53248
    v_add_f32 v224, v224, v232
    v_add_f32 v225, v225, v233
    ds_read_b128 v[208:211], v116 offset:55296
    v_mfma_f32_32x32x16_bf16 v[236:251], a[236:239], v[212:215], v[236:251]
    s_waitcnt lgkmcnt(2)
    v_mfma_f32_32x32x16_bf16 v[236:251], a[240:243], v[216:219], v[236:251]
    v_add_f32 v226, v226, v234
    v_add_f32 v227, v227, v235
    ds_read_b128 v[212:215], v116 offset:57344
    v_fmac_f32_dpp v84, v100, v220 row_newbcast:12 row_mask:0xf bank_mask:0xf
    v_fmac_f32_dpp v85, v101, v221 row_newbcast:12 row_mask:0xf bank_mask:0xf
    ds_read_b128 v[216:219], v116 offset:59392
    v_mfma_f32_32x32x16_bf16 v[236:251], a[244:247], v[200:203], v[236:251]
    s_waitcnt lgkmcnt(2)
    v_mfma_f32_32x32x16_bf16 v[236:251], a[248:251], v[204:207], v[236:251]
    v_fmac_f32_dpp v86, v102, v222 row_newbcast:12 row_mask:0xf bank_mask:0xf
    v_fmac_f32_dpp v87, v103, v223 row_newbcast:12 row_mask:0xf bank_mask:0xf
    ds_read_b128 v[200:203], v116 offset:61440
    v_fmac_f32_dpp v88, v104, v224 row_newbcast:12 row_mask:0xf bank_mask:0xf
    v_fmac_f32_dpp v89, v105, v225 row_newbcast:12 row_mask:0xf bank_mask:0xf
    ds_read_b128 v[204:207], v116 offset:63488
    v_mfma_f32_32x32x16_bf16 v[236:251], a[252:255], v[208:211], v[236:251]
    s_waitcnt lgkmcnt(2)
    v_mfma_f32_32x32x16_bf16 v[236:251], v[36:39], v[212:215], v[236:251]
    v_fmac_f32_dpp v90, v106, v226 row_newbcast:12 row_mask:0xf bank_mask:0xf
    v_fmac_f32_dpp v91, v107, v227 row_newbcast:12 row_mask:0xf bank_mask:0xf
    s_waitcnt vmcnt(2)
    s_barrier
    v_mfma_f32_32x32x16_bf16 v[236:251], v[40:43], v[216:219], v[236:251]
    ds_read_b128 v[208:211], v117 offset:0
    v_cvt_pk_bf16_f32 v220, v84, v85
    v_cvt_pk_bf16_f32 v222, v88, v89
    ds_read_b128 v[212:215], v117 offset:2048
    s_waitcnt lgkmcnt(2)
    v_mfma_f32_32x32x16_bf16 v[236:251], v[44:47], v[200:203], v[236:251]
    v_cvt_pk_bf16_f32 v221, v86, v87
    v_cvt_pk_bf16_f32 v223, v90, v91
    ds_read_b128 v[216:219], v117 offset:4096
    v_permlane32_swap_b32 v220, v222
    ds_read_b128 v[200:203], v117 offset:6144
    v_mfma_f32_32x32x16_bf16 v[236:251], v[48:51], v[204:207], v[236:251]
    s_waitcnt lgkmcnt(2)
    v_mfma_f32_32x32x16_bf16 v[236:251], v[52:55], v[208:211], v[236:251]
    v_permlane32_swap_b32 v221, v223
    ds_read_b128 v[204:207], v117 offset:8192
    buffer_store_dwordx4 v[220:223], v6, s[52:55], s96 offen
    s_add_u32 s96, s96, 32768
    ds_read_b128 v[208:211], v117 offset:10240
    v_mfma_f32_32x32x16_bf16 v[236:251], v[56:59], v[212:215], v[236:251]
    s_waitcnt lgkmcnt(2)
    v_mfma_f32_32x32x16_bf16 v[236:251], v[60:63], v[216:219], v[236:251]
    ds_read_b128 v[212:215], v117 offset:12288
    ds_read_b128 v[216:219], v117 offset:14336
    v_mfma_f32_32x32x16_bf16 v[236:251], v[64:67], v[200:203], v[236:251]
    s_waitcnt lgkmcnt(2)
    v_mfma_f32_32x32x16_bf16 v[236:251], v[68:71], v[204:207], v[236:251]
    s_waitcnt vmcnt(1)
    s_barrier
    ds_read_b128 v[200:203], v117 offset:16384
    ds_read_b128 v[204:207], v117 offset:18432
    v_mfma_f32_32x32x16_bf16 v[236:251], v[72:75], v[208:211], v[236:251]
    s_waitcnt lgkmcnt(2)
    v_mfma_f32_32x32x16_bf16 v[236:251], v[76:79], v[212:215], v[236:251]
    ds_read_b128 v[208:211], v117 offset:20480
    v_mfma_f32_32x32x16_bf16 v[236:251], v[80:83], v[216:219], v[236:251]
    s_waitcnt lgkmcnt(1)
    v_mfma_f32_32x32x16_bf16 v[236:251], a[0:3], v[200:203], v[236:251]
    v_mfma_f32_32x32x16_bf16 v[236:251], a[4:7], v[204:207], v[236:251]
    s_waitcnt lgkmcnt(0)
    v_mfma_f32_32x32x16_bf16 v[236:251], a[8:11], v[208:211], v[236:251]
    s_nop 11
    ds_write_b128 v9, v[244:247] offset:0
    ds_write_b128 v9, v[248:251] offset:1024
    s_waitcnt lgkmcnt(0)
    s_barrier
    ds_read_b128 v[244:247], v10 offset:0
    ds_read_b128 v[248:251], v10 offset:1024
    s_waitcnt lgkmcnt(1)
    v_add_f32 v236, v236, v244
    v_add_f32 v237, v237, v245
    v_add_f32 v238, v238, v246
    v_add_f32 v239, v239, v247
    s_waitcnt lgkmcnt(0)
    v_add_f32 v240, v240, v248
    v_add_f32 v241, v241, v249
    v_add_f32 v242, v242, v250
    v_add_f32 v243, v243, v251
    v_fmac_f32_dpp v92, v100, v236 row_newbcast:12 row_mask:0xf bank_mask:0xf
    v_fmac_f32_dpp v93, v101, v237 row_newbcast:12 row_mask:0xf bank_mask:0xf
    v_fmac_f32_dpp v94, v102, v238 row_newbcast:12 row_mask:0xf bank_mask:0xf
    v_fmac_f32_dpp v95, v103, v239 row_newbcast:12 row_mask:0xf bank_mask:0xf
    v_fmac_f32_dpp v96, v104, v240 row_newbcast:12 row_mask:0xf bank_mask:0xf
    v_fmac_f32_dpp v97, v105, v241 row_newbcast:12 row_mask:0xf bank_mask:0xf
    v_fmac_f32_dpp v98, v106, v242 row_newbcast:12 row_mask:0xf bank_mask:0xf
    v_fmac_f32_dpp v99, v107, v243 row_newbcast:12 row_mask:0xf bank_mask:0xf
    v_cvt_pk_bf16_f32 v236, v92, v93
    v_cvt_pk_bf16_f32 v238, v96, v97
    v_cvt_pk_bf16_f32 v237, v94, v95
    v_cvt_pk_bf16_f32 v239, v98, v99
    v_permlane32_swap_b32 v236, v238
    s_nop 0
    v_permlane32_swap_b32 v237, v239
    buffer_store_dwordx4 v[236:239], v6, s[52:55], s96 offen
L_end_s:
    s_endpgm
retry_8_s:
    s_sub_u32 s7, s7, 1
    s_cbranch_scc0 retry_8_go_s
    s_mov_b32 s7, 0
    s_branch ready_9_s
retry_8_go_s:
    s_mov_b32 exec_lo, 0xf00ff00f
    s_mov_b32 exec_hi, exec_lo
    buffer_load_dwordx4 v[100:103], v120, s[12:15], s97 offen sc1
    s_mov_b64 exec, -1
    s_waitcnt vmcnt(0)
    v_xor_b32 v100, s72, v100
    v_xor_b32 v101, s73, v101
    v_xor_b32 v102, s74, v102
    v_xor_b32 v103, s75, v103
    v_or3_b32 v122, v100, v101, v102
    v_or_b32 v122, v122, v103
    v_and_b32 v122, 0xff, v122
    s_mov_b32 exec_lo, 0xf00ff00f
    s_mov_b32 exec_hi, exec_lo
    v_cmp_ne_u32 vcc, 0, v122
    s_mov_b64 exec, -1
    s_cbranch_vccnz retry_8_s
    s_branch ready_9_s
retry_10_s:
    s_sub_u32 s7, s7, 1
    s_cbranch_scc0 retry_10_go_s
    s_mov_b32 s7, 0
    s_branch ready_11_s
retry_10_go_s:
    buffer_load_dwordx4 v[84:87], v128, s[12:15], s84 offen sc1
    buffer_load_dwordx4 v[88:91], v128, s[12:15], s85 offen sc1
    buffer_load_dwordx4 v[92:95], v128, s[12:15], s86 offen sc1
    buffer_load_dwordx4 v[96:99], v128, s[12:15], s87 offen sc1
    s_waitcnt vmcnt(0)
    v_xor_b32 v84, s72, v84
    v_xor_b32 v85, s73, v85
    v_xor_b32 v86, s74, v86
    v_xor_b32 v87, s75, v87
    v_xor_b32 v88, s72, v88
    v_xor_b32 v89, s73, v89
    v_xor_b32 v90, s74, v90
    v_xor_b32 v91, s75, v91
    v_xor_b32 v92, s72, v92
    v_xor_b32 v93, s73, v93
    v_xor_b32 v94, s74, v94
    v_xor_b32 v95, s75, v95
    v_xor_b32 v96, s72, v96
    v_xor_b32 v97, s73, v97
    v_xor_b32 v98, s74, v98
    v_xor_b32 v99, s75, v99
    v_or3_b32 v150, v84, v85, v86
    v_or3_b32 v151, v87, v88, v89
    v_or3_b32 v152, v90, v91, v92
    v_or3_b32 v153, v93, v94, v95
    v_or3_b32 v154, v96, v97, v98
    v_or3_b32 v150, v150, v151, v152
    v_or3_b32 v153, v153, v154, v99
    v_or_b32 v150, v150, v153
    v_and_b32 v150, 0xff, v150
    v_cmp_ne_u32 vcc, 0, v150
    s_nop 0
    s_cbranch_vccnz retry_10_s
    s_branch ready_11_s
retry_14_s:
    s_sub_u32 s7, s7, 1
    s_cbranch_scc0 retry_14_go_s
    s_mov_b32 s7, 0
    s_branch ready_15_s
retry_14_go_s:
    buffer_load_dword v14, v3, s[12:15], s22 offen sc1
    s_waitcnt vmcnt(0)
    v_cmp_ne_u32 vcc, s6, v14
    s_nop 0
    s_cbranch_vccnz retry_14_s
    s_branch ready_15_s
retry_16_s:
    s_sub_u32 s7, s7, 1
    s_cbranch_scc0 retry_16_go_s
    s_mov_b32 s7, 0
    s_branch ready_17_s
retry_16_go_s:
    buffer_load_dword v14, v3, s[12:15], s22 offen sc1
    s_waitcnt vmcnt(0)
    v_cmp_ne_u32 vcc, s6, v14
    s_nop 0
    s_cbranch_vccnz retry_16_s
    s_branch ready_17_s
retry_18_s:
    s_sub_u32 s7, s7, 1
    s_cbranch_scc0 retry_18_go_s
    s_mov_b32 s7, 0
    s_branch ready_19_s
retry_18_go_s:
    buffer_load_dword v14, v3, s[12:15], s22 offen sc1
    s_waitcnt vmcnt(0)
    v_cmp_ne_u32 vcc, s6, v14
    s_nop 0
    s_cbranch_vccnz retry_18_s
    s_branch ready_19_s
retry_20_s:
    s_sub_u32 s7, s7, 1
    s_cbranch_scc0 retry_20_go_s
    s_mov_b32 s7, 0
    s_branch ready_21_s
retry_20_go_s:
    buffer_load_dword v14, v3, s[12:15], s22 offen sc1
    s_waitcnt vmcnt(0)
    v_cmp_ne_u32 vcc, s6, v14
    s_nop 0
    s_cbranch_vccnz retry_20_s
    s_branch ready_21_s
retry_22_s:
    s_sub_u32 s7, s7, 1
    s_cbranch_scc0 retry_22_go_s
    s_mov_b32 s7, 0
    s_branch ready_23_s
retry_22_go_s:
    buffer_load_dword v14, v3, s[12:15], s22 offen sc1
    s_waitcnt vmcnt(0)
    v_cmp_ne_u32 vcc, s6, v14
    s_nop 0
    s_cbranch_vccnz retry_22_s
    s_branch ready_23_s
retry_24_s:
    s_sub_u32 s7, s7, 1
    s_cbranch_scc0 retry_24_go_s
    s_mov_b32 s7, 0
    s_branch ready_25_s
retry_24_go_s:
    buffer_load_dword v14, v3, s[12:15], s22 offen sc1
    s_waitcnt vmcnt(0)
    v_cmp_ne_u32 vcc, s6, v14
    s_nop 0
    s_cbranch_vccnz retry_24_s
    s_branch ready_25_s
retry_26_s:
    s_sub_u32 s7, s7, 1
    s_cbranch_scc0 retry_26_go_s
    s_mov_b32 s7, 0
    s_branch ready_27_s
retry_26_go_s:
    buffer_load_dword v14, v3, s[12:15], s22 offen sc1
    s_waitcnt vmcnt(0)
    v_cmp_ne_u32 vcc, s6, v14
    s_nop 0
    s_cbranch_vccnz retry_26_s
    s_branch ready_27_s
retry_28_s:
    s_sub_u32 s7, s7, 1
    s_cbranch_scc0 retry_28_go_s
    s_mov_b32 s7, 0
    s_branch ready_29_s
retry_28_go_s:
    buffer_load_dword v14, v3, s[12:15], s22 offen sc1
    s_waitcnt vmcnt(0)
    v_cmp_ne_u32 vcc, s6, v14
    s_nop 0
    s_cbranch_vccnz retry_28_s
    s_branch ready_29_s
L_code_end:
.set CODE_LAST, L_fast_end - adaLN_cond__sliding_local_dilated__mixer_channel_mlp__prompt_kernel - 128
.set pf_last1, L_end - L_pf1
.set pf_last2, L_end - L_pf2
.set pf_last3, L_end - L_pf3
.set pf_last4, L_end - L_pf4
.section .rodata,"a"
.p2align 6
.amdhsa_kernel adaLN_cond__sliding_local_dilated__mixer_channel_mlp__prompt_kernel
  .amdhsa_next_free_vgpr 512
  .amdhsa_next_free_sgpr 102
  .amdhsa_accum_offset 256
  .amdhsa_group_segment_fixed_size 0
  .amdhsa_kernarg_size 104
  .amdhsa_user_sgpr_count 2
  .amdhsa_user_sgpr_kernarg_segment_ptr 1
  .amdhsa_system_sgpr_workgroup_id_x 1
.end_amdhsa_kernel
```
